```python
import torch

def _softmax(x, axis=-1):
    return torch.softmax(x, dim=axis)
def _gelu(x):
    return torch.nn.functional.gelu(x, approximate="tanh")
def _silu(x):
    return torch.nn.functional.silu(x)
def _sigmoid(x):
    return torch.sigmoid(x)
def _layernorm(x, axis=-1, eps=1e-5):
    m = x.mean(dim=axis, keepdim=True)
    v = x.var(dim=axis, keepdim=True, unbiased=False)
    return (x - m) / torch.sqrt(v + eps)
def _scatter_add(tgt, idx, src, axis=0):
    return tgt.clone().index_add_(axis, idx, src)
def _segment_sum(src, seg, n):
    out = torch.zeros((n,) + src.shape[1:], dtype=src.dtype)
    return out.index_add_(0, seg, src)
def _pad(x, pw):
    flat = tuple(v for pair in reversed(pw) for v in pair)
    return torch.nn.functional.pad(x, flat)

kernel_name = 'standalone__mha_block_cached__near_ridge'

def setup_inputs():

    _w = (lambda a: (lambda t: t.to(torch.bfloat16) if t.is_floating_point() else t)(torch.as_tensor(a)))
    B, Sq, D = 16, 160, 640
    H, Sk, Dh = 32, 512, 128
    return {
        "x": _w((lambda *s: torch.randn(*s, dtype=torch.bfloat16) * 0.8)(B, Sq, D)),
        "k_cache": _w((lambda *s: torch.randn(*s, dtype=torch.bfloat16) * 0.8)(B, H, Sk, Dh)),
        "v_cache": _w((lambda *s: torch.randn(*s, dtype=torch.bfloat16) * 0.05)(B, H, Sk, Dh)),
        "wq": _w((lambda *s: torch.randn(*s, dtype=torch.bfloat16) * 0.8)(D, H * Dh) * (D ** -0.5)),
        "wo": _w((lambda *s: torch.randn(*s, dtype=torch.bfloat16) * 0.05)(H * Dh, D) * ((H * Dh) ** -0.5)),
    }

def reference(x, k_cache, v_cache, wq, wo):
    B, Sq, D = x.shape
    H, Dh = 32, 128
    q = (lambda x, *d: x.permute(*d))((x @ wq).reshape(B, Sq, H, Dh), 0, 2, 1, 3)
    scores = torch.einsum("bhqd,bhkd->bhqk", q, k_cache) * (Dh ** -0.5)
    p = _softmax(scores, axis=-1)
    o = torch.einsum("bhqk,bhkd->bhqd", p, v_cache)
    return (lambda x, *d: x.permute(*d))(o, 0, 2, 1, 3).reshape(B, Sq, H * Dh) @ wo
```

```asm
; @launch grid=(256,1,1) block=(256,1,1) lds=163840
.amdgcn_target "amdgcn-amd-amdhsa--gfx950"
.text
.globl standalone__mha_block_cached__near_ridge_kernel
.p2align 8
.type standalone__mha_block_cached__near_ridge_kernel,@function
standalone__mha_block_cached__near_ridge_kernel:
    s_cmp_ge_u32 s2, 256
    s_cbranch_scc1 K1_END
    s_load_dwordx8 s[36:43], s[0:1], 0
    s_getpc_b64 s[22:23]
K1_PC:
    v_lshlrev_b32 v208, 7, v0
    v_min_u32 v210, K1_FALL-K1_PC, v208
    v_mov_b32 v211, s23
    v_add_co_u32 v210, vcc, s22, v210
    s_nop 1
    v_addc_co_u32 v211, vcc, 0, v211, vcc
    global_load_dword v198, v[210:211], off
    v_lshrrev_b32 v254, 6, v0
    v_and_b32 v255, 63, v0
    v_readfirstlane_b32 s3, v254
    s_bfe_u32 s50, s2, 0x30003
    s_lshr_b32 s51, s2, 6
    s_bfe_u32 s7, s2, 0x20001
    s_lshl2_add_u32 s7, s7, s51
    s_lshl_b32 s53, s50, 2
    s_lshr_b32 s52, 0x98654210, s53
    s_and_b32 s52, s52, 15
    s_lshl_b32 s53, s51, 2
    s_lshr_b32 s54, 0x8530, s53
    s_and_b32 s54, s54, 15
    s_add_u32 s52, s52, s54
    s_cmp_ge_u32 s52, 10
    s_cselect_b32 s53, 10, 0
    s_sub_u32 s52, s52, s53
    s_lshr_b32 s4, s3, 1
    s_and_b32 s5, s3, 1
    v_lshrrev_b32 v245, 5, v255
    v_and_b32 v246, 31, v255
    s_lshl_b32 s53, s5, 3
    v_xor_b32 v246, v246, v245
    v_xor_b32 v246, s53, v246
    s_lshl_b32 s53, s3, 16
    s_lshl_b32 s54, s7, 9
    s_add_u32 s53, s53, s54
    v_lshl_add_u32 v247, v245, 13, s53
    v_lshl_add_u32 v178, v246, 4, v247
    v_xor_b32 v246, 4, v246
    v_lshl_add_u32 v247, v246, 4, v247
    v_add_u32 v179, 15360, v247
    v_add_u32 v180, 30720, v178
    v_add_u32 v181, 46080, v247
    s_lshl_b32 s55, s3, 12
    s_lshl_b32 s56, s52, 19
    s_waitcnt lgkmcnt(0)
    s_mov_b32 s12, s42
    s_and_b32 s13, s43, 0xffff
    s_mov_b32 s14, 5242880
    s_mov_b32 s15, 0x20000
    s_add_u32 m0, s55, 32768
    s_nop 0
    buffer_load_dwordx4 v178, s[12:15], s56 offen offset:0 lds
    buffer_load_dwordx4 v179, s[12:15], s56 offen offset:1024 lds
    buffer_load_dwordx4 v180, s[12:15], s56 offen offset:2048 lds
    buffer_load_dwordx4 v181, s[12:15], s56 offen offset:3072 lds
    s_mov_b32 s8, s36
    s_and_b32 s9, s37, 0xffff
    s_mov_b32 s10, 3276800
    s_mov_b32 s11, 0x20000
    s_load_dwordx2 s[44:45], s[0:1], 32
    s_load_dwordx2 s[46:47], s[0:1], 56
    s_load_dwordx2 s[68:69], s[0:1], 48
    s_memrealtime s[80:81]
    s_and_b32 s6, s2, 1
    s_lshl3_add_u32 s6, s6, s50
    v_lshrrev_b32 v241, 4, v255
    v_and_b32 v244, 3, v255
    v_lshrrev_b32 v245, 3, v255
    v_mul_u32_u24 v247, 1280, v245
    v_and_b32 v246, 7, v255
    v_xor_b32 v246, v246, v241
    s_lshl_b32 s53, s5, 2
    v_xor_b32 v246, s53, v246
    v_lshl_add_u32 v182, v246, 4, v247
    v_xor_b32 v247, 64, v182
    v_add_u32 v183, 9216, v247
    v_add_u32 v184, 18432, v182
    v_add_u32 v185, 27648, v247
    v_add_u32 v186, 40960, v182
    s_lshl_b32 s57, s52, 7
    s_lshl2_add_u32 s53, s6, s3
    s_mul_i32 s58, s53, 51200
    s_add_u32 s67, s58, s57
    s_mul_i32 s64, s3, 5120
    s_add_u32 m0, s64, 98304
    s_add_u32 s56, s56, 0x40000
    buffer_load_dwordx4 v182, s[8:11], s67 offen offset:0 lds
    buffer_load_dwordx4 v183, s[8:11], s67 offen offset:1024 lds
    buffer_load_dwordx4 v184, s[8:11], s67 offen offset:2048 lds
    buffer_load_dwordx4 v185, s[8:11], s67 offen offset:3072 lds
    s_add_u32 m0, s64, 102400
    s_add_u32 s57, s57, 128
    buffer_load_dwordx4 v186, s[8:11], s67 offen offset:0 lds
    s_add_u32 m0, s55, 49152
    s_nop 0
    buffer_load_dwordx4 v178, s[12:15], s56 offen offset:0 lds
    buffer_load_dwordx4 v179, s[12:15], s56 offen offset:1024 lds
    v_and_b32 v242, 15, v255
    v_bfe_u32 v243, v255, 2, 2
    s_waitcnt lgkmcnt(0)
    s_mov_b32 s24, s38
    s_and_b32 s25, s39, 0xffff
    s_mov_b32 s26, 67108864
    s_mov_b32 s27, 0x20000
    s_mov_b32 s16, s40
    s_and_b32 s17, s41, 0xffff
    s_mov_b32 s18, 67108864
    s_mov_b32 s19, 0x20000
    s_mov_b32 s28, s46
    s_and_b32 s29, s47, 0xffff
    s_mov_b32 s30, 34611200
    s_mov_b32 s31, 0x20000
    s_mov_b32 s32, s44
    s_and_b32 s33, s45, 0xffff
    s_mov_b32 s34, 5242880
    s_mov_b32 s35, 0x20000
    s_lshl_b32 s60, s6, 5
    s_lshl_b32 s53, s7, 1
    s_add_u32 s60, s60, s53
    s_add_u32 s60, s60, s4
    s_lshl_b32 s60, s60, 17
    s_lshl_b32 s53, s5, 12
    s_add_u32 s60, s60, s53
    s_lshl_b32 s61, s4, 16
    s_add_u32 s61, s61, s53
    v_lshlrev_b32 v247, 8, v241
    v_xor_b32 v245, v242, v241
    v_xor_b32 v237, 0, v245
    v_lshl_add_u32 v237, v237, 4, v247
    v_xor_b32 v238, 4, v245
    v_lshl_add_u32 v238, v238, 4, v247
    v_xor_b32 v239, 8, v245
    v_lshl_add_u32 v239, v239, 4, v247
    v_xor_b32 v240, 12, v245
    v_lshl_add_u32 v240, v240, 4, v247
    v_lshlrev_b32 v245, 1, v241
    v_xor_b32 v245, v242, v245
    v_lshl_add_u32 v206, v245, 4, v247
    v_xor_b32 v253, 128, v206
    s_lshl_b32 s53, s4, 16
    v_lshlrev_b32 v247, 8, v242
    v_add_u32 v247, s53, v247
    v_xor_b32 v246, v241, v242
    v_xor_b32 v225, 0, v246
    v_lshl_add_u32 v225, v225, 4, v247
    v_xor_b32 v226, 4, v246
    v_lshl_add_u32 v226, v226, 4, v247
    v_xor_b32 v227, 8, v246
    v_lshl_add_u32 v227, v227, 4, v247
    v_xor_b32 v228, 12, v246
    v_lshl_add_u32 v228, v228, 4, v247
    v_lshrrev_b32 v245, 2, v255
    v_lshlrev_b32 v247, 8, v245
    s_add_u32 s53, s53, 8192
    v_add_u32 v247, s53, v247
    v_and_b32 v246, 1, v255
    v_lshl_add_u32 v247, v246, 3, v247
    v_and_b32 v245, 7, v245
    v_lshlrev_b32 v245, 1, v245
    v_bfe_u32 v246, v255, 1, 1
    v_xor_b32 v246, v246, v245
    v_xor_b32 v229, 0, v246
    v_lshl_add_u32 v229, v229, 4, v247
    v_xor_b32 v230, 2, v246
    v_lshl_add_u32 v230, v230, 4, v247
    v_xor_b32 v231, 4, v246
    v_lshl_add_u32 v231, v231, 4, v247
    v_xor_b32 v232, 6, v246
    v_lshl_add_u32 v232, v232, 4, v247
    v_xor_b32 v233, 8, v246
    v_lshl_add_u32 v233, v233, 4, v247
    v_xor_b32 v234, 10, v246
    v_lshl_add_u32 v234, v234, 4, v247
    v_xor_b32 v235, 12, v246
    v_lshl_add_u32 v235, v235, 4, v247
    v_xor_b32 v236, 14, v246
    v_lshl_add_u32 v236, v236, 4, v247
    v_lshl_add_u32 v247, v241, 3, v243
    v_lshlrev_b32 v247, 9, v247
    s_lshl_b32 s53, s4, 8
    v_add_u32 v247, s53, v247
    v_and_b32 v246, 1, v244
    v_lshl_add_u32 v247, v246, 3, v247
    v_and_b32 v245, 1, v243
    v_lshrrev_b32 v246, 1, v243
    v_lshl_or_b32 v245, v246, 2, v245
    v_and_b32 v246, 1, v241
    v_lshl_or_b32 v245, v246, 3, v245
    v_xor_b32 v245, v245, v244
    v_xor_b32 v160, 0, v245
    v_lshl_add_u32 v160, v160, 4, v247
    v_xor_b32 v161, 8, v160
    v_xor_b32 v162, 4, v245
    v_lshl_add_u32 v162, v162, 4, v247
    v_xor_b32 v163, 8, v162
    v_xor_b32 v164, 8, v245
    v_lshl_add_u32 v164, v164, 4, v247
    v_xor_b32 v165, 8, v164
    v_xor_b32 v166, 12, v245
    v_lshl_add_u32 v166, v166, 4, v247
    v_xor_b32 v167, 8, v166
    v_add_u32 v168, 0x10000, v160
    v_add_u32 v169, 0x10000, v161
    v_add_u32 v170, 0x10000, v162
    v_add_u32 v171, 0x10000, v163
    v_add_u32 v172, 0x10000, v164
    v_add_u32 v173, 0x10000, v165
    v_add_u32 v174, 0x10000, v166
    v_add_u32 v175, 0x10000, v167
    s_mul_i32 s53, s5, 10240
    s_add_u32 s53, s53, 98304
    v_lshl_add_u32 v247, v242, 7, s53
    v_lshrrev_b32 v245, 1, v242
    v_xor_b32 v245, v245, v241
    v_lshl_add_u32 v176, v245, 4, v247
    v_xor_b32 v177, 64, v176
    s_lshl_b32 s53, s6, 1
    s_add_u32 s53, s53, s5
    s_lshl_b32 s53, s53, 7
    s_lshl_b32 s54, s7, 1
    s_add_u32 s54, s54, s4
    s_lshl_b32 s54, s54, 2
    s_add_u32 s54, s53, s54
    s_mul_i32 s48, s54, 5120
    s_add_u32 s49, s48, 5120
    s_add_u32 s50, s48, 10240
    s_add_u32 s51, s48, 15360
    s_and_b32 s42, s7, 3
    s_lshr_b32 s43, s7, 2
    s_lshl_b32 s54, s43, 5
    s_add_u32 s44, s53, s54
    s_add_u32 s44, s44, s4
    s_mul_i32 s44, s44, 5120
    s_mul_i32 s53, s42, 320
    s_mul_i32 s59, s4, 160
    s_add_u32 s53, s53, s59
    s_add_u32 s45, s54, s5
    s_mul_i32 s45, s45, 40960
    s_add_u32 s45, s45, s53
    s_lshl_b32 s54, s7, 3
    s_lshl_b32 s59, s5, 1
    s_add_u32 s54, s54, s59
    s_lshl_b32 s59, s4, 2
    s_add_u32 s70, s54, s59
    s_xor_b32 s59, s59, 4
    s_add_u32 s71, s54, s59
    s_mul_i32 s70, s70, 40960
    s_add_u32 s70, s70, s53
    s_mul_i32 s71, s71, 40960
    s_add_u32 s71, s71, s53
    s_lshl_b32 s53, s4, 14
    s_add_u32 s53, s53, 131072
    s_lshl_b32 s54, s4, 16
    s_mul_i32 s59, s5, 10240
    s_add_u32 s72, s53, s59
    s_add_u32 s73, s53, 5120
    s_cmp_eq_u32 s5, 0
    s_cselect_b32 s73, s73, s54
    s_add_u32 s74, s54, s59
    s_add_u32 s74, s74, 5120
    s_lshl_b32 s46, s6, 7
    s_add_u32 s46, s46, 34603008
    s_lshl_b32 s59, s43, 5
    s_add_u32 s47, s46, s59
    s_lshl_b32 s59, s7, 3
    s_add_u32 s46, s46, s59
    s_lshl_b32 s21, s6, 2
    s_add_u32 s21, s21, s42
    s_lshl_b32 s21, s21, 5
    s_add_u32 s21, s21, 34605056
    s_lshl_b32 s59, s43, 3
    s_add_u32 s20, s21, s59
    s_mov_b32 s76, 1040356334
    s_mov_b32 s77, 1040356334
    s_mov_b32 s78, 0xffff0000
    s_mov_b32 s79, 0xffff0000
    s_mov_b32 s62, 0
    s_mov_b32 s63, 0
    s_mov_b32 s75, s60
    s_lshl1_add_u32 s59, s7, s4
    s_lshl_b32 s59, s59, 13
    s_and_b32 s59, s59, 0x1e000
    s_or_b32 s75, s60, s59
    v_lshrrev_b32 v245, 2, v255
    v_mul_u32_u24 v245, 160, v245
    v_lshl_add_u32 v243, v244, 3, v245
    v_add_u32 v249, s54, v243
    v_add_u32 v250, s53, v243
    v_mov_b32 v254, 0
    s_or_b32 s53, s3, s2
    s_cmp_lg_u32 s53, 0
    s_cbranch_scc1 K1_NOTOK
    s_or_b32 s80, s80, 1
    v_mov_b32 v188, s80
    v_mov_b32 v189, s81
    s_mov_b64 exec, 1
    global_store_dwordx2 v254, v[188:189], s[68:69] sc1
    s_mov_b64 exec, -1
K1_NOTOK:
    v_lshlrev_b32 v241, 4, v255
    v_add_u32 v242, 4096, v241
    v_add_u32 v245, 0, v255
    v_mul_u32_u24 v246, 6554, v245
    v_lshrrev_b32 v246, 16, v246
    v_mul_u32_u24 v247, 1120, v246
    v_lshl_add_u32 v220, v245, 4, v247
    v_add_u32 v245, 64, v255
    v_mul_u32_u24 v246, 6554, v245
    v_lshrrev_b32 v246, 16, v246
    v_mul_u32_u24 v247, 1120, v246
    v_lshl_add_u32 v221, v245, 4, v247
    v_subrev_u32 v221, 1024, v221
    v_add_u32 v245, 128, v255
    v_mul_u32_u24 v246, 6554, v245
    v_lshrrev_b32 v246, 16, v246
    v_mul_u32_u24 v247, 1120, v246
    v_lshl_add_u32 v222, v245, 4, v247
    v_subrev_u32 v222, 2048, v222
    v_add_u32 v245, 192, v255
    v_mul_u32_u24 v246, 6554, v245
    v_lshrrev_b32 v246, 16, v246
    v_mul_u32_u24 v247, 1120, v246
    v_lshl_add_u32 v223, v245, 4, v247
    v_subrev_u32 v223, 3072, v223
    v_add_u32 v245, 256, v255
    v_mul_u32_u24 v246, 6554, v245
    v_lshrrev_b32 v246, 16, v246
    v_mul_u32_u24 v247, 1120, v246
    v_lshl_add_u32 v224, v245, 4, v247
    s_lshl_b32 s53, s4, 16
    s_lshl_b32 s54, s5, 14
    s_add_u32 s53, s53, s54
    s_add_u32 s53, s53, 32768
    v_add_u32 v251, s53, v241
    s_lshl_b32 s53, s3, 12
    s_add_u32 s53, s53, 131072
    v_add_u32 v252, s53, v241
    v_mov_b32 v244, v206
    s_lshr_b32 s53, s2, 3
    s_lshl_b32 s53, s53, 2
    s_add_u32 s53, s53, s3
    s_mul_i32 s53, s53, 10240
    s_mul_i32 s54, s43, 1310720
    s_add_u32 s53, s53, s54
    v_lshlrev_b32 v190, 7, v255
    v_add_u32 v190, s53, v190
    v_and_b32 v191, 15, v255
    v_lshlrev_b32 v191, 7, v191
    s_add_u32 s53, s53, 8192
    v_add_u32 v191, s53, v191
    s_lshl2_add_u32 s53, s2, s3
    s_mul_i32 s53, s53, 5120
    v_min_u32 v190, 39, v255
    v_lshlrev_b32 v190, 7, v190
    v_add_u32 v190, s53, v190
    v_add_u32 v208, K1_TGO-K1_PC, v208
    v_min_u32 v212, K1_FALL-K1_PC, v208
    v_mov_b32 v213, s23
    v_add_co_u32 v212, vcc, s22, v212
    s_nop 1
    v_addc_co_u32 v213, vcc, 0, v213, vcc
    v_add_u32 v208, 0x8000, v208
    v_min_u32 v214, K1_FALL-K1_PC, v208
    v_mov_b32 v215, s23
    v_add_co_u32 v214, vcc, s22, v214
    s_nop 1
    v_addc_co_u32 v215, vcc, 0, v215, vcc
    buffer_load_dwordx4 v180, s[12:15], s56 offen offset:2048 lds
    buffer_load_dwordx4 v181, s[12:15], s56 offen offset:3072 lds
    s_add_u32 s56, s56, 0x40000
    s_cmp_ge_u32 s57, 1280
    s_cselect_b32 s56, 0, s56
    s_cselect_b32 s57, 0, s57
    s_waitcnt vmcnt(4)
    s_barrier
    ds_read_b64_tr_b16 a[0:1], v160 offset:32768
    ds_read_b64_tr_b16 a[2:3], v160 offset:34816
    ds_read_b128 a[64:67], v176 offset:0
    ds_read_b64_tr_b16 a[8:9], v161 offset:32768
    ds_read_b64_tr_b16 a[10:11], v161 offset:34816
    ds_read_b128 a[72:75], v176 offset:2048
    ds_read_b64_tr_b16 a[16:17], v162 offset:32768
    ds_read_b64_tr_b16 a[18:19], v162 offset:34816
    ds_read_b128 a[80:83], v176 offset:4096
    ds_read_b64_tr_b16 a[24:25], v163 offset:32768
    ds_read_b64_tr_b16 a[26:27], v163 offset:34816
    ds_read_b128 a[88:91], v176 offset:6144
    ds_read_b64_tr_b16 a[32:33], v164 offset:32768
    ds_read_b64_tr_b16 a[34:35], v164 offset:34816
    ds_read_b128 a[96:99], v176 offset:8192
    ds_read_b64_tr_b16 a[40:41], v165 offset:32768
    ds_read_b64_tr_b16 a[42:43], v165 offset:34816
    ds_read_b64_tr_b16 a[48:49], v166 offset:32768
    ds_read_b64_tr_b16 a[50:51], v166 offset:34816
    ds_read_b64_tr_b16 a[56:57], v167 offset:32768
    ds_read_b64_tr_b16 a[58:59], v167 offset:34816
    s_add_u32 m0, s55, 0
    s_add_u32 s67, s58, s57
    buffer_load_dwordx4 v178, s[12:15], s56 offen offset:0 lds
    buffer_load_dwordx4 v179, s[12:15], s56 offen offset:1024 lds
    buffer_load_dwordx4 v180, s[12:15], s56 offen offset:2048 lds
    buffer_load_dwordx4 v181, s[12:15], s56 offen offset:3072 lds
    s_add_u32 m0, s64, 118784
    s_add_u32 s56, s56, 0x40000
    buffer_load_dwordx4 v182, s[8:11], s67 offen offset:0 lds
    buffer_load_dwordx4 v183, s[8:11], s67 offen offset:1024 lds
    buffer_load_dwordx4 v184, s[8:11], s67 offen offset:2048 lds
    buffer_load_dwordx4 v185, s[8:11], s67 offen offset:3072 lds
    s_add_u32 m0, s64, 122880
    s_add_u32 s57, s57, 128
    buffer_load_dwordx4 v186, s[8:11], s67 offen offset:0 lds
    s_waitcnt vmcnt(9) lgkmcnt(0)
    v_mfma_f32_16x16x32_bf16 v[0:3], a[0:3], a[64:67], 0
    s_barrier
    ds_read_b64_tr_b16 a[4:5], v160 offset:49152
    v_mfma_f32_16x16x32_bf16 v[32:35], a[0:3], a[72:75], 0
    ds_read_b64_tr_b16 a[6:7], v160 offset:51200
    v_mfma_f32_16x16x32_bf16 v[64:67], a[0:3], a[80:83], 0
    ds_read_b128 a[68:71], v177 offset:0
    s_add_u32 m0, s55, 65536
    s_nop 0
    buffer_load_dwordx4 v178, s[12:15], s56 offen offset:0 lds
    v_mfma_f32_16x16x32_bf16 v[96:99], a[0:3], a[88:91], 0
    v_mfma_f32_16x16x32_bf16 v[128:131], a[0:3], a[96:99], 0
    ds_read_b64_tr_b16 a[12:13], v161 offset:49152
    v_mfma_f32_16x16x32_bf16 v[4:7], a[8:11], a[64:67], 0
    ds_read_b64_tr_b16 a[14:15], v161 offset:51200
    buffer_load_dwordx4 v179, s[12:15], s56 offen offset:1024 lds
    v_mfma_f32_16x16x32_bf16 v[36:39], a[8:11], a[72:75], 0
    v_mfma_f32_16x16x32_bf16 v[68:71], a[8:11], a[80:83], 0
    ds_read_b128 a[76:79], v177 offset:2048
    v_mfma_f32_16x16x32_bf16 v[100:103], a[8:11], a[88:91], 0
    ds_read_b64_tr_b16 a[20:21], v162 offset:49152
    v_mfma_f32_16x16x32_bf16 v[132:135], a[8:11], a[96:99], 0
    buffer_load_dwordx4 v180, s[12:15], s56 offen offset:2048 lds
    v_mfma_f32_16x16x32_bf16 v[8:11], a[16:19], a[64:67], 0
    ds_read_b64_tr_b16 a[22:23], v162 offset:51200
    v_mfma_f32_16x16x32_bf16 v[40:43], a[16:19], a[72:75], 0
    ds_read_b128 a[84:87], v177 offset:4096
    v_mfma_f32_16x16x32_bf16 v[72:75], a[16:19], a[80:83], 0
    ds_read_b64_tr_b16 a[28:29], v163 offset:49152
    v_mfma_f32_16x16x32_bf16 v[104:107], a[16:19], a[88:91], 0
    buffer_load_dwordx4 v181, s[12:15], s56 offen offset:3072 lds
    s_add_u32 s56, s56, 0x40000
    s_cmp_ge_u32 s57, 1280
    s_cselect_b32 s56, 0, s56
    s_cselect_b32 s57, 0, s57
    v_mfma_f32_16x16x32_bf16 v[136:139], a[16:19], a[96:99], 0
    ds_read_b64_tr_b16 a[30:31], v163 offset:51200
    v_mfma_f32_16x16x32_bf16 v[12:15], a[24:27], a[64:67], 0
    ds_read_b128 a[92:95], v177 offset:6144
    v_mfma_f32_16x16x32_bf16 v[44:47], a[24:27], a[72:75], 0
    s_add_u32 m0, s55, 16384
    s_add_u32 s67, s58, s57
    buffer_load_dwordx4 v178, s[12:15], s56 offen offset:0 lds
    v_mfma_f32_16x16x32_bf16 v[76:79], a[24:27], a[80:83], 0
    ds_read_b64_tr_b16 a[36:37], v164 offset:49152
    v_mfma_f32_16x16x32_bf16 v[108:111], a[24:27], a[88:91], 0
    ds_read_b64_tr_b16 a[38:39], v164 offset:51200
    v_mfma_f32_16x16x32_bf16 v[140:143], a[24:27], a[96:99], 0
    v_mfma_f32_16x16x32_bf16 v[16:19], a[32:35], a[64:67], 0
    ds_read_b128 a[100:103], v177 offset:8192
    buffer_load_dwordx4 v179, s[12:15], s56 offen offset:1024 lds
    v_mfma_f32_16x16x32_bf16 v[48:51], a[32:35], a[72:75], 0
    ds_read_b64_tr_b16 a[44:45], v165 offset:49152
    v_mfma_f32_16x16x32_bf16 v[80:83], a[32:35], a[80:83], 0
    ds_read_b64_tr_b16 a[46:47], v165 offset:51200
    v_mfma_f32_16x16x32_bf16 v[112:115], a[32:35], a[88:91], 0
    v_mfma_f32_16x16x32_bf16 v[144:147], a[32:35], a[96:99], 0
    ds_read_b64_tr_b16 a[52:53], v166 offset:49152
    buffer_load_dwordx4 v180, s[12:15], s56 offen offset:2048 lds
    v_mfma_f32_16x16x32_bf16 v[20:23], a[40:43], a[64:67], 0
    ds_read_b64_tr_b16 a[54:55], v166 offset:51200
    v_mfma_f32_16x16x32_bf16 v[52:55], a[40:43], a[72:75], 0
    v_mfma_f32_16x16x32_bf16 v[84:87], a[40:43], a[80:83], 0
    ds_read_b64_tr_b16 a[60:61], v167 offset:49152
    buffer_load_dwordx4 v181, s[12:15], s56 offen offset:3072 lds
    v_mfma_f32_16x16x32_bf16 v[116:119], a[40:43], a[88:91], 0
    ds_read_b64_tr_b16 a[62:63], v167 offset:51200
    v_mfma_f32_16x16x32_bf16 v[148:151], a[40:43], a[96:99], 0
    v_mfma_f32_16x16x32_bf16 v[24:27], a[48:51], a[64:67], 0
    v_mfma_f32_16x16x32_bf16 v[56:59], a[48:51], a[72:75], 0
    s_add_u32 m0, s64, 139264
    s_add_u32 s56, s56, 0x40000
    buffer_load_dwordx4 v182, s[8:11], s67 offen offset:0 lds
    v_mfma_f32_16x16x32_bf16 v[88:91], a[48:51], a[80:83], 0
    v_mfma_f32_16x16x32_bf16 v[120:123], a[48:51], a[88:91], 0
    v_mfma_f32_16x16x32_bf16 v[152:155], a[48:51], a[96:99], 0
    v_mfma_f32_16x16x32_bf16 v[28:31], a[56:59], a[64:67], 0
    buffer_load_dwordx4 v183, s[8:11], s67 offen offset:1024 lds
    v_mfma_f32_16x16x32_bf16 v[60:63], a[56:59], a[72:75], 0
    v_mfma_f32_16x16x32_bf16 v[92:95], a[56:59], a[80:83], 0
    v_mfma_f32_16x16x32_bf16 v[124:127], a[56:59], a[88:91], 0
    v_mfma_f32_16x16x32_bf16 v[156:159], a[56:59], a[96:99], 0
    s_waitcnt vmcnt(10) lgkmcnt(0)
    v_mfma_f32_16x16x32_bf16 v[0:3], a[4:7], a[68:71], v[0:3]
    s_barrier
    ds_read_b64_tr_b16 a[144:145], v160 offset:0
    v_mfma_f32_16x16x32_bf16 v[32:35], a[4:7], a[76:79], v[32:35]
    ds_read_b64_tr_b16 a[146:147], v160 offset:2048
    v_mfma_f32_16x16x32_bf16 v[64:67], a[4:7], a[84:87], v[64:67]
    ds_read_b128 a[208:211], v176 offset:20480
    buffer_load_dwordx4 v184, s[8:11], s67 offen offset:2048 lds
    v_mfma_f32_16x16x32_bf16 v[96:99], a[4:7], a[92:95], v[96:99]
    v_mfma_f32_16x16x32_bf16 v[128:131], a[4:7], a[100:103], v[128:131]
    ds_read_b64_tr_b16 a[152:153], v161 offset:0
    v_mfma_f32_16x16x32_bf16 v[4:7], a[12:15], a[68:71], v[4:7]
    ds_read_b64_tr_b16 a[154:155], v161 offset:2048
    buffer_load_dwordx4 v185, s[8:11], s67 offen offset:3072 lds
    v_mfma_f32_16x16x32_bf16 v[36:39], a[12:15], a[76:79], v[36:39]
    v_mfma_f32_16x16x32_bf16 v[68:71], a[12:15], a[84:87], v[68:71]
    ds_read_b128 a[216:219], v176 offset:22528
    v_mfma_f32_16x16x32_bf16 v[100:103], a[12:15], a[92:95], v[100:103]
    ds_read_b64_tr_b16 a[160:161], v162 offset:0
    v_mfma_f32_16x16x32_bf16 v[132:135], a[12:15], a[100:103], v[132:135]
    s_add_u32 m0, s64, 143360
    s_add_u32 s57, s57, 128
    buffer_load_dwordx4 v186, s[8:11], s67 offen offset:0 lds
    v_mfma_f32_16x16x32_bf16 v[8:11], a[20:23], a[68:71], v[8:11]
    ds_read_b64_tr_b16 a[162:163], v162 offset:2048
    v_mfma_f32_16x16x32_bf16 v[40:43], a[20:23], a[76:79], v[40:43]
    ds_read_b128 a[224:227], v176 offset:24576
    v_mfma_f32_16x16x32_bf16 v[72:75], a[20:23], a[84:87], v[72:75]
    ds_read_b64_tr_b16 a[168:169], v163 offset:0
    v_mfma_f32_16x16x32_bf16 v[104:107], a[20:23], a[92:95], v[104:107]
    s_add_u32 m0, s55, 81920
    s_nop 0
    buffer_load_dwordx4 v178, s[12:15], s56 offen offset:0 lds
    v_mfma_f32_16x16x32_bf16 v[136:139], a[20:23], a[100:103], v[136:139]
    ds_read_b64_tr_b16 a[170:171], v163 offset:2048
    v_mfma_f32_16x16x32_bf16 v[12:15], a[28:31], a[68:71], v[12:15]
    ds_read_b128 a[232:235], v176 offset:26624
    v_mfma_f32_16x16x32_bf16 v[44:47], a[28:31], a[76:79], v[44:47]
    buffer_load_dwordx4 v179, s[12:15], s56 offen offset:1024 lds
    v_mfma_f32_16x16x32_bf16 v[76:79], a[28:31], a[84:87], v[76:79]
    ds_read_b64_tr_b16 a[176:177], v164 offset:0
    v_mfma_f32_16x16x32_bf16 v[108:111], a[28:31], a[92:95], v[108:111]
    ds_read_b64_tr_b16 a[178:179], v164 offset:2048
    v_mfma_f32_16x16x32_bf16 v[140:143], a[28:31], a[100:103], v[140:143]
    v_mfma_f32_16x16x32_bf16 v[16:19], a[36:39], a[68:71], v[16:19]
    ds_read_b128 a[240:243], v176 offset:28672
    buffer_load_dwordx4 v180, s[12:15], s56 offen offset:2048 lds
    v_mfma_f32_16x16x32_bf16 v[48:51], a[36:39], a[76:79], v[48:51]
    ds_read_b64_tr_b16 a[184:185], v165 offset:0
    v_mfma_f32_16x16x32_bf16 v[80:83], a[36:39], a[84:87], v[80:83]
    ds_read_b64_tr_b16 a[186:187], v165 offset:2048
    v_mfma_f32_16x16x32_bf16 v[112:115], a[36:39], a[92:95], v[112:115]
    v_mfma_f32_16x16x32_bf16 v[144:147], a[36:39], a[100:103], v[144:147]
    ds_read_b64_tr_b16 a[192:193], v166 offset:0
    buffer_load_dwordx4 v181, s[12:15], s56 offen offset:3072 lds
    s_add_u32 s56, s56, 0x40000
    s_cmp_ge_u32 s57, 1280
    s_cselect_b32 s56, 0, s56
    s_cselect_b32 s57, 0, s57
    v_mfma_f32_16x16x32_bf16 v[20:23], a[44:47], a[68:71], v[20:23]
    ds_read_b64_tr_b16 a[194:195], v166 offset:2048
    v_mfma_f32_16x16x32_bf16 v[52:55], a[44:47], a[76:79], v[52:55]
    v_mfma_f32_16x16x32_bf16 v[84:87], a[44:47], a[84:87], v[84:87]
    ds_read_b64_tr_b16 a[200:201], v167 offset:0
    s_add_u32 m0, s55, 32768
    s_add_u32 s67, s58, s57
    buffer_load_dwordx4 v178, s[12:15], s56 offen offset:0 lds
    v_mfma_f32_16x16x32_bf16 v[116:119], a[44:47], a[92:95], v[116:119]
    ds_read_b64_tr_b16 a[202:203], v167 offset:2048
    v_mfma_f32_16x16x32_bf16 v[148:151], a[44:47], a[100:103], v[148:151]
    v_mfma_f32_16x16x32_bf16 v[24:27], a[52:55], a[68:71], v[24:27]
    v_mfma_f32_16x16x32_bf16 v[56:59], a[52:55], a[76:79], v[56:59]
    buffer_load_dwordx4 v179, s[12:15], s56 offen offset:1024 lds
    v_mfma_f32_16x16x32_bf16 v[88:91], a[52:55], a[84:87], v[88:91]
    v_mfma_f32_16x16x32_bf16 v[120:123], a[52:55], a[92:95], v[120:123]
    v_mfma_f32_16x16x32_bf16 v[152:155], a[52:55], a[100:103], v[152:155]
    v_mfma_f32_16x16x32_bf16 v[28:31], a[60:63], a[68:71], v[28:31]
    buffer_load_dwordx4 v180, s[12:15], s56 offen offset:2048 lds
    v_mfma_f32_16x16x32_bf16 v[60:63], a[60:63], a[76:79], v[60:63]
    v_mfma_f32_16x16x32_bf16 v[92:95], a[60:63], a[84:87], v[92:95]
    v_mfma_f32_16x16x32_bf16 v[124:127], a[60:63], a[92:95], v[124:127]
    v_mfma_f32_16x16x32_bf16 v[156:159], a[60:63], a[100:103], v[156:159]
    s_waitcnt vmcnt(16) lgkmcnt(0)
    v_mfma_f32_16x16x32_bf16 v[0:3], a[144:147], a[208:211], v[0:3]
    s_barrier
    ds_read_b64_tr_b16 a[148:149], v168 offset:0
    v_mfma_f32_16x16x32_bf16 v[32:35], a[144:147], a[216:219], v[32:35]
    ds_read_b64_tr_b16 a[150:151], v168 offset:2048
    v_mfma_f32_16x16x32_bf16 v[64:67], a[144:147], a[224:227], v[64:67]
    ds_read_b128 a[212:215], v177 offset:20480
    buffer_load_dwordx4 v181, s[12:15], s56 offen offset:3072 lds
    v_mfma_f32_16x16x32_bf16 v[96:99], a[144:147], a[232:235], v[96:99]
    v_mfma_f32_16x16x32_bf16 v[128:131], a[144:147], a[240:243], v[128:131]
    ds_read_b64_tr_b16 a[156:157], v169 offset:0
    v_mfma_f32_16x16x32_bf16 v[4:7], a[152:155], a[208:211], v[4:7]
    ds_read_b64_tr_b16 a[158:159], v169 offset:2048
    s_add_u32 m0, s64, 98304
    s_add_u32 s56, s56, 0x40000
    buffer_load_dwordx4 v182, s[8:11], s67 offen offset:0 lds
    v_mfma_f32_16x16x32_bf16 v[36:39], a[152:155], a[216:219], v[36:39]
    v_mfma_f32_16x16x32_bf16 v[68:71], a[152:155], a[224:227], v[68:71]
    ds_read_b128 a[220:223], v177 offset:22528
    v_mfma_f32_16x16x32_bf16 v[100:103], a[152:155], a[232:235], v[100:103]
    ds_read_b64_tr_b16 a[164:165], v170 offset:0
    v_mfma_f32_16x16x32_bf16 v[132:135], a[152:155], a[240:243], v[132:135]
    buffer_load_dwordx4 v183, s[8:11], s67 offen offset:1024 lds
    v_mfma_f32_16x16x32_bf16 v[8:11], a[160:163], a[208:211], v[8:11]
    ds_read_b64_tr_b16 a[166:167], v170 offset:2048
    v_mfma_f32_16x16x32_bf16 v[40:43], a[160:163], a[216:219], v[40:43]
    ds_read_b128 a[228:231], v177 offset:24576
    v_mfma_f32_16x16x32_bf16 v[72:75], a[160:163], a[224:227], v[72:75]
    ds_read_b64_tr_b16 a[172:173], v171 offset:0
    v_mfma_f32_16x16x32_bf16 v[104:107], a[160:163], a[232:235], v[104:107]
    buffer_load_dwordx4 v184, s[8:11], s67 offen offset:2048 lds
    v_mfma_f32_16x16x32_bf16 v[136:139], a[160:163], a[240:243], v[136:139]
    ds_read_b64_tr_b16 a[174:175], v171 offset:2048
    v_mfma_f32_16x16x32_bf16 v[12:15], a[168:171], a[208:211], v[12:15]
    ds_read_b128 a[236:239], v177 offset:26624
    v_mfma_f32_16x16x32_bf16 v[44:47], a[168:171], a[216:219], v[44:47]
    buffer_load_dwordx4 v185, s[8:11], s67 offen offset:3072 lds
    v_mfma_f32_16x16x32_bf16 v[76:79], a[168:171], a[224:227], v[76:79]
    ds_read_b64_tr_b16 a[180:181], v172 offset:0
    v_mfma_f32_16x16x32_bf16 v[108:111], a[168:171], a[232:235], v[108:111]
    ds_read_b64_tr_b16 a[182:183], v172 offset:2048
    v_mfma_f32_16x16x32_bf16 v[140:143], a[168:171], a[240:243], v[140:143]
    v_mfma_f32_16x16x32_bf16 v[16:19], a[176:179], a[208:211], v[16:19]
    ds_read_b128 a[244:247], v177 offset:28672
    s_add_u32 m0, s64, 102400
    s_add_u32 s57, s57, 128
    buffer_load_dwordx4 v186, s[8:11], s67 offen offset:0 lds
    v_mfma_f32_16x16x32_bf16 v[48:51], a[176:179], a[216:219], v[48:51]
    ds_read_b64_tr_b16 a[188:189], v173 offset:0
    v_mfma_f32_16x16x32_bf16 v[80:83], a[176:179], a[224:227], v[80:83]
    ds_read_b64_tr_b16 a[190:191], v173 offset:2048
    v_mfma_f32_16x16x32_bf16 v[112:115], a[176:179], a[232:235], v[112:115]
    v_mfma_f32_16x16x32_bf16 v[144:147], a[176:179], a[240:243], v[144:147]
    ds_read_b64_tr_b16 a[196:197], v174 offset:0
    s_add_u32 m0, s55, 49152
    s_nop 0
    buffer_load_dwordx4 v178, s[12:15], s56 offen offset:0 lds
    v_mfma_f32_16x16x32_bf16 v[20:23], a[184:187], a[208:211], v[20:23]
    ds_read_b64_tr_b16 a[198:199], v174 offset:2048
    v_mfma_f32_16x16x32_bf16 v[52:55], a[184:187], a[216:219], v[52:55]
    v_mfma_f32_16x16x32_bf16 v[84:87], a[184:187], a[224:227], v[84:87]
    ds_read_b64_tr_b16 a[204:205], v175 offset:0
    buffer_load_dwordx4 v179, s[12:15], s56 offen offset:1024 lds
    v_mfma_f32_16x16x32_bf16 v[116:119], a[184:187], a[232:235], v[116:119]
    ds_read_b64_tr_b16 a[206:207], v175 offset:2048
    v_mfma_f32_16x16x32_bf16 v[148:151], a[184:187], a[240:243], v[148:151]
    v_mfma_f32_16x16x32_bf16 v[24:27], a[192:195], a[208:211], v[24:27]
    v_mfma_f32_16x16x32_bf16 v[56:59], a[192:195], a[216:219], v[56:59]
    buffer_load_dwordx4 v180, s[12:15], s56 offen offset:2048 lds
    v_mfma_f32_16x16x32_bf16 v[88:91], a[192:195], a[224:227], v[88:91]
    v_mfma_f32_16x16x32_bf16 v[120:123], a[192:195], a[232:235], v[120:123]
    v_mfma_f32_16x16x32_bf16 v[152:155], a[192:195], a[240:243], v[152:155]
    v_mfma_f32_16x16x32_bf16 v[28:31], a[200:203], a[208:211], v[28:31]
    buffer_load_dwordx4 v181, s[12:15], s56 offen offset:3072 lds
    s_add_u32 s56, s56, 0x40000
    s_cmp_ge_u32 s57, 1280
    s_cselect_b32 s56, 0, s56
    s_cselect_b32 s57, 0, s57
    v_mfma_f32_16x16x32_bf16 v[60:63], a[200:203], a[216:219], v[60:63]
    v_mfma_f32_16x16x32_bf16 v[92:95], a[200:203], a[224:227], v[92:95]
    v_mfma_f32_16x16x32_bf16 v[124:127], a[200:203], a[232:235], v[124:127]
    v_mfma_f32_16x16x32_bf16 v[156:159], a[200:203], a[240:243], v[156:159]
    s_waitcnt vmcnt(13) lgkmcnt(0)
    v_mfma_f32_16x16x32_bf16 v[0:3], a[148:151], a[212:215], v[0:3]
    s_barrier
    ds_read_b64_tr_b16 a[0:1], v160 offset:16384
    ds_read_b64_tr_b16 a[2:3], v160 offset:18432
    v_mfma_f32_16x16x32_bf16 v[32:35], a[148:151], a[220:223], v[32:35]
    ds_read_b128 a[64:67], v176 offset:40960
    v_mfma_f32_16x16x32_bf16 v[64:67], a[148:151], a[228:231], v[64:67]
    ds_read_b64_tr_b16 a[8:9], v161 offset:16384
    s_add_u32 m0, s55, 0
    s_add_u32 s67, s58, s57
    buffer_load_dwordx4 v178, s[12:15], s56 offen offset:0 lds
    v_mfma_f32_16x16x32_bf16 v[96:99], a[148:151], a[236:239], v[96:99]
    ds_read_b64_tr_b16 a[10:11], v161 offset:18432
    v_mfma_f32_16x16x32_bf16 v[128:131], a[148:151], a[244:247], v[128:131]
    ds_read_b128 a[72:75], v176 offset:43008
    v_mfma_f32_16x16x32_bf16 v[4:7], a[156:159], a[212:215], v[4:7]
    ds_read_b64_tr_b16 a[16:17], v162 offset:16384
    buffer_load_dwordx4 v179, s[12:15], s56 offen offset:1024 lds
    v_mfma_f32_16x16x32_bf16 v[36:39], a[156:159], a[220:223], v[36:39]
    ds_read_b64_tr_b16 a[18:19], v162 offset:18432
    ds_read_b128 a[80:83], v176 offset:45056
    v_mfma_f32_16x16x32_bf16 v[68:71], a[156:159], a[228:231], v[68:71]
    ds_read_b64_tr_b16 a[24:25], v163 offset:16384
    v_mfma_f32_16x16x32_bf16 v[100:103], a[156:159], a[236:239], v[100:103]
    ds_read_b64_tr_b16 a[26:27], v163 offset:18432
    v_mfma_f32_16x16x32_bf16 v[132:135], a[156:159], a[244:247], v[132:135]
    ds_read_b128 a[88:91], v176 offset:47104
    buffer_load_dwordx4 v180, s[12:15], s56 offen offset:2048 lds
    v_mfma_f32_16x16x32_bf16 v[8:11], a[164:167], a[212:215], v[8:11]
    ds_read_b64_tr_b16 a[32:33], v164 offset:16384
    v_mfma_f32_16x16x32_bf16 v[40:43], a[164:167], a[220:223], v[40:43]
    ds_read_b64_tr_b16 a[34:35], v164 offset:18432
    v_mfma_f32_16x16x32_bf16 v[72:75], a[164:167], a[228:231], v[72:75]
    ds_read_b128 a[96:99], v176 offset:49152
    ds_read_b64_tr_b16 a[40:41], v165 offset:16384
    v_mfma_f32_16x16x32_bf16 v[104:107], a[164:167], a[236:239], v[104:107]
    ds_read_b64_tr_b16 a[42:43], v165 offset:18432
    buffer_load_dwordx4 v181, s[12:15], s56 offen offset:3072 lds
    v_mfma_f32_16x16x32_bf16 v[136:139], a[164:167], a[244:247], v[136:139]
    ds_read_b64_tr_b16 a[48:49], v166 offset:16384
    v_mfma_f32_16x16x32_bf16 v[12:15], a[172:175], a[212:215], v[12:15]
    ds_read_b64_tr_b16 a[50:51], v166 offset:18432
    v_mfma_f32_16x16x32_bf16 v[44:47], a[172:175], a[220:223], v[44:47]
    ds_read_b64_tr_b16 a[56:57], v167 offset:16384
    s_add_u32 m0, s64, 118784
    s_add_u32 s56, s56, 0x40000
    buffer_load_dwordx4 v182, s[8:11], s67 offen offset:0 lds
    v_mfma_f32_16x16x32_bf16 v[76:79], a[172:175], a[228:231], v[76:79]
    ds_read_b64_tr_b16 a[58:59], v167 offset:18432
    v_mfma_f32_16x16x32_bf16 v[108:111], a[172:175], a[236:239], v[108:111]
    ds_read_b64_tr_b16 a[4:5], v168 offset:16384
    ds_read_b64_tr_b16 a[6:7], v168 offset:18432
    v_mfma_f32_16x16x32_bf16 v[140:143], a[172:175], a[244:247], v[140:143]
    ds_read_b128 a[68:71], v177 offset:40960
    v_mfma_f32_16x16x32_bf16 v[16:19], a[180:183], a[212:215], v[16:19]
    ds_read_b64_tr_b16 a[12:13], v169 offset:16384
    buffer_load_dwordx4 v183, s[8:11], s67 offen offset:1024 lds
    v_mfma_f32_16x16x32_bf16 v[48:51], a[180:183], a[220:223], v[48:51]
    ds_read_b64_tr_b16 a[14:15], v169 offset:18432
    v_mfma_f32_16x16x32_bf16 v[80:83], a[180:183], a[228:231], v[80:83]
    ds_read_b128 a[76:79], v177 offset:43008
    v_mfma_f32_16x16x32_bf16 v[112:115], a[180:183], a[236:239], v[112:115]
    ds_read_b64_tr_b16 a[20:21], v170 offset:16384
    v_mfma_f32_16x16x32_bf16 v[144:147], a[180:183], a[244:247], v[144:147]
    ds_read_b64_tr_b16 a[22:23], v170 offset:18432
    ds_read_b128 a[84:87], v177 offset:45056
    buffer_load_dwordx4 v184, s[8:11], s67 offen offset:2048 lds
    v_mfma_f32_16x16x32_bf16 v[20:23], a[188:191], a[212:215], v[20:23]
    ds_read_b64_tr_b16 a[28:29], v171 offset:16384
    v_mfma_f32_16x16x32_bf16 v[52:55], a[188:191], a[220:223], v[52:55]
    ds_read_b64_tr_b16 a[30:31], v171 offset:18432
    v_mfma_f32_16x16x32_bf16 v[84:87], a[188:191], a[228:231], v[84:87]
    ds_read_b128 a[92:95], v177 offset:47104
    buffer_load_dwordx4 v185, s[8:11], s67 offen offset:3072 lds
    v_mfma_f32_16x16x32_bf16 v[116:119], a[188:191], a[236:239], v[116:119]
    ds_read_b64_tr_b16 a[36:37], v172 offset:16384
    v_mfma_f32_16x16x32_bf16 v[148:151], a[188:191], a[244:247], v[148:151]
    ds_read_b64_tr_b16 a[38:39], v172 offset:18432
    v_mfma_f32_16x16x32_bf16 v[24:27], a[196:199], a[212:215], v[24:27]
    ds_read_b128 a[100:103], v177 offset:49152
    ds_read_b64_tr_b16 a[44:45], v173 offset:16384
    v_mfma_f32_16x16x32_bf16 v[56:59], a[196:199], a[220:223], v[56:59]
    ds_read_b64_tr_b16 a[46:47], v173 offset:18432
    s_add_u32 m0, s64, 122880
    s_add_u32 s57, s57, 128
    buffer_load_dwordx4 v186, s[8:11], s67 offen offset:0 lds
    v_mfma_f32_16x16x32_bf16 v[88:91], a[196:199], a[228:231], v[88:91]
    ds_read_b64_tr_b16 a[52:53], v174 offset:16384
    v_mfma_f32_16x16x32_bf16 v[120:123], a[196:199], a[236:239], v[120:123]
    ds_read_b64_tr_b16 a[54:55], v174 offset:18432
    v_mfma_f32_16x16x32_bf16 v[152:155], a[196:199], a[244:247], v[152:155]
    ds_read_b64_tr_b16 a[60:61], v175 offset:16384
    v_mfma_f32_16x16x32_bf16 v[28:31], a[204:207], a[212:215], v[28:31]
    ds_read_b64_tr_b16 a[62:63], v175 offset:18432
    s_add_u32 m0, s55, 65536
    s_nop 0
    buffer_load_dwordx4 v178, s[12:15], s56 offen offset:0 lds
    v_mfma_f32_16x16x32_bf16 v[60:63], a[204:207], a[220:223], v[60:63]
    v_mfma_f32_16x16x32_bf16 v[92:95], a[204:207], a[228:231], v[92:95]
    v_mfma_f32_16x16x32_bf16 v[124:127], a[204:207], a[236:239], v[124:127]
    v_mfma_f32_16x16x32_bf16 v[156:159], a[204:207], a[244:247], v[156:159]
    s_waitcnt vmcnt(10) lgkmcnt(0)
    v_mfma_f32_16x16x32_bf16 v[0:3], a[0:3], a[64:67], v[0:3]
    s_barrier
    ds_read_b64_tr_b16 a[144:145], v160 offset:32768
    v_mfma_f32_16x16x32_bf16 v[0:3], a[4:7], a[68:71], v[0:3]
    ds_read_b64_tr_b16 a[146:147], v160 offset:34816
    v_mfma_f32_16x16x32_bf16 v[32:35], a[0:3], a[72:75], v[32:35]
    buffer_load_dwordx4 v179, s[12:15], s56 offen offset:1024 lds
    v_mfma_f32_16x16x32_bf16 v[32:35], a[4:7], a[76:79], v[32:35]
    ds_read_b128 a[208:211], v176 offset:0
    v_mfma_f32_16x16x32_bf16 v[64:67], a[0:3], a[80:83], v[64:67]
    ds_read_b64_tr_b16 a[152:153], v161 offset:32768
    v_mfma_f32_16x16x32_bf16 v[64:67], a[4:7], a[84:87], v[64:67]
    v_mfma_f32_16x16x32_bf16 v[96:99], a[0:3], a[88:91], v[96:99]
    ds_read_b64_tr_b16 a[154:155], v161 offset:34816
    buffer_load_dwordx4 v180, s[12:15], s56 offen offset:2048 lds
    v_mfma_f32_16x16x32_bf16 v[96:99], a[4:7], a[92:95], v[96:99]
    ds_read_b128 a[216:219], v176 offset:2048
    v_mfma_f32_16x16x32_bf16 v[128:131], a[0:3], a[96:99], v[128:131]
    v_mfma_f32_16x16x32_bf16 v[128:131], a[4:7], a[100:103], v[128:131]
    ds_read_b64_tr_b16 a[160:161], v162 offset:32768
    v_mfma_f32_16x16x32_bf16 v[4:7], a[8:11], a[64:67], v[4:7]
    v_mfma_f32_16x16x32_bf16 v[4:7], a[12:15], a[68:71], v[4:7]
    ds_read_b64_tr_b16 a[162:163], v162 offset:34816
    buffer_load_dwordx4 v181, s[12:15], s56 offen offset:3072 lds
    s_add_u32 s56, s56, 0x40000
    s_cmp_ge_u32 s57, 1280
    s_cselect_b32 s56, 0, s56
    s_cselect_b32 s57, 0, s57
    v_mfma_f32_16x16x32_bf16 v[36:39], a[8:11], a[72:75], v[36:39]
    ds_read_b128 a[224:227], v176 offset:4096
    v_mfma_f32_16x16x32_bf16 v[36:39], a[12:15], a[76:79], v[36:39]
    v_mfma_f32_16x16x32_bf16 v[68:71], a[8:11], a[80:83], v[68:71]
    ds_read_b64_tr_b16 a[168:169], v163 offset:32768
    v_mfma_f32_16x16x32_bf16 v[68:71], a[12:15], a[84:87], v[68:71]
    ds_read_b64_tr_b16 a[170:171], v163 offset:34816
    v_mfma_f32_16x16x32_bf16 v[100:103], a[8:11], a[88:91], v[100:103]
    s_add_u32 m0, s55, 16384
    s_add_u32 s67, s58, s57
    buffer_load_dwordx4 v178, s[12:15], s56 offen offset:0 lds
    v_mfma_f32_16x16x32_bf16 v[100:103], a[12:15], a[92:95], v[100:103]
    ds_read_b128 a[232:235], v176 offset:6144
    v_mfma_f32_16x16x32_bf16 v[132:135], a[8:11], a[96:99], v[132:135]
    v_mfma_f32_16x16x32_bf16 v[132:135], a[12:15], a[100:103], v[132:135]
    ds_read_b64_tr_b16 a[176:177], v164 offset:32768
    v_mfma_f32_16x16x32_bf16 v[8:11], a[16:19], a[64:67], v[8:11]
    ds_read_b64_tr_b16 a[178:179], v164 offset:34816
    v_mfma_f32_16x16x32_bf16 v[8:11], a[20:23], a[68:71], v[8:11]
    buffer_load_dwordx4 v179, s[12:15], s56 offen offset:1024 lds
    v_mfma_f32_16x16x32_bf16 v[40:43], a[16:19], a[72:75], v[40:43]
    ds_read_b128 a[240:243], v176 offset:8192
    v_mfma_f32_16x16x32_bf16 v[40:43], a[20:23], a[76:79], v[40:43]
    ds_read_b64_tr_b16 a[184:185], v165 offset:32768
    v_mfma_f32_16x16x32_bf16 v[72:75], a[16:19], a[80:83], v[72:75]
    v_mfma_f32_16x16x32_bf16 v[72:75], a[20:23], a[84:87], v[72:75]
    ds_read_b64_tr_b16 a[186:187], v165 offset:34816
    buffer_load_dwordx4 v180, s[12:15], s56 offen offset:2048 lds
    v_mfma_f32_16x16x32_bf16 v[104:107], a[16:19], a[88:91], v[104:107]
    v_mfma_f32_16x16x32_bf16 v[104:107], a[20:23], a[92:95], v[104:107]
    ds_read_b64_tr_b16 a[192:193], v166 offset:32768
    v_mfma_f32_16x16x32_bf16 v[136:139], a[16:19], a[96:99], v[136:139]
    ds_read_b64_tr_b16 a[194:195], v166 offset:34816
    v_mfma_f32_16x16x32_bf16 v[136:139], a[20:23], a[100:103], v[136:139]
    v_mfma_f32_16x16x32_bf16 v[12:15], a[24:27], a[64:67], v[12:15]
    ds_read_b64_tr_b16 a[200:201], v167 offset:32768
    buffer_load_dwordx4 v181, s[12:15], s56 offen offset:3072 lds
    v_mfma_f32_16x16x32_bf16 v[12:15], a[28:31], a[68:71], v[12:15]
    ds_read_b64_tr_b16 a[202:203], v167 offset:34816
    v_mfma_f32_16x16x32_bf16 v[44:47], a[24:27], a[72:75], v[44:47]
    v_mfma_f32_16x16x32_bf16 v[44:47], a[28:31], a[76:79], v[44:47]
    ds_read_b64_tr_b16 a[148:149], v160 offset:49152
    v_mfma_f32_16x16x32_bf16 v[76:79], a[24:27], a[80:83], v[76:79]
    v_mfma_f32_16x16x32_bf16 v[76:79], a[28:31], a[84:87], v[76:79]
    ds_read_b64_tr_b16 a[150:151], v160 offset:51200
    s_add_u32 m0, s64, 139264
    s_add_u32 s56, s56, 0x40000
    buffer_load_dwordx4 v182, s[8:11], s67 offen offset:0 lds
    v_mfma_f32_16x16x32_bf16 v[108:111], a[24:27], a[88:91], v[108:111]
    ds_read_b128 a[212:215], v177 offset:0
    v_mfma_f32_16x16x32_bf16 v[108:111], a[28:31], a[92:95], v[108:111]
    v_mfma_f32_16x16x32_bf16 v[140:143], a[24:27], a[96:99], v[140:143]
    ds_read_b64_tr_b16 a[156:157], v161 offset:49152
    v_mfma_f32_16x16x32_bf16 v[140:143], a[28:31], a[100:103], v[140:143]
    ds_read_b64_tr_b16 a[158:159], v161 offset:51200
    v_mfma_f32_16x16x32_bf16 v[16:19], a[32:35], a[64:67], v[16:19]
    buffer_load_dwordx4 v183, s[8:11], s67 offen offset:1024 lds
    v_mfma_f32_16x16x32_bf16 v[16:19], a[36:39], a[68:71], v[16:19]
    ds_read_b128 a[220:223], v177 offset:2048
    v_mfma_f32_16x16x32_bf16 v[48:51], a[32:35], a[72:75], v[48:51]
    v_mfma_f32_16x16x32_bf16 v[48:51], a[36:39], a[76:79], v[48:51]
    ds_read_b64_tr_b16 a[164:165], v162 offset:49152
    v_mfma_f32_16x16x32_bf16 v[80:83], a[32:35], a[80:83], v[80:83]
    ds_read_b64_tr_b16 a[166:167], v162 offset:51200
    buffer_load_dwordx4 v184, s[8:11], s67 offen offset:2048 lds
    v_mfma_f32_16x16x32_bf16 v[80:83], a[36:39], a[84:87], v[80:83]
    v_mfma_f32_16x16x32_bf16 v[112:115], a[32:35], a[88:91], v[112:115]
    ds_read_b128 a[228:231], v177 offset:4096
    v_mfma_f32_16x16x32_bf16 v[112:115], a[36:39], a[92:95], v[112:115]
    ds_read_b64_tr_b16 a[172:173], v163 offset:49152
    v_mfma_f32_16x16x32_bf16 v[144:147], a[32:35], a[96:99], v[144:147]
    v_mfma_f32_16x16x32_bf16 v[144:147], a[36:39], a[100:103], v[144:147]
    ds_read_b64_tr_b16 a[174:175], v163 offset:51200
    buffer_load_dwordx4 v185, s[8:11], s67 offen offset:3072 lds
    v_mfma_f32_16x16x32_bf16 v[20:23], a[40:43], a[64:67], v[20:23]
    v_mfma_f32_16x16x32_bf16 v[20:23], a[44:47], a[68:71], v[20:23]
    ds_read_b128 a[236:239], v177 offset:6144
    v_mfma_f32_16x16x32_bf16 v[52:55], a[40:43], a[72:75], v[52:55]
    ds_read_b64_tr_b16 a[180:181], v164 offset:49152
    v_mfma_f32_16x16x32_bf16 v[52:55], a[44:47], a[76:79], v[52:55]
    v_mfma_f32_16x16x32_bf16 v[84:87], a[40:43], a[80:83], v[84:87]
    ds_read_b64_tr_b16 a[182:183], v164 offset:51200
    s_add_u32 m0, s64, 143360
    s_add_u32 s57, s57, 128
    buffer_load_dwordx4 v186, s[8:11], s67 offen offset:0 lds
    v_mfma_f32_16x16x32_bf16 v[84:87], a[44:47], a[84:87], v[84:87]
    ds_read_b128 a[244:247], v177 offset:8192
    v_mfma_f32_16x16x32_bf16 v[116:119], a[40:43], a[88:91], v[116:119]
    v_mfma_f32_16x16x32_bf16 v[116:119], a[44:47], a[92:95], v[116:119]
    ds_read_b64_tr_b16 a[188:189], v165 offset:49152
    v_mfma_f32_16x16x32_bf16 v[148:151], a[40:43], a[96:99], v[148:151]
    v_mfma_f32_16x16x32_bf16 v[148:151], a[44:47], a[100:103], v[148:151]
    ds_read_b64_tr_b16 a[190:191], v165 offset:51200
    s_add_u32 m0, s55, 81920
    s_nop 0
    buffer_load_dwordx4 v178, s[12:15], s56 offen offset:0 lds
    v_mfma_f32_16x16x32_bf16 v[24:27], a[48:51], a[64:67], v[24:27]
    ds_read_b64_tr_b16 a[196:197], v166 offset:49152
    v_mfma_f32_16x16x32_bf16 v[24:27], a[52:55], a[68:71], v[24:27]
    v_mfma_f32_16x16x32_bf16 v[56:59], a[48:51], a[72:75], v[56:59]
    ds_read_b64_tr_b16 a[198:199], v166 offset:51200
    v_mfma_f32_16x16x32_bf16 v[56:59], a[52:55], a[76:79], v[56:59]
    ds_read_b64_tr_b16 a[204:205], v167 offset:49152
    buffer_load_dwordx4 v179, s[12:15], s56 offen offset:1024 lds
    v_mfma_f32_16x16x32_bf16 v[88:91], a[48:51], a[80:83], v[88:91]
    v_mfma_f32_16x16x32_bf16 v[88:91], a[52:55], a[84:87], v[88:91]
    ds_read_b64_tr_b16 a[206:207], v167 offset:51200
    v_mfma_f32_16x16x32_bf16 v[120:123], a[48:51], a[88:91], v[120:123]
    v_mfma_f32_16x16x32_bf16 v[120:123], a[52:55], a[92:95], v[120:123]
    v_mfma_f32_16x16x32_bf16 v[152:155], a[48:51], a[96:99], v[152:155]
    buffer_load_dwordx4 v180, s[12:15], s56 offen offset:2048 lds
    v_mfma_f32_16x16x32_bf16 v[152:155], a[52:55], a[100:103], v[152:155]
    v_mfma_f32_16x16x32_bf16 v[28:31], a[56:59], a[64:67], v[28:31]
    v_mfma_f32_16x16x32_bf16 v[28:31], a[60:63], a[68:71], v[28:31]
    v_mfma_f32_16x16x32_bf16 v[60:63], a[56:59], a[72:75], v[60:63]
    v_mfma_f32_16x16x32_bf16 v[60:63], a[60:63], a[76:79], v[60:63]
    buffer_load_dwordx4 v181, s[12:15], s56 offen offset:3072 lds
    s_add_u32 s56, s56, 0x40000
    s_cmp_ge_u32 s57, 1280
    s_cselect_b32 s56, 0, s56
    s_cselect_b32 s57, 0, s57
    v_mfma_f32_16x16x32_bf16 v[92:95], a[56:59], a[80:83], v[92:95]
    v_mfma_f32_16x16x32_bf16 v[92:95], a[60:63], a[84:87], v[92:95]
    v_mfma_f32_16x16x32_bf16 v[124:127], a[56:59], a[88:91], v[124:127]
    v_mfma_f32_16x16x32_bf16 v[124:127], a[60:63], a[92:95], v[124:127]
    v_mfma_f32_16x16x32_bf16 v[156:159], a[56:59], a[96:99], v[156:159]
    v_mfma_f32_16x16x32_bf16 v[156:159], a[60:63], a[100:103], v[156:159]
    s_waitcnt vmcnt(13) lgkmcnt(0)
    v_mfma_f32_16x16x32_bf16 v[0:3], a[144:147], a[208:211], v[0:3]
    s_barrier
    ds_read_b64_tr_b16 a[0:1], v160 offset:0
    v_mfma_f32_16x16x32_bf16 v[0:3], a[148:151], a[212:215], v[0:3]
    ds_read_b64_tr_b16 a[2:3], v160 offset:2048
    v_mfma_f32_16x16x32_bf16 v[32:35], a[144:147], a[216:219], v[32:35]
    s_add_u32 m0, s55, 32768
    s_add_u32 s67, s58, s57
    buffer_load_dwordx4 v178, s[12:15], s56 offen offset:0 lds
    v_mfma_f32_16x16x32_bf16 v[32:35], a[148:151], a[220:223], v[32:35]
    ds_read_b128 a[64:67], v176 offset:20480
    v_mfma_f32_16x16x32_bf16 v[64:67], a[144:147], a[224:227], v[64:67]
    ds_read_b64_tr_b16 a[8:9], v161 offset:0
    v_mfma_f32_16x16x32_bf16 v[64:67], a[148:151], a[228:231], v[64:67]
    v_mfma_f32_16x16x32_bf16 v[96:99], a[144:147], a[232:235], v[96:99]
    ds_read_b64_tr_b16 a[10:11], v161 offset:2048
    v_mfma_f32_16x16x32_bf16 v[96:99], a[148:151], a[236:239], v[96:99]
    ds_read_b128 a[72:75], v176 offset:22528
    buffer_load_dwordx4 v179, s[12:15], s56 offen offset:1024 lds
    v_mfma_f32_16x16x32_bf16 v[128:131], a[144:147], a[240:243], v[128:131]
    v_mfma_f32_16x16x32_bf16 v[128:131], a[148:151], a[244:247], v[128:131]
    ds_read_b64_tr_b16 a[16:17], v162 offset:0
    v_mfma_f32_16x16x32_bf16 v[4:7], a[152:155], a[208:211], v[4:7]
    v_mfma_f32_16x16x32_bf16 v[4:7], a[156:159], a[212:215], v[4:7]
    ds_read_b64_tr_b16 a[18:19], v162 offset:2048
    v_mfma_f32_16x16x32_bf16 v[36:39], a[152:155], a[216:219], v[36:39]
    ds_read_b128 a[80:83], v176 offset:24576
    buffer_load_dwordx4 v180, s[12:15], s56 offen offset:2048 lds
    v_mfma_f32_16x16x32_bf16 v[36:39], a[156:159], a[220:223], v[36:39]
    v_mfma_f32_16x16x32_bf16 v[68:71], a[152:155], a[224:227], v[68:71]
    ds_read_b64_tr_b16 a[24:25], v163 offset:0
    v_mfma_f32_16x16x32_bf16 v[68:71], a[156:159], a[228:231], v[68:71]
    ds_read_b64_tr_b16 a[26:27], v163 offset:2048
    v_mfma_f32_16x16x32_bf16 v[100:103], a[152:155], a[232:235], v[100:103]
    v_mfma_f32_16x16x32_bf16 v[100:103], a[156:159], a[236:239], v[100:103]
    ds_read_b128 a[88:91], v176 offset:26624
    v_mfma_f32_16x16x32_bf16 v[132:135], a[152:155], a[240:243], v[132:135]
    buffer_load_dwordx4 v181, s[12:15], s56 offen offset:3072 lds
    v_mfma_f32_16x16x32_bf16 v[132:135], a[156:159], a[244:247], v[132:135]
    ds_read_b64_tr_b16 a[32:33], v164 offset:0
    v_mfma_f32_16x16x32_bf16 v[8:11], a[160:163], a[208:211], v[8:11]
    ds_read_b64_tr_b16 a[34:35], v164 offset:2048
    v_mfma_f32_16x16x32_bf16 v[8:11], a[164:167], a[212:215], v[8:11]
    v_mfma_f32_16x16x32_bf16 v[40:43], a[160:163], a[216:219], v[40:43]
    ds_read_b128 a[96:99], v176 offset:28672
    v_mfma_f32_16x16x32_bf16 v[40:43], a[164:167], a[220:223], v[40:43]
    ds_read_b64_tr_b16 a[40:41], v165 offset:0
    s_add_u32 m0, s64, 98304
    s_add_u32 s56, s56, 0x40000
    buffer_load_dwordx4 v182, s[8:11], s67 offen offset:0 lds
    v_mfma_f32_16x16x32_bf16 v[72:75], a[160:163], a[224:227], v[72:75]
    v_mfma_f32_16x16x32_bf16 v[72:75], a[164:167], a[228:231], v[72:75]
    ds_read_b64_tr_b16 a[42:43], v165 offset:2048
    v_mfma_f32_16x16x32_bf16 v[104:107], a[160:163], a[232:235], v[104:107]
    v_mfma_f32_16x16x32_bf16 v[104:107], a[164:167], a[236:239], v[104:107]
    ds_read_b64_tr_b16 a[48:49], v166 offset:0
    v_mfma_f32_16x16x32_bf16 v[136:139], a[160:163], a[240:243], v[136:139]
    ds_read_b64_tr_b16 a[50:51], v166 offset:2048
    v_mfma_f32_16x16x32_bf16 v[136:139], a[164:167], a[244:247], v[136:139]
    buffer_load_dwordx4 v183, s[8:11], s67 offen offset:1024 lds
    v_mfma_f32_16x16x32_bf16 v[12:15], a[168:171], a[208:211], v[12:15]
    ds_read_b64_tr_b16 a[56:57], v167 offset:0
    v_mfma_f32_16x16x32_bf16 v[12:15], a[172:175], a[212:215], v[12:15]
    ds_read_b64_tr_b16 a[58:59], v167 offset:2048
    v_mfma_f32_16x16x32_bf16 v[44:47], a[168:171], a[216:219], v[44:47]
    v_mfma_f32_16x16x32_bf16 v[44:47], a[172:175], a[220:223], v[44:47]
    ds_read_b64_tr_b16 a[4:5], v168 offset:0
    v_mfma_f32_16x16x32_bf16 v[76:79], a[168:171], a[224:227], v[76:79]
    buffer_load_dwordx4 v184, s[8:11], s67 offen offset:2048 lds
    v_mfma_f32_16x16x32_bf16 v[76:79], a[172:175], a[228:231], v[76:79]
    ds_read_b64_tr_b16 a[6:7], v168 offset:2048
    v_mfma_f32_16x16x32_bf16 v[108:111], a[168:171], a[232:235], v[108:111]
    ds_read_b128 a[68:71], v177 offset:20480
    v_mfma_f32_16x16x32_bf16 v[108:111], a[172:175], a[236:239], v[108:111]
    v_mfma_f32_16x16x32_bf16 v[140:143], a[168:171], a[240:243], v[140:143]
    ds_read_b64_tr_b16 a[12:13], v169 offset:0
    v_mfma_f32_16x16x32_bf16 v[140:143], a[172:175], a[244:247], v[140:143]
    ds_read_b64_tr_b16 a[14:15], v169 offset:2048
    v_mfma_f32_16x16x32_bf16 v[16:19], a[176:179], a[208:211], v[16:19]
    buffer_load_dwordx4 v185, s[8:11], s67 offen offset:3072 lds
    v_mfma_f32_16x16x32_bf16 v[16:19], a[180:183], a[212:215], v[16:19]
    ds_read_b128 a[76:79], v177 offset:22528
    v_mfma_f32_16x16x32_bf16 v[48:51], a[176:179], a[216:219], v[48:51]
    v_mfma_f32_16x16x32_bf16 v[48:51], a[180:183], a[220:223], v[48:51]
    ds_read_b64_tr_b16 a[20:21], v170 offset:0
    v_mfma_f32_16x16x32_bf16 v[80:83], a[176:179], a[224:227], v[80:83]
    ds_read_b64_tr_b16 a[22:23], v170 offset:2048
    v_mfma_f32_16x16x32_bf16 v[80:83], a[180:183], a[228:231], v[80:83]
    s_add_u32 m0, s64, 102400
    s_add_u32 s57, s57, 128
    buffer_load_dwordx4 v186, s[8:11], s67 offen offset:0 lds
    v_mfma_f32_16x16x32_bf16 v[112:115], a[176:179], a[232:235], v[112:115]
    ds_read_b128 a[84:87], v177 offset:24576
    v_mfma_f32_16x16x32_bf16 v[112:115], a[180:183], a[236:239], v[112:115]
    ds_read_b64_tr_b16 a[28:29], v171 offset:0
    v_mfma_f32_16x16x32_bf16 v[144:147], a[176:179], a[240:243], v[144:147]
    v_mfma_f32_16x16x32_bf16 v[144:147], a[180:183], a[244:247], v[144:147]
    ds_read_b64_tr_b16 a[30:31], v171 offset:2048
    v_mfma_f32_16x16x32_bf16 v[20:23], a[184:187], a[208:211], v[20:23]
    s_add_u32 m0, s55, 49152
    s_nop 0
    buffer_load_dwordx4 v178, s[12:15], s56 offen offset:0 lds
    v_mfma_f32_16x16x32_bf16 v[20:23], a[188:191], a[212:215], v[20:23]
    ds_read_b128 a[92:95], v177 offset:26624
    v_mfma_f32_16x16x32_bf16 v[52:55], a[184:187], a[216:219], v[52:55]
    ds_read_b64_tr_b16 a[36:37], v172 offset:0
    v_mfma_f32_16x16x32_bf16 v[52:55], a[188:191], a[220:223], v[52:55]
    v_mfma_f32_16x16x32_bf16 v[84:87], a[184:187], a[224:227], v[84:87]
    ds_read_b64_tr_b16 a[38:39], v172 offset:2048
    v_mfma_f32_16x16x32_bf16 v[84:87], a[188:191], a[228:231], v[84:87]
    ds_read_b128 a[100:103], v177 offset:28672
    v_mfma_f32_16x16x32_bf16 v[116:119], a[184:187], a[232:235], v[116:119]
    buffer_load_dwordx4 v179, s[12:15], s56 offen offset:1024 lds
    v_mfma_f32_16x16x32_bf16 v[116:119], a[188:191], a[236:239], v[116:119]
    ds_read_b64_tr_b16 a[44:45], v173 offset:0
    v_mfma_f32_16x16x32_bf16 v[148:151], a[184:187], a[240:243], v[148:151]
    v_mfma_f32_16x16x32_bf16 v[148:151], a[188:191], a[244:247], v[148:151]
    ds_read_b64_tr_b16 a[46:47], v173 offset:2048
    v_mfma_f32_16x16x32_bf16 v[24:27], a[192:195], a[208:211], v[24:27]
    ds_read_b64_tr_b16 a[52:53], v174 offset:0
    v_mfma_f32_16x16x32_bf16 v[24:27], a[196:199], a[212:215], v[24:27]
    buffer_load_dwordx4 v180, s[12:15], s56 offen offset:2048 lds
    v_mfma_f32_16x16x32_bf16 v[56:59], a[192:195], a[216:219], v[56:59]
    ds_read_b64_tr_b16 a[54:55], v174 offset:2048
    v_mfma_f32_16x16x32_bf16 v[56:59], a[196:199], a[220:223], v[56:59]
    ds_read_b64_tr_b16 a[60:61], v175 offset:0
    v_mfma_f32_16x16x32_bf16 v[88:91], a[192:195], a[224:227], v[88:91]
    v_mfma_f32_16x16x32_bf16 v[88:91], a[196:199], a[228:231], v[88:91]
    ds_read_b64_tr_b16 a[62:63], v175 offset:2048
    v_mfma_f32_16x16x32_bf16 v[120:123], a[192:195], a[232:235], v[120:123]
    v_mfma_f32_16x16x32_bf16 v[120:123], a[196:199], a[236:239], v[120:123]
    buffer_load_dwordx4 v181, s[12:15], s56 offen offset:3072 lds
    s_add_u32 s56, s56, 0x40000
    s_cmp_ge_u32 s57, 1280
    s_cselect_b32 s56, 0, s56
    s_cselect_b32 s57, 0, s57
    v_mfma_f32_16x16x32_bf16 v[152:155], a[192:195], a[240:243], v[152:155]
    v_mfma_f32_16x16x32_bf16 v[152:155], a[196:199], a[244:247], v[152:155]
    v_mfma_f32_16x16x32_bf16 v[28:31], a[200:203], a[208:211], v[28:31]
    v_mfma_f32_16x16x32_bf16 v[28:31], a[204:207], a[212:215], v[28:31]
    v_mfma_f32_16x16x32_bf16 v[60:63], a[200:203], a[216:219], v[60:63]
    buffer_load_dword v192, v190, s[32:35], 0 offen
    v_mfma_f32_16x16x32_bf16 v[60:63], a[204:207], a[220:223], v[60:63]
    v_mfma_f32_16x16x32_bf16 v[92:95], a[200:203], a[224:227], v[92:95]
    v_mfma_f32_16x16x32_bf16 v[92:95], a[204:207], a[228:231], v[92:95]
    v_mfma_f32_16x16x32_bf16 v[124:127], a[200:203], a[232:235], v[124:127]
    v_mfma_f32_16x16x32_bf16 v[124:127], a[204:207], a[236:239], v[124:127]
    v_mfma_f32_16x16x32_bf16 v[156:159], a[200:203], a[240:243], v[156:159]
    v_mfma_f32_16x16x32_bf16 v[156:159], a[204:207], a[244:247], v[156:159]
    s_waitcnt vmcnt(14) lgkmcnt(0)
    v_mfma_f32_16x16x32_bf16 v[0:3], a[0:3], a[64:67], v[0:3]
    s_barrier
    ds_read_b64_tr_b16 a[144:145], v160 offset:16384
    v_mfma_f32_16x16x32_bf16 v[0:3], a[4:7], a[68:71], v[0:3]
    ds_read_b64_tr_b16 a[146:147], v160 offset:18432
    v_mfma_f32_16x16x32_bf16 v[32:35], a[0:3], a[72:75], v[32:35]
    s_add_u32 m0, s55, 0
    s_add_u32 s67, s58, s57
    buffer_load_dwordx4 v178, s[12:15], s56 offen offset:0 lds
    v_mfma_f32_16x16x32_bf16 v[32:35], a[4:7], a[76:79], v[32:35]
    ds_read_b128 a[208:211], v176 offset:40960
    v_mfma_f32_16x16x32_bf16 v[64:67], a[0:3], a[80:83], v[64:67]
    ds_read_b64_tr_b16 a[152:153], v161 offset:16384
    v_mfma_f32_16x16x32_bf16 v[64:67], a[4:7], a[84:87], v[64:67]
    v_mfma_f32_16x16x32_bf16 v[96:99], a[0:3], a[88:91], v[96:99]
    ds_read_b64_tr_b16 a[154:155], v161 offset:18432
    v_mfma_f32_16x16x32_bf16 v[96:99], a[4:7], a[92:95], v[96:99]
    ds_read_b128 a[216:219], v176 offset:43008
    buffer_load_dwordx4 v179, s[12:15], s56 offen offset:1024 lds
    v_mfma_f32_16x16x32_bf16 v[128:131], a[0:3], a[96:99], v[128:131]
    v_mfma_f32_16x16x32_bf16 v[128:131], a[4:7], a[100:103], v[128:131]
    ds_read_b64_tr_b16 a[160:161], v162 offset:16384
    v_mfma_f32_16x16x32_bf16 v[4:7], a[8:11], a[64:67], v[4:7]
    v_mfma_f32_16x16x32_bf16 v[4:7], a[12:15], a[68:71], v[4:7]
    ds_read_b64_tr_b16 a[162:163], v162 offset:18432
    v_mfma_f32_16x16x32_bf16 v[36:39], a[8:11], a[72:75], v[36:39]
    ds_read_b128 a[224:227], v176 offset:45056
    v_mfma_f32_16x16x32_bf16 v[36:39], a[12:15], a[76:79], v[36:39]
    buffer_load_dwordx4 v180, s[12:15], s56 offen offset:2048 lds
    v_mfma_f32_16x16x32_bf16 v[68:71], a[8:11], a[80:83], v[68:71]
    ds_read_b64_tr_b16 a[168:169], v163 offset:16384
    v_mfma_f32_16x16x32_bf16 v[68:71], a[12:15], a[84:87], v[68:71]
    ds_read_b64_tr_b16 a[170:171], v163 offset:18432
    v_mfma_f32_16x16x32_bf16 v[100:103], a[8:11], a[88:91], v[100:103]
    v_mfma_f32_16x16x32_bf16 v[100:103], a[12:15], a[92:95], v[100:103]
    ds_read_b128 a[232:235], v176 offset:47104
    v_mfma_f32_16x16x32_bf16 v[132:135], a[8:11], a[96:99], v[132:135]
    v_mfma_f32_16x16x32_bf16 v[132:135], a[12:15], a[100:103], v[132:135]
    ds_read_b64_tr_b16 a[176:177], v164 offset:16384
    buffer_load_dwordx4 v181, s[12:15], s56 offen offset:3072 lds
    v_mfma_f32_16x16x32_bf16 v[8:11], a[16:19], a[64:67], v[8:11]
    ds_read_b64_tr_b16 a[178:179], v164 offset:18432
    v_mfma_f32_16x16x32_bf16 v[8:11], a[20:23], a[68:71], v[8:11]
    v_mfma_f32_16x16x32_bf16 v[40:43], a[16:19], a[72:75], v[40:43]
    ds_read_b128 a[240:243], v176 offset:49152
    v_mfma_f32_16x16x32_bf16 v[40:43], a[20:23], a[76:79], v[40:43]
    ds_read_b64_tr_b16 a[184:185], v165 offset:16384
    v_mfma_f32_16x16x32_bf16 v[72:75], a[16:19], a[80:83], v[72:75]
    v_mfma_f32_16x16x32_bf16 v[72:75], a[20:23], a[84:87], v[72:75]
    ds_read_b64_tr_b16 a[186:187], v165 offset:18432
    s_add_u32 m0, s64, 118784
    s_add_u32 s56, s56, 0x40000
    buffer_load_dwordx4 v182, s[8:11], s67 offen offset:0 lds
    v_mfma_f32_16x16x32_bf16 v[104:107], a[16:19], a[88:91], v[104:107]
    v_mfma_f32_16x16x32_bf16 v[104:107], a[20:23], a[92:95], v[104:107]
    ds_read_b64_tr_b16 a[192:193], v166 offset:16384
    v_mfma_f32_16x16x32_bf16 v[136:139], a[16:19], a[96:99], v[136:139]
    ds_read_b64_tr_b16 a[194:195], v166 offset:18432
    v_mfma_f32_16x16x32_bf16 v[136:139], a[20:23], a[100:103], v[136:139]
    v_mfma_f32_16x16x32_bf16 v[12:15], a[24:27], a[64:67], v[12:15]
    ds_read_b64_tr_b16 a[200:201], v167 offset:16384
    v_mfma_f32_16x16x32_bf16 v[12:15], a[28:31], a[68:71], v[12:15]
    ds_read_b64_tr_b16 a[202:203], v167 offset:18432
    buffer_load_dwordx4 v183, s[8:11], s67 offen offset:1024 lds
    v_mfma_f32_16x16x32_bf16 v[44:47], a[24:27], a[72:75], v[44:47]
    v_mfma_f32_16x16x32_bf16 v[44:47], a[28:31], a[76:79], v[44:47]
    ds_read_b64_tr_b16 a[148:149], v168 offset:16384
    v_mfma_f32_16x16x32_bf16 v[76:79], a[24:27], a[80:83], v[76:79]
    v_mfma_f32_16x16x32_bf16 v[76:79], a[28:31], a[84:87], v[76:79]
    ds_read_b64_tr_b16 a[150:151], v168 offset:18432
    v_mfma_f32_16x16x32_bf16 v[108:111], a[24:27], a[88:91], v[108:111]
    ds_read_b128 a[212:215], v177 offset:40960
    v_mfma_f32_16x16x32_bf16 v[108:111], a[28:31], a[92:95], v[108:111]
    buffer_load_dwordx4 v184, s[8:11], s67 offen offset:2048 lds
    v_mfma_f32_16x16x32_bf16 v[140:143], a[24:27], a[96:99], v[140:143]
    ds_read_b64_tr_b16 a[156:157], v169 offset:16384
    v_mfma_f32_16x16x32_bf16 v[140:143], a[28:31], a[100:103], v[140:143]
    ds_read_b64_tr_b16 a[158:159], v169 offset:18432
    v_mfma_f32_16x16x32_bf16 v[16:19], a[32:35], a[64:67], v[16:19]
    v_mfma_f32_16x16x32_bf16 v[16:19], a[36:39], a[68:71], v[16:19]
    ds_read_b128 a[220:223], v177 offset:43008
    v_mfma_f32_16x16x32_bf16 v[48:51], a[32:35], a[72:75], v[48:51]
    buffer_load_dwordx4 v185, s[8:11], s67 offen offset:3072 lds
    v_mfma_f32_16x16x32_bf16 v[48:51], a[36:39], a[76:79], v[48:51]
    ds_read_b64_tr_b16 a[164:165], v170 offset:16384
    v_mfma_f32_16x16x32_bf16 v[80:83], a[32:35], a[80:83], v[80:83]
    ds_read_b64_tr_b16 a[166:167], v170 offset:18432
    v_mfma_f32_16x16x32_bf16 v[80:83], a[36:39], a[84:87], v[80:83]
    v_mfma_f32_16x16x32_bf16 v[112:115], a[32:35], a[88:91], v[112:115]
    ds_read_b128 a[228:231], v177 offset:45056
    v_mfma_f32_16x16x32_bf16 v[112:115], a[36:39], a[92:95], v[112:115]
    ds_read_b64_tr_b16 a[172:173], v171 offset:16384
    v_mfma_f32_16x16x32_bf16 v[144:147], a[32:35], a[96:99], v[144:147]
    s_add_u32 m0, s64, 122880
    s_add_u32 s57, s57, 128
    buffer_load_dwordx4 v186, s[8:11], s67 offen offset:0 lds
    v_mfma_f32_16x16x32_bf16 v[144:147], a[36:39], a[100:103], v[144:147]
    ds_read_b64_tr_b16 a[174:175], v171 offset:18432
    v_mfma_f32_16x16x32_bf16 v[20:23], a[40:43], a[64:67], v[20:23]
    v_mfma_f32_16x16x32_bf16 v[20:23], a[44:47], a[68:71], v[20:23]
    ds_read_b128 a[236:239], v177 offset:47104
    v_mfma_f32_16x16x32_bf16 v[52:55], a[40:43], a[72:75], v[52:55]
    ds_read_b64_tr_b16 a[180:181], v172 offset:16384
    v_mfma_f32_16x16x32_bf16 v[52:55], a[44:47], a[76:79], v[52:55]
    v_mfma_f32_16x16x32_bf16 v[84:87], a[40:43], a[80:83], v[84:87]
    ds_read_b64_tr_b16 a[182:183], v172 offset:18432
    s_add_u32 m0, s55, 65536
    s_nop 0
    buffer_load_dwordx4 v178, s[12:15], s56 offen offset:0 lds
    v_mfma_f32_16x16x32_bf16 v[84:87], a[44:47], a[84:87], v[84:87]
    ds_read_b128 a[244:247], v177 offset:49152
    v_mfma_f32_16x16x32_bf16 v[116:119], a[40:43], a[88:91], v[116:119]
    v_mfma_f32_16x16x32_bf16 v[116:119], a[44:47], a[92:95], v[116:119]
    ds_read_b64_tr_b16 a[188:189], v173 offset:16384
    v_mfma_f32_16x16x32_bf16 v[148:151], a[40:43], a[96:99], v[148:151]
    v_mfma_f32_16x16x32_bf16 v[148:151], a[44:47], a[100:103], v[148:151]
    ds_read_b64_tr_b16 a[190:191], v173 offset:18432
    v_mfma_f32_16x16x32_bf16 v[24:27], a[48:51], a[64:67], v[24:27]
    ds_read_b64_tr_b16 a[196:197], v174 offset:16384
    buffer_load_dwordx4 v179, s[12:15], s56 offen offset:1024 lds
    v_mfma_f32_16x16x32_bf16 v[24:27], a[52:55], a[68:71], v[24:27]
    v_mfma_f32_16x16x32_bf16 v[56:59], a[48:51], a[72:75], v[56:59]
    ds_read_b64_tr_b16 a[198:199], v174 offset:18432
    v_mfma_f32_16x16x32_bf16 v[56:59], a[52:55], a[76:79], v[56:59]
    ds_read_b64_tr_b16 a[204:205], v175 offset:16384
    v_mfma_f32_16x16x32_bf16 v[88:91], a[48:51], a[80:83], v[88:91]
    v_mfma_f32_16x16x32_bf16 v[88:91], a[52:55], a[84:87], v[88:91]
    ds_read_b64_tr_b16 a[206:207], v175 offset:18432
    v_mfma_f32_16x16x32_bf16 v[120:123], a[48:51], a[88:91], v[120:123]
    buffer_load_dwordx4 v180, s[12:15], s56 offen offset:2048 lds
    v_mfma_f32_16x16x32_bf16 v[120:123], a[52:55], a[92:95], v[120:123]
    v_mfma_f32_16x16x32_bf16 v[152:155], a[48:51], a[96:99], v[152:155]
    v_mfma_f32_16x16x32_bf16 v[152:155], a[52:55], a[100:103], v[152:155]
    v_mfma_f32_16x16x32_bf16 v[28:31], a[56:59], a[64:67], v[28:31]
    v_mfma_f32_16x16x32_bf16 v[28:31], a[60:63], a[68:71], v[28:31]
    v_mfma_f32_16x16x32_bf16 v[60:63], a[56:59], a[72:75], v[60:63]
    buffer_load_dwordx4 v181, s[12:15], s56 offen offset:3072 lds
    s_add_u32 s56, s56, 0x40000
    s_cmp_ge_u32 s57, 1280
    s_cselect_b32 s56, 0, s56
    s_cselect_b32 s57, 0, s57
    v_mfma_f32_16x16x32_bf16 v[60:63], a[60:63], a[76:79], v[60:63]
    v_mfma_f32_16x16x32_bf16 v[92:95], a[56:59], a[80:83], v[92:95]
    v_mfma_f32_16x16x32_bf16 v[92:95], a[60:63], a[84:87], v[92:95]
    v_mfma_f32_16x16x32_bf16 v[124:127], a[56:59], a[88:91], v[124:127]
    v_mfma_f32_16x16x32_bf16 v[124:127], a[60:63], a[92:95], v[124:127]
    v_mfma_f32_16x16x32_bf16 v[156:159], a[56:59], a[96:99], v[156:159]
    v_mfma_f32_16x16x32_bf16 v[156:159], a[60:63], a[100:103], v[156:159]
    s_waitcnt vmcnt(14) lgkmcnt(0)
    v_mfma_f32_16x16x32_bf16 v[0:3], a[144:147], a[208:211], v[0:3]
    s_barrier
    ds_read_b64_tr_b16 a[0:1], v160 offset:32768
    v_mfma_f32_16x16x32_bf16 v[0:3], a[148:151], a[212:215], v[0:3]
    ds_read_b64_tr_b16 a[2:3], v160 offset:34816
    v_mfma_f32_16x16x32_bf16 v[32:35], a[144:147], a[216:219], v[32:35]
    s_add_u32 m0, s55, 16384
    s_add_u32 s67, s58, s57
    buffer_load_dwordx4 v178, s[12:15], s56 offen offset:0 lds
    v_mfma_f32_16x16x32_bf16 v[32:35], a[148:151], a[220:223], v[32:35]
    ds_read_b128 a[64:67], v176 offset:0
    v_mfma_f32_16x16x32_bf16 v[64:67], a[144:147], a[224:227], v[64:67]
    ds_read_b64_tr_b16 a[8:9], v161 offset:32768
    v_mfma_f32_16x16x32_bf16 v[64:67], a[148:151], a[228:231], v[64:67]
    v_mfma_f32_16x16x32_bf16 v[96:99], a[144:147], a[232:235], v[96:99]
    ds_read_b64_tr_b16 a[10:11], v161 offset:34816
    v_mfma_f32_16x16x32_bf16 v[96:99], a[148:151], a[236:239], v[96:99]
    ds_read_b128 a[72:75], v176 offset:2048
    buffer_load_dwordx4 v179, s[12:15], s56 offen offset:1024 lds
    v_mfma_f32_16x16x32_bf16 v[128:131], a[144:147], a[240:243], v[128:131]
    v_mfma_f32_16x16x32_bf16 v[128:131], a[148:151], a[244:247], v[128:131]
    ds_read_b64_tr_b16 a[16:17], v162 offset:32768
    v_mfma_f32_16x16x32_bf16 v[4:7], a[152:155], a[208:211], v[4:7]
    v_mfma_f32_16x16x32_bf16 v[4:7], a[156:159], a[212:215], v[4:7]
    ds_read_b64_tr_b16 a[18:19], v162 offset:34816
    v_mfma_f32_16x16x32_bf16 v[36:39], a[152:155], a[216:219], v[36:39]
    ds_read_b128 a[80:83], v176 offset:4096
    buffer_load_dwordx4 v180, s[12:15], s56 offen offset:2048 lds
    v_mfma_f32_16x16x32_bf16 v[36:39], a[156:159], a[220:223], v[36:39]
    v_mfma_f32_16x16x32_bf16 v[68:71], a[152:155], a[224:227], v[68:71]
    ds_read_b64_tr_b16 a[24:25], v163 offset:32768
    v_mfma_f32_16x16x32_bf16 v[68:71], a[156:159], a[228:231], v[68:71]
    ds_read_b64_tr_b16 a[26:27], v163 offset:34816
    v_mfma_f32_16x16x32_bf16 v[100:103], a[152:155], a[232:235], v[100:103]
    v_mfma_f32_16x16x32_bf16 v[100:103], a[156:159], a[236:239], v[100:103]
    ds_read_b128 a[88:91], v176 offset:6144
    v_mfma_f32_16x16x32_bf16 v[132:135], a[152:155], a[240:243], v[132:135]
    buffer_load_dwordx4 v181, s[12:15], s56 offen offset:3072 lds
    v_mfma_f32_16x16x32_bf16 v[132:135], a[156:159], a[244:247], v[132:135]
    ds_read_b64_tr_b16 a[32:33], v164 offset:32768
    v_mfma_f32_16x16x32_bf16 v[8:11], a[160:163], a[208:211], v[8:11]
    ds_read_b64_tr_b16 a[34:35], v164 offset:34816
    v_mfma_f32_16x16x32_bf16 v[8:11], a[164:167], a[212:215], v[8:11]
    v_mfma_f32_16x16x32_bf16 v[40:43], a[160:163], a[216:219], v[40:43]
    ds_read_b128 a[96:99], v176 offset:8192
    v_mfma_f32_16x16x32_bf16 v[40:43], a[164:167], a[220:223], v[40:43]
    ds_read_b64_tr_b16 a[40:41], v165 offset:32768
    s_add_u32 m0, s64, 139264
    s_add_u32 s56, s56, 0x40000
    buffer_load_dwordx4 v182, s[8:11], s67 offen offset:0 lds
    v_mfma_f32_16x16x32_bf16 v[72:75], a[160:163], a[224:227], v[72:75]
    v_mfma_f32_16x16x32_bf16 v[72:75], a[164:167], a[228:231], v[72:75]
    ds_read_b64_tr_b16 a[42:43], v165 offset:34816
    v_mfma_f32_16x16x32_bf16 v[104:107], a[160:163], a[232:235], v[104:107]
    v_mfma_f32_16x16x32_bf16 v[104:107], a[164:167], a[236:239], v[104:107]
    ds_read_b64_tr_b16 a[48:49], v166 offset:32768
    v_mfma_f32_16x16x32_bf16 v[136:139], a[160:163], a[240:243], v[136:139]
    ds_read_b64_tr_b16 a[50:51], v166 offset:34816
    v_mfma_f32_16x16x32_bf16 v[136:139], a[164:167], a[244:247], v[136:139]
    buffer_load_dwordx4 v183, s[8:11], s67 offen offset:1024 lds
    v_mfma_f32_16x16x32_bf16 v[12:15], a[168:171], a[208:211], v[12:15]
    ds_read_b64_tr_b16 a[56:57], v167 offset:32768
    v_mfma_f32_16x16x32_bf16 v[12:15], a[172:175], a[212:215], v[12:15]
    ds_read_b64_tr_b16 a[58:59], v167 offset:34816
    v_mfma_f32_16x16x32_bf16 v[44:47], a[168:171], a[216:219], v[44:47]
    v_mfma_f32_16x16x32_bf16 v[44:47], a[172:175], a[220:223], v[44:47]
    ds_read_b64_tr_b16 a[4:5], v160 offset:49152
    v_mfma_f32_16x16x32_bf16 v[76:79], a[168:171], a[224:227], v[76:79]
    global_load_dwordx2 v[188:189], v254, s[68:69] sc1
    v_mfma_f32_16x16x32_bf16 v[76:79], a[172:175], a[228:231], v[76:79]
    ds_read_b64_tr_b16 a[6:7], v160 offset:51200
    v_mfma_f32_16x16x32_bf16 v[108:111], a[168:171], a[232:235], v[108:111]
    ds_read_b128 a[68:71], v177 offset:0
    v_mfma_f32_16x16x32_bf16 v[108:111], a[172:175], a[236:239], v[108:111]
    v_mfma_f32_16x16x32_bf16 v[140:143], a[168:171], a[240:243], v[140:143]
    ds_read_b64_tr_b16 a[12:13], v161 offset:49152
    v_mfma_f32_16x16x32_bf16 v[140:143], a[172:175], a[244:247], v[140:143]
    ds_read_b64_tr_b16 a[14:15], v161 offset:51200
    v_mfma_f32_16x16x32_bf16 v[16:19], a[176:179], a[208:211], v[16:19]
    buffer_load_dwordx4 v184, s[8:11], s67 offen offset:2048 lds
    v_mfma_f32_16x16x32_bf16 v[16:19], a[180:183], a[212:215], v[16:19]
    ds_read_b128 a[76:79], v177 offset:2048
    v_mfma_f32_16x16x32_bf16 v[48:51], a[176:179], a[216:219], v[48:51]
    v_mfma_f32_16x16x32_bf16 v[48:51], a[180:183], a[220:223], v[48:51]
    ds_read_b64_tr_b16 a[20:21], v162 offset:49152
    v_mfma_f32_16x16x32_bf16 v[80:83], a[176:179], a[224:227], v[80:83]
    ds_read_b64_tr_b16 a[22:23], v162 offset:51200
    v_mfma_f32_16x16x32_bf16 v[80:83], a[180:183], a[228:231], v[80:83]
    buffer_load_dwordx4 v185, s[8:11], s67 offen offset:3072 lds
    v_mfma_f32_16x16x32_bf16 v[112:115], a[176:179], a[232:235], v[112:115]
    ds_read_b128 a[84:87], v177 offset:4096
    v_mfma_f32_16x16x32_bf16 v[112:115], a[180:183], a[236:239], v[112:115]
    ds_read_b64_tr_b16 a[28:29], v163 offset:49152
    v_mfma_f32_16x16x32_bf16 v[144:147], a[176:179], a[240:243], v[144:147]
    v_mfma_f32_16x16x32_bf16 v[144:147], a[180:183], a[244:247], v[144:147]
    ds_read_b64_tr_b16 a[30:31], v163 offset:51200
    v_mfma_f32_16x16x32_bf16 v[20:23], a[184:187], a[208:211], v[20:23]
    s_add_u32 m0, s64, 143360
    s_add_u32 s57, s57, 128
    buffer_load_dwordx4 v186, s[8:11], s67 offen offset:0 lds
    v_mfma_f32_16x16x32_bf16 v[20:23], a[188:191], a[212:215], v[20:23]
    ds_read_b128 a[92:95], v177 offset:6144
    v_mfma_f32_16x16x32_bf16 v[52:55], a[184:187], a[216:219], v[52:55]
    ds_read_b64_tr_b16 a[36:37], v164 offset:49152
    v_mfma_f32_16x16x32_bf16 v[52:55], a[188:191], a[220:223], v[52:55]
    v_mfma_f32_16x16x32_bf16 v[84:87], a[184:187], a[224:227], v[84:87]
    ds_read_b64_tr_b16 a[38:39], v164 offset:51200
    v_mfma_f32_16x16x32_bf16 v[84:87], a[188:191], a[228:231], v[84:87]
    ds_read_b128 a[100:103], v177 offset:8192
    v_mfma_f32_16x16x32_bf16 v[116:119], a[184:187], a[232:235], v[116:119]
    s_add_u32 m0, s55, 81920
    s_nop 0
    buffer_load_dwordx4 v178, s[12:15], s56 offen offset:0 lds
    v_mfma_f32_16x16x32_bf16 v[116:119], a[188:191], a[236:239], v[116:119]
    ds_read_b64_tr_b16 a[44:45], v165 offset:49152
    v_mfma_f32_16x16x32_bf16 v[148:151], a[184:187], a[240:243], v[148:151]
    v_mfma_f32_16x16x32_bf16 v[148:151], a[188:191], a[244:247], v[148:151]
    ds_read_b64_tr_b16 a[46:47], v165 offset:51200
    v_mfma_f32_16x16x32_bf16 v[24:27], a[192:195], a[208:211], v[24:27]
    ds_read_b64_tr_b16 a[52:53], v166 offset:49152
    v_mfma_f32_16x16x32_bf16 v[24:27], a[196:199], a[212:215], v[24:27]
    buffer_load_dwordx4 v179, s[12:15], s56 offen offset:1024 lds
    v_mfma_f32_16x16x32_bf16 v[56:59], a[192:195], a[216:219], v[56:59]
    ds_read_b64_tr_b16 a[54:55], v166 offset:51200
    v_mfma_f32_16x16x32_bf16 v[56:59], a[196:199], a[220:223], v[56:59]
    ds_read_b64_tr_b16 a[60:61], v167 offset:49152
    v_mfma_f32_16x16x32_bf16 v[88:91], a[192:195], a[224:227], v[88:91]
    v_mfma_f32_16x16x32_bf16 v[88:91], a[196:199], a[228:231], v[88:91]
    ds_read_b64_tr_b16 a[62:63], v167 offset:51200
    v_mfma_f32_16x16x32_bf16 v[120:123], a[192:195], a[232:235], v[120:123]
    v_mfma_f32_16x16x32_bf16 v[120:123], a[196:199], a[236:239], v[120:123]
    buffer_load_dwordx4 v180, s[12:15], s56 offen offset:2048 lds
    v_mfma_f32_16x16x32_bf16 v[152:155], a[192:195], a[240:243], v[152:155]
    v_mfma_f32_16x16x32_bf16 v[152:155], a[196:199], a[244:247], v[152:155]
    v_mfma_f32_16x16x32_bf16 v[28:31], a[200:203], a[208:211], v[28:31]
    v_mfma_f32_16x16x32_bf16 v[28:31], a[204:207], a[212:215], v[28:31]
    v_mfma_f32_16x16x32_bf16 v[60:63], a[200:203], a[216:219], v[60:63]
    buffer_load_dwordx4 v181, s[12:15], s56 offen offset:3072 lds
    s_add_u32 s56, s56, 0x40000
    s_cmp_ge_u32 s57, 1280
    s_cselect_b32 s56, 0, s56
    s_cselect_b32 s57, 0, s57
    v_mfma_f32_16x16x32_bf16 v[60:63], a[204:207], a[220:223], v[60:63]
    v_mfma_f32_16x16x32_bf16 v[92:95], a[200:203], a[224:227], v[92:95]
    v_mfma_f32_16x16x32_bf16 v[92:95], a[204:207], a[228:231], v[92:95]
    v_mfma_f32_16x16x32_bf16 v[124:127], a[200:203], a[232:235], v[124:127]
    v_mfma_f32_16x16x32_bf16 v[124:127], a[204:207], a[236:239], v[124:127]
    v_mfma_f32_16x16x32_bf16 v[156:159], a[200:203], a[240:243], v[156:159]
    v_mfma_f32_16x16x32_bf16 v[156:159], a[204:207], a[244:247], v[156:159]
    s_waitcnt vmcnt(14) lgkmcnt(0)
    v_mfma_f32_16x16x32_bf16 v[0:3], a[0:3], a[64:67], v[0:3]
    s_barrier
    ds_read_b64_tr_b16 a[144:145], v160 offset:0
    v_mfma_f32_16x16x32_bf16 v[0:3], a[4:7], a[68:71], v[0:3]
    ds_read_b64_tr_b16 a[146:147], v160 offset:2048
    v_mfma_f32_16x16x32_bf16 v[32:35], a[0:3], a[72:75], v[32:35]
    s_add_u32 m0, s55, 32768
    s_add_u32 s67, s58, s57
    buffer_load_dwordx4 v178, s[12:15], s56 offen offset:0 lds
    v_mfma_f32_16x16x32_bf16 v[32:35], a[4:7], a[76:79], v[32:35]
    ds_read_b128 a[208:211], v176 offset:20480
    v_mfma_f32_16x16x32_bf16 v[64:67], a[0:3], a[80:83], v[64:67]
    ds_read_b64_tr_b16 a[152:153], v161 offset:0
    v_mfma_f32_16x16x32_bf16 v[64:67], a[4:7], a[84:87], v[64:67]
    v_mfma_f32_16x16x32_bf16 v[96:99], a[0:3], a[88:91], v[96:99]
    ds_read_b64_tr_b16 a[154:155], v161 offset:2048
    v_mfma_f32_16x16x32_bf16 v[96:99], a[4:7], a[92:95], v[96:99]
    ds_read_b128 a[216:219], v176 offset:22528
    buffer_load_dwordx4 v179, s[12:15], s56 offen offset:1024 lds
    v_mfma_f32_16x16x32_bf16 v[128:131], a[0:3], a[96:99], v[128:131]
    v_mfma_f32_16x16x32_bf16 v[128:131], a[4:7], a[100:103], v[128:131]
    ds_read_b64_tr_b16 a[160:161], v162 offset:0
    v_mfma_f32_16x16x32_bf16 v[4:7], a[8:11], a[64:67], v[4:7]
    v_mfma_f32_16x16x32_bf16 v[4:7], a[12:15], a[68:71], v[4:7]
    ds_read_b64_tr_b16 a[162:163], v162 offset:2048
    v_mfma_f32_16x16x32_bf16 v[36:39], a[8:11], a[72:75], v[36:39]
    ds_read_b128 a[224:227], v176 offset:24576
    buffer_load_dwordx4 v180, s[12:15], s56 offen offset:2048 lds
    v_mfma_f32_16x16x32_bf16 v[36:39], a[12:15], a[76:79], v[36:39]
    v_mfma_f32_16x16x32_bf16 v[68:71], a[8:11], a[80:83], v[68:71]
    ds_read_b64_tr_b16 a[168:169], v163 offset:0
    v_mfma_f32_16x16x32_bf16 v[68:71], a[12:15], a[84:87], v[68:71]
    ds_read_b64_tr_b16 a[170:171], v163 offset:2048
    v_mfma_f32_16x16x32_bf16 v[100:103], a[8:11], a[88:91], v[100:103]
    v_mfma_f32_16x16x32_bf16 v[100:103], a[12:15], a[92:95], v[100:103]
    ds_read_b128 a[232:235], v176 offset:26624
    buffer_load_dwordx4 v181, s[12:15], s56 offen offset:3072 lds
    v_mfma_f32_16x16x32_bf16 v[132:135], a[8:11], a[96:99], v[132:135]
    v_mfma_f32_16x16x32_bf16 v[132:135], a[12:15], a[100:103], v[132:135]
    ds_read_b64_tr_b16 a[176:177], v164 offset:0
    v_mfma_f32_16x16x32_bf16 v[8:11], a[16:19], a[64:67], v[8:11]
    ds_read_b64_tr_b16 a[178:179], v164 offset:2048
    v_mfma_f32_16x16x32_bf16 v[8:11], a[20:23], a[68:71], v[8:11]
    v_mfma_f32_16x16x32_bf16 v[40:43], a[16:19], a[72:75], v[40:43]
    ds_read_b128 a[240:243], v176 offset:28672
    s_add_u32 m0, s64, 98304
    s_add_u32 s56, s56, 0x40000
    buffer_load_dwordx4 v182, s[8:11], s67 offen offset:0 lds
    v_mfma_f32_16x16x32_bf16 v[40:43], a[20:23], a[76:79], v[40:43]
    ds_read_b64_tr_b16 a[184:185], v165 offset:0
    v_mfma_f32_16x16x32_bf16 v[72:75], a[16:19], a[80:83], v[72:75]
    v_mfma_f32_16x16x32_bf16 v[72:75], a[20:23], a[84:87], v[72:75]
    ds_read_b64_tr_b16 a[186:187], v165 offset:2048
    v_mfma_f32_16x16x32_bf16 v[104:107], a[16:19], a[88:91], v[104:107]
    v_mfma_f32_16x16x32_bf16 v[104:107], a[20:23], a[92:95], v[104:107]
    ds_read_b64_tr_b16 a[192:193], v166 offset:0
    buffer_load_dwordx4 v183, s[8:11], s67 offen offset:1024 lds
    v_mfma_f32_16x16x32_bf16 v[136:139], a[16:19], a[96:99], v[136:139]
    ds_read_b64_tr_b16 a[194:195], v166 offset:2048
    v_mfma_f32_16x16x32_bf16 v[136:139], a[20:23], a[100:103], v[136:139]
    v_mfma_f32_16x16x32_bf16 v[12:15], a[24:27], a[64:67], v[12:15]
    ds_read_b64_tr_b16 a[200:201], v167 offset:0
    v_mfma_f32_16x16x32_bf16 v[12:15], a[28:31], a[68:71], v[12:15]
    ds_read_b64_tr_b16 a[202:203], v167 offset:2048
    v_mfma_f32_16x16x32_bf16 v[44:47], a[24:27], a[72:75], v[44:47]
    buffer_load_dwordx4 v184, s[8:11], s67 offen offset:2048 lds
    v_mfma_f32_16x16x32_bf16 v[44:47], a[28:31], a[76:79], v[44:47]
    ds_read_b64_tr_b16 a[148:149], v168 offset:0
    v_mfma_f32_16x16x32_bf16 v[76:79], a[24:27], a[80:83], v[76:79]
    v_mfma_f32_16x16x32_bf16 v[76:79], a[28:31], a[84:87], v[76:79]
    ds_read_b64_tr_b16 a[150:151], v168 offset:2048
    v_mfma_f32_16x16x32_bf16 v[108:111], a[24:27], a[88:91], v[108:111]
    ds_read_b128 a[212:215], v177 offset:20480
    v_mfma_f32_16x16x32_bf16 v[108:111], a[28:31], a[92:95], v[108:111]
    buffer_load_dwordx4 v185, s[8:11], s67 offen offset:3072 lds
    v_mfma_f32_16x16x32_bf16 v[140:143], a[24:27], a[96:99], v[140:143]
    ds_read_b64_tr_b16 a[156:157], v169 offset:0
    v_mfma_f32_16x16x32_bf16 v[140:143], a[28:31], a[100:103], v[140:143]
    ds_read_b64_tr_b16 a[158:159], v169 offset:2048
    v_mfma_f32_16x16x32_bf16 v[16:19], a[32:35], a[64:67], v[16:19]
    v_mfma_f32_16x16x32_bf16 v[16:19], a[36:39], a[68:71], v[16:19]
    ds_read_b128 a[220:223], v177 offset:22528
    v_mfma_f32_16x16x32_bf16 v[48:51], a[32:35], a[72:75], v[48:51]
    s_add_u32 m0, s64, 102400
    s_add_u32 s57, s57, 128
    buffer_load_dwordx4 v186, s[8:11], s67 offen offset:0 lds
    v_mfma_f32_16x16x32_bf16 v[48:51], a[36:39], a[76:79], v[48:51]
    ds_read_b64_tr_b16 a[164:165], v170 offset:0
    v_mfma_f32_16x16x32_bf16 v[80:83], a[32:35], a[80:83], v[80:83]
    ds_read_b64_tr_b16 a[166:167], v170 offset:2048
    v_mfma_f32_16x16x32_bf16 v[80:83], a[36:39], a[84:87], v[80:83]
    v_mfma_f32_16x16x32_bf16 v[112:115], a[32:35], a[88:91], v[112:115]
    ds_read_b128 a[228:231], v177 offset:24576
    v_mfma_f32_16x16x32_bf16 v[112:115], a[36:39], a[92:95], v[112:115]
    ds_read_b64_tr_b16 a[172:173], v171 offset:0
    s_add_u32 m0, s55, 49152
    s_nop 0
    buffer_load_dwordx4 v178, s[12:15], s56 offen offset:0 lds
    v_mfma_f32_16x16x32_bf16 v[144:147], a[32:35], a[96:99], v[144:147]
    v_mfma_f32_16x16x32_bf16 v[144:147], a[36:39], a[100:103], v[144:147]
    ds_read_b64_tr_b16 a[174:175], v171 offset:2048
    v_mfma_f32_16x16x32_bf16 v[20:23], a[40:43], a[64:67], v[20:23]
    v_mfma_f32_16x16x32_bf16 v[20:23], a[44:47], a[68:71], v[20:23]
    ds_read_b128 a[236:239], v177 offset:26624
    v_mfma_f32_16x16x32_bf16 v[52:55], a[40:43], a[72:75], v[52:55]
    ds_read_b64_tr_b16 a[180:181], v172 offset:0
    buffer_load_dwordx4 v179, s[12:15], s56 offen offset:1024 lds
    v_mfma_f32_16x16x32_bf16 v[52:55], a[44:47], a[76:79], v[52:55]
    v_mfma_f32_16x16x32_bf16 v[84:87], a[40:43], a[80:83], v[84:87]
    ds_read_b64_tr_b16 a[182:183], v172 offset:2048
    v_mfma_f32_16x16x32_bf16 v[84:87], a[44:47], a[84:87], v[84:87]
    ds_read_b128 a[244:247], v177 offset:28672
    v_mfma_f32_16x16x32_bf16 v[116:119], a[40:43], a[88:91], v[116:119]
    v_mfma_f32_16x16x32_bf16 v[116:119], a[44:47], a[92:95], v[116:119]
    ds_read_b64_tr_b16 a[188:189], v173 offset:0
    buffer_load_dwordx4 v180, s[12:15], s56 offen offset:2048 lds
    v_mfma_f32_16x16x32_bf16 v[148:151], a[40:43], a[96:99], v[148:151]
    v_mfma_f32_16x16x32_bf16 v[148:151], a[44:47], a[100:103], v[148:151]
    ds_read_b64_tr_b16 a[190:191], v173 offset:2048
    v_mfma_f32_16x16x32_bf16 v[24:27], a[48:51], a[64:67], v[24:27]
    ds_read_b64_tr_b16 a[196:197], v174 offset:0
    v_mfma_f32_16x16x32_bf16 v[24:27], a[52:55], a[68:71], v[24:27]
    v_mfma_f32_16x16x32_bf16 v[56:59], a[48:51], a[72:75], v[56:59]
    ds_read_b64_tr_b16 a[198:199], v174 offset:2048
    buffer_load_dwordx4 v181, s[12:15], s56 offen offset:3072 lds
    s_add_u32 s56, s56, 0x40000
    s_cmp_ge_u32 s57, 1280
    s_cselect_b32 s56, 0, s56
    s_cselect_b32 s57, 0, s57
    v_mfma_f32_16x16x32_bf16 v[56:59], a[52:55], a[76:79], v[56:59]
    ds_read_b64_tr_b16 a[204:205], v175 offset:0
    v_mfma_f32_16x16x32_bf16 v[88:91], a[48:51], a[80:83], v[88:91]
    v_mfma_f32_16x16x32_bf16 v[88:91], a[52:55], a[84:87], v[88:91]
    ds_read_b64_tr_b16 a[206:207], v175 offset:2048
    v_mfma_f32_16x16x32_bf16 v[120:123], a[48:51], a[88:91], v[120:123]
    v_mfma_f32_16x16x32_bf16 v[120:123], a[52:55], a[92:95], v[120:123]
    global_load_dword v197, v[212:213], off
    v_mfma_f32_16x16x32_bf16 v[152:155], a[48:51], a[96:99], v[152:155]
    v_mfma_f32_16x16x32_bf16 v[152:155], a[52:55], a[100:103], v[152:155]
    v_mfma_f32_16x16x32_bf16 v[28:31], a[56:59], a[64:67], v[28:31]
    v_mfma_f32_16x16x32_bf16 v[28:31], a[60:63], a[68:71], v[28:31]
    v_mfma_f32_16x16x32_bf16 v[60:63], a[56:59], a[72:75], v[60:63]
    global_load_dword v197, v[214:215], off
    v_mfma_f32_16x16x32_bf16 v[60:63], a[60:63], a[76:79], v[60:63]
    v_mfma_f32_16x16x32_bf16 v[92:95], a[56:59], a[80:83], v[92:95]
    v_mfma_f32_16x16x32_bf16 v[92:95], a[60:63], a[84:87], v[92:95]
    v_mfma_f32_16x16x32_bf16 v[124:127], a[56:59], a[88:91], v[124:127]
    v_mfma_f32_16x16x32_bf16 v[124:127], a[60:63], a[92:95], v[124:127]
    v_mfma_f32_16x16x32_bf16 v[156:159], a[56:59], a[96:99], v[156:159]
    v_mfma_f32_16x16x32_bf16 v[156:159], a[60:63], a[100:103], v[156:159]
    s_waitcnt vmcnt(15) lgkmcnt(0)
    v_mfma_f32_16x16x32_bf16 v[0:3], a[144:147], a[208:211], v[0:3]
    s_barrier
    ds_read_b64_tr_b16 a[0:1], v160 offset:16384
    v_mfma_f32_16x16x32_bf16 v[0:3], a[148:151], a[212:215], v[0:3]
    ds_read_b64_tr_b16 a[2:3], v160 offset:18432
    v_mfma_f32_16x16x32_bf16 v[32:35], a[144:147], a[216:219], v[32:35]
    s_add_u32 m0, s61, 0
    s_nop 0
    buffer_load_dwordx4 v237, s[24:27], s75 offen offset:0 nt lds
    v_mfma_f32_16x16x32_bf16 v[32:35], a[148:151], a[220:223], v[32:35]
    ds_read_b128 a[64:67], v176 offset:40960
    v_mfma_f32_16x16x32_bf16 v[64:67], a[144:147], a[224:227], v[64:67]
    ds_read_b64_tr_b16 a[8:9], v161 offset:16384
    v_mfma_f32_16x16x32_bf16 v[64:67], a[148:151], a[228:231], v[64:67]
    v_mfma_f32_16x16x32_bf16 v[96:99], a[144:147], a[232:235], v[96:99]
    ds_read_b64_tr_b16 a[10:11], v161 offset:18432
    v_mfma_f32_16x16x32_bf16 v[96:99], a[148:151], a[236:239], v[96:99]
    ds_read_b128 a[72:75], v176 offset:43008
    v_mfma_f32_16x16x32_bf16 v[128:131], a[144:147], a[240:243], v[128:131]
    v_mfma_f32_16x16x32_bf16 v[128:131], a[148:151], a[244:247], v[128:131]
    ds_read_b64_tr_b16 a[16:17], v162 offset:16384
    v_mfma_f32_16x16x32_bf16 v[4:7], a[152:155], a[208:211], v[4:7]
    v_mfma_f32_16x16x32_bf16 v[4:7], a[156:159], a[212:215], v[4:7]
    ds_read_b64_tr_b16 a[18:19], v162 offset:18432
    buffer_load_dwordx4 v238, s[24:27], s75 offen offset:1024 nt lds
    v_mfma_f32_16x16x32_bf16 v[36:39], a[152:155], a[216:219], v[36:39]
    ds_read_b128 a[80:83], v176 offset:45056
    v_mfma_f32_16x16x32_bf16 v[36:39], a[156:159], a[220:223], v[36:39]
    v_mfma_f32_16x16x32_bf16 v[68:71], a[152:155], a[224:227], v[68:71]
    ds_read_b64_tr_b16 a[24:25], v163 offset:16384
    v_mfma_f32_16x16x32_bf16 v[68:71], a[156:159], a[228:231], v[68:71]
    ds_read_b64_tr_b16 a[26:27], v163 offset:18432
    v_mfma_f32_16x16x32_bf16 v[100:103], a[152:155], a[232:235], v[100:103]
    v_mfma_f32_16x16x32_bf16 v[100:103], a[156:159], a[236:239], v[100:103]
    ds_read_b128 a[88:91], v176 offset:47104
    v_mfma_f32_16x16x32_bf16 v[132:135], a[152:155], a[240:243], v[132:135]
    v_mfma_f32_16x16x32_bf16 v[132:135], a[156:159], a[244:247], v[132:135]
    ds_read_b64_tr_b16 a[32:33], v164 offset:16384
    v_mfma_f32_16x16x32_bf16 v[8:11], a[160:163], a[208:211], v[8:11]
    ds_read_b64_tr_b16 a[34:35], v164 offset:18432
    v_mfma_f32_16x16x32_bf16 v[8:11], a[164:167], a[212:215], v[8:11]
    buffer_load_dwordx4 v239, s[24:27], s75 offen offset:2048 nt lds
    v_mfma_f32_16x16x32_bf16 v[40:43], a[160:163], a[216:219], v[40:43]
    ds_read_b128 a[96:99], v176 offset:49152
    v_mfma_f32_16x16x32_bf16 v[40:43], a[164:167], a[220:223], v[40:43]
    ds_read_b64_tr_b16 a[40:41], v165 offset:16384
    v_mfma_f32_16x16x32_bf16 v[72:75], a[160:163], a[224:227], v[72:75]
    v_mfma_f32_16x16x32_bf16 v[72:75], a[164:167], a[228:231], v[72:75]
    ds_read_b64_tr_b16 a[42:43], v165 offset:18432
    v_mfma_f32_16x16x32_bf16 v[104:107], a[160:163], a[232:235], v[104:107]
    v_mfma_f32_16x16x32_bf16 v[104:107], a[164:167], a[236:239], v[104:107]
    ds_read_b64_tr_b16 a[48:49], v166 offset:16384
    v_mfma_f32_16x16x32_bf16 v[136:139], a[160:163], a[240:243], v[136:139]
    ds_read_b64_tr_b16 a[50:51], v166 offset:18432
    v_mfma_f32_16x16x32_bf16 v[136:139], a[164:167], a[244:247], v[136:139]
    v_mfma_f32_16x16x32_bf16 v[12:15], a[168:171], a[208:211], v[12:15]
    ds_read_b64_tr_b16 a[56:57], v167 offset:16384
    buffer_load_dwordx4 v240, s[24:27], s75 offen offset:3072 nt lds
    v_mfma_f32_16x16x32_bf16 v[12:15], a[172:175], a[212:215], v[12:15]
    ds_read_b64_tr_b16 a[58:59], v167 offset:18432
    v_mfma_f32_16x16x32_bf16 v[44:47], a[168:171], a[216:219], v[44:47]
    v_mfma_f32_16x16x32_bf16 v[44:47], a[172:175], a[220:223], v[44:47]
    ds_read_b64_tr_b16 a[4:5], v168 offset:16384
    v_mfma_f32_16x16x32_bf16 v[76:79], a[168:171], a[224:227], v[76:79]
    v_mfma_f32_16x16x32_bf16 v[76:79], a[172:175], a[228:231], v[76:79]
    ds_read_b64_tr_b16 a[6:7], v168 offset:18432
    v_mfma_f32_16x16x32_bf16 v[108:111], a[168:171], a[232:235], v[108:111]
    ds_read_b128 a[68:71], v177 offset:40960
    v_mfma_f32_16x16x32_bf16 v[108:111], a[172:175], a[236:239], v[108:111]
    v_mfma_f32_16x16x32_bf16 v[140:143], a[168:171], a[240:243], v[140:143]
    ds_read_b64_tr_b16 a[12:13], v169 offset:16384
    v_mfma_f32_16x16x32_bf16 v[140:143], a[172:175], a[244:247], v[140:143]
    ds_read_b64_tr_b16 a[14:15], v169 offset:18432
    v_mfma_f32_16x16x32_bf16 v[16:19], a[176:179], a[208:211], v[16:19]
    s_add_u32 m0, s61, 8192
    s_nop 0
    buffer_load_dwordx4 v244, s[16:19], s75 offen offset:0 nt lds
    v_mfma_f32_16x16x32_bf16 v[16:19], a[180:183], a[212:215], v[16:19]
    ds_read_b128 a[76:79], v177 offset:43008
    v_mfma_f32_16x16x32_bf16 v[48:51], a[176:179], a[216:219], v[48:51]
    v_mfma_f32_16x16x32_bf16 v[48:51], a[180:183], a[220:223], v[48:51]
    ds_read_b64_tr_b16 a[20:21], v170 offset:16384
    v_mfma_f32_16x16x32_bf16 v[80:83], a[176:179], a[224:227], v[80:83]
    ds_read_b64_tr_b16 a[22:23], v170 offset:18432
    v_mfma_f32_16x16x32_bf16 v[80:83], a[180:183], a[228:231], v[80:83]
    v_mfma_f32_16x16x32_bf16 v[112:115], a[176:179], a[232:235], v[112:115]
    ds_read_b128 a[84:87], v177 offset:45056
    v_mfma_f32_16x16x32_bf16 v[112:115], a[180:183], a[236:239], v[112:115]
    ds_read_b64_tr_b16 a[28:29], v171 offset:16384
    v_mfma_f32_16x16x32_bf16 v[144:147], a[176:179], a[240:243], v[144:147]
    v_mfma_f32_16x16x32_bf16 v[144:147], a[180:183], a[244:247], v[144:147]
    ds_read_b64_tr_b16 a[30:31], v171 offset:18432
    buffer_load_dwordx4 v253, s[16:19], s75 offen offset:1024 nt lds
    v_mfma_f32_16x16x32_bf16 v[20:23], a[184:187], a[208:211], v[20:23]
    v_mfma_f32_16x16x32_bf16 v[20:23], a[188:191], a[212:215], v[20:23]
    ds_read_b128 a[92:95], v177 offset:47104
    v_mfma_f32_16x16x32_bf16 v[52:55], a[184:187], a[216:219], v[52:55]
    ds_read_b64_tr_b16 a[36:37], v172 offset:16384
    v_mfma_f32_16x16x32_bf16 v[52:55], a[188:191], a[220:223], v[52:55]
    v_mfma_f32_16x16x32_bf16 v[84:87], a[184:187], a[224:227], v[84:87]
    ds_read_b64_tr_b16 a[38:39], v172 offset:18432
    v_mfma_f32_16x16x32_bf16 v[84:87], a[188:191], a[228:231], v[84:87]
    ds_read_b128 a[100:103], v177 offset:49152
    v_mfma_f32_16x16x32_bf16 v[116:119], a[184:187], a[232:235], v[116:119]
    v_mfma_f32_16x16x32_bf16 v[116:119], a[188:191], a[236:239], v[116:119]
    ds_read_b64_tr_b16 a[44:45], v173 offset:16384
    v_mfma_f32_16x16x32_bf16 v[148:151], a[184:187], a[240:243], v[148:151]
    v_mfma_f32_16x16x32_bf16 v[148:151], a[188:191], a[244:247], v[148:151]
    ds_read_b64_tr_b16 a[46:47], v173 offset:18432
    buffer_load_dwordx4 v244, s[16:19], s75 offen offset:2048 nt lds
    v_mfma_f32_16x16x32_bf16 v[24:27], a[192:195], a[208:211], v[24:27]
    ds_read_b64_tr_b16 a[52:53], v174 offset:16384
    v_mfma_f32_16x16x32_bf16 v[24:27], a[196:199], a[212:215], v[24:27]
    v_mfma_f32_16x16x32_bf16 v[56:59], a[192:195], a[216:219], v[56:59]
    ds_read_b64_tr_b16 a[54:55], v174 offset:18432
    v_mfma_f32_16x16x32_bf16 v[56:59], a[196:199], a[220:223], v[56:59]
    ds_read_b64_tr_b16 a[60:61], v175 offset:16384
    v_mfma_f32_16x16x32_bf16 v[88:91], a[192:195], a[224:227], v[88:91]
    v_mfma_f32_16x16x32_bf16 v[88:91], a[196:199], a[228:231], v[88:91]
    ds_read_b64_tr_b16 a[62:63], v175 offset:18432
    v_mfma_f32_16x16x32_bf16 v[120:123], a[192:195], a[232:235], v[120:123]
    v_mfma_f32_16x16x32_bf16 v[120:123], a[196:199], a[236:239], v[120:123]
    v_mfma_f32_16x16x32_bf16 v[152:155], a[192:195], a[240:243], v[152:155]
    buffer_load_dwordx4 v253, s[16:19], s75 offen offset:3072 nt lds
    s_add_u32 s75, s75, 8192
    s_and_b32 s75, s75, 0x1e000
    s_or_b32 s75, s75, s60
    v_mfma_f32_16x16x32_bf16 v[152:155], a[196:199], a[244:247], v[152:155]
    v_mfma_f32_16x16x32_bf16 v[28:31], a[200:203], a[208:211], v[28:31]
    v_mfma_f32_16x16x32_bf16 v[28:31], a[204:207], a[212:215], v[28:31]
    v_mfma_f32_16x16x32_bf16 v[60:63], a[200:203], a[216:219], v[60:63]
    v_mfma_f32_16x16x32_bf16 v[60:63], a[204:207], a[220:223], v[60:63]
    v_mfma_f32_16x16x32_bf16 v[92:95], a[200:203], a[224:227], v[92:95]
    v_mfma_f32_16x16x32_bf16 v[92:95], a[204:207], a[228:231], v[92:95]
    v_mfma_f32_16x16x32_bf16 v[124:127], a[200:203], a[232:235], v[124:127]
    v_mfma_f32_16x16x32_bf16 v[124:127], a[204:207], a[236:239], v[124:127]
    v_mfma_f32_16x16x32_bf16 v[156:159], a[200:203], a[240:243], v[156:159]
    v_mfma_f32_16x16x32_bf16 v[156:159], a[204:207], a[244:247], v[156:159]
    s_waitcnt vmcnt(10) lgkmcnt(0)
    v_mfma_f32_16x16x32_bf16 v[0:3], a[0:3], a[64:67], v[0:3]
    s_barrier
    ds_read_b64_tr_b16 a[144:145], v160 offset:32768
    v_mfma_f32_16x16x32_bf16 v[0:3], a[4:7], a[68:71], v[0:3]
    ds_read_b64_tr_b16 a[146:147], v160 offset:34816
    v_mfma_f32_16x16x32_bf16 v[32:35], a[0:3], a[72:75], v[32:35]
    s_add_u32 m0, s61, 16384
    s_nop 0
    buffer_load_dwordx4 v237, s[24:27], s75 offen offset:0 nt lds
    v_mfma_f32_16x16x32_bf16 v[32:35], a[4:7], a[76:79], v[32:35]
    ds_read_b128 a[208:211], v176 offset:0
    v_mfma_f32_16x16x32_bf16 v[64:67], a[0:3], a[80:83], v[64:67]
    ds_read_b64_tr_b16 a[152:153], v161 offset:32768
    v_mfma_f32_16x16x32_bf16 v[64:67], a[4:7], a[84:87], v[64:67]
    v_mfma_f32_16x16x32_bf16 v[96:99], a[0:3], a[88:91], v[96:99]
    ds_read_b64_tr_b16 a[154:155], v161 offset:34816
    v_mfma_f32_16x16x32_bf16 v[96:99], a[4:7], a[92:95], v[96:99]
    ds_read_b128 a[216:219], v176 offset:2048
    v_mfma_f32_16x16x32_bf16 v[128:131], a[0:3], a[96:99], v[128:131]
    v_mfma_f32_16x16x32_bf16 v[128:131], a[4:7], a[100:103], v[128:131]
    ds_read_b64_tr_b16 a[160:161], v162 offset:32768
    v_mfma_f32_16x16x32_bf16 v[4:7], a[8:11], a[64:67], v[4:7]
    v_mfma_f32_16x16x32_bf16 v[4:7], a[12:15], a[68:71], v[4:7]
    ds_read_b64_tr_b16 a[162:163], v162 offset:34816
    buffer_load_dwordx4 v238, s[24:27], s75 offen offset:1024 nt lds
    v_mfma_f32_16x16x32_bf16 v[36:39], a[8:11], a[72:75], v[36:39]
    ds_read_b128 a[224:227], v176 offset:4096
    v_mfma_f32_16x16x32_bf16 v[36:39], a[12:15], a[76:79], v[36:39]
    v_mfma_f32_16x16x32_bf16 v[68:71], a[8:11], a[80:83], v[68:71]
    ds_read_b64_tr_b16 a[168:169], v163 offset:32768
    v_mfma_f32_16x16x32_bf16 v[68:71], a[12:15], a[84:87], v[68:71]
    ds_read_b64_tr_b16 a[170:171], v163 offset:34816
    v_mfma_f32_16x16x32_bf16 v[100:103], a[8:11], a[88:91], v[100:103]
    v_mfma_f32_16x16x32_bf16 v[100:103], a[12:15], a[92:95], v[100:103]
    ds_read_b128 a[232:235], v176 offset:6144
    v_mfma_f32_16x16x32_bf16 v[132:135], a[8:11], a[96:99], v[132:135]
    v_mfma_f32_16x16x32_bf16 v[132:135], a[12:15], a[100:103], v[132:135]
    ds_read_b64_tr_b16 a[176:177], v164 offset:32768
    v_mfma_f32_16x16x32_bf16 v[8:11], a[16:19], a[64:67], v[8:11]
    ds_read_b64_tr_b16 a[178:179], v164 offset:34816
    v_mfma_f32_16x16x32_bf16 v[8:11], a[20:23], a[68:71], v[8:11]
    buffer_load_dwordx4 v239, s[24:27], s75 offen offset:2048 nt lds
    v_mfma_f32_16x16x32_bf16 v[40:43], a[16:19], a[72:75], v[40:43]
    ds_read_b128 a[240:243], v176 offset:8192
    v_mfma_f32_16x16x32_bf16 v[40:43], a[20:23], a[76:79], v[40:43]
    ds_read_b64_tr_b16 a[184:185], v165 offset:32768
    v_mfma_f32_16x16x32_bf16 v[72:75], a[16:19], a[80:83], v[72:75]
    v_mfma_f32_16x16x32_bf16 v[72:75], a[20:23], a[84:87], v[72:75]
    ds_read_b64_tr_b16 a[186:187], v165 offset:34816
    v_mfma_f32_16x16x32_bf16 v[104:107], a[16:19], a[88:91], v[104:107]
    v_mfma_f32_16x16x32_bf16 v[104:107], a[20:23], a[92:95], v[104:107]
    ds_read_b64_tr_b16 a[192:193], v166 offset:32768
    v_mfma_f32_16x16x32_bf16 v[136:139], a[16:19], a[96:99], v[136:139]
    ds_read_b64_tr_b16 a[194:195], v166 offset:34816
    v_mfma_f32_16x16x32_bf16 v[136:139], a[20:23], a[100:103], v[136:139]
    v_mfma_f32_16x16x32_bf16 v[12:15], a[24:27], a[64:67], v[12:15]
    ds_read_b64_tr_b16 a[200:201], v167 offset:32768
    buffer_load_dwordx4 v240, s[24:27], s75 offen offset:3072 nt lds
    v_mfma_f32_16x16x32_bf16 v[12:15], a[28:31], a[68:71], v[12:15]
    ds_read_b64_tr_b16 a[202:203], v167 offset:34816
    v_mfma_f32_16x16x32_bf16 v[44:47], a[24:27], a[72:75], v[44:47]
    v_mfma_f32_16x16x32_bf16 v[44:47], a[28:31], a[76:79], v[44:47]
    ds_read_b64_tr_b16 a[148:149], v160 offset:49152
    v_mfma_f32_16x16x32_bf16 v[76:79], a[24:27], a[80:83], v[76:79]
    v_mfma_f32_16x16x32_bf16 v[76:79], a[28:31], a[84:87], v[76:79]
    ds_read_b64_tr_b16 a[150:151], v160 offset:51200
    v_mfma_f32_16x16x32_bf16 v[108:111], a[24:27], a[88:91], v[108:111]
    ds_read_b128 a[212:215], v177 offset:0
    v_mfma_f32_16x16x32_bf16 v[108:111], a[28:31], a[92:95], v[108:111]
    v_mfma_f32_16x16x32_bf16 v[140:143], a[24:27], a[96:99], v[140:143]
    ds_read_b64_tr_b16 a[156:157], v161 offset:49152
    v_mfma_f32_16x16x32_bf16 v[140:143], a[28:31], a[100:103], v[140:143]
    ds_read_b64_tr_b16 a[158:159], v161 offset:51200
    v_mfma_f32_16x16x32_bf16 v[16:19], a[32:35], a[64:67], v[16:19]
    s_add_u32 m0, s61, 24576
    s_nop 0
    buffer_load_dwordx4 v244, s[16:19], s75 offen offset:0 nt lds
    v_mfma_f32_16x16x32_bf16 v[16:19], a[36:39], a[68:71], v[16:19]
    ds_read_b128 a[220:223], v177 offset:2048
    v_mfma_f32_16x16x32_bf16 v[48:51], a[32:35], a[72:75], v[48:51]
    v_mfma_f32_16x16x32_bf16 v[48:51], a[36:39], a[76:79], v[48:51]
    ds_read_b64_tr_b16 a[164:165], v162 offset:49152
    v_mfma_f32_16x16x32_bf16 v[80:83], a[32:35], a[80:83], v[80:83]
    ds_read_b64_tr_b16 a[166:167], v162 offset:51200
    v_mfma_f32_16x16x32_bf16 v[80:83], a[36:39], a[84:87], v[80:83]
    v_mfma_f32_16x16x32_bf16 v[112:115], a[32:35], a[88:91], v[112:115]
    ds_read_b128 a[228:231], v177 offset:4096
    v_mfma_f32_16x16x32_bf16 v[112:115], a[36:39], a[92:95], v[112:115]
    ds_read_b64_tr_b16 a[172:173], v163 offset:49152
    v_mfma_f32_16x16x32_bf16 v[144:147], a[32:35], a[96:99], v[144:147]
    v_mfma_f32_16x16x32_bf16 v[144:147], a[36:39], a[100:103], v[144:147]
    ds_read_b64_tr_b16 a[174:175], v163 offset:51200
    buffer_load_dwordx4 v253, s[16:19], s75 offen offset:1024 nt lds
    v_mfma_f32_16x16x32_bf16 v[20:23], a[40:43], a[64:67], v[20:23]
    v_mfma_f32_16x16x32_bf16 v[20:23], a[44:47], a[68:71], v[20:23]
    ds_read_b128 a[236:239], v177 offset:6144
    v_mfma_f32_16x16x32_bf16 v[52:55], a[40:43], a[72:75], v[52:55]
    ds_read_b64_tr_b16 a[180:181], v164 offset:49152
    v_mfma_f32_16x16x32_bf16 v[52:55], a[44:47], a[76:79], v[52:55]
    v_mfma_f32_16x16x32_bf16 v[84:87], a[40:43], a[80:83], v[84:87]
    ds_read_b64_tr_b16 a[182:183], v164 offset:51200
    v_mfma_f32_16x16x32_bf16 v[84:87], a[44:47], a[84:87], v[84:87]
    ds_read_b128 a[244:247], v177 offset:8192
    v_mfma_f32_16x16x32_bf16 v[116:119], a[40:43], a[88:91], v[116:119]
    v_mfma_f32_16x16x32_bf16 v[116:119], a[44:47], a[92:95], v[116:119]
    ds_read_b64_tr_b16 a[188:189], v165 offset:49152
    v_mfma_f32_16x16x32_bf16 v[148:151], a[40:43], a[96:99], v[148:151]
    v_mfma_f32_16x16x32_bf16 v[148:151], a[44:47], a[100:103], v[148:151]
    ds_read_b64_tr_b16 a[190:191], v165 offset:51200
    buffer_load_dwordx4 v244, s[16:19], s75 offen offset:2048 nt lds
    v_mfma_f32_16x16x32_bf16 v[24:27], a[48:51], a[64:67], v[24:27]
    ds_read_b64_tr_b16 a[196:197], v166 offset:49152
    v_mfma_f32_16x16x32_bf16 v[24:27], a[52:55], a[68:71], v[24:27]
    v_mfma_f32_16x16x32_bf16 v[56:59], a[48:51], a[72:75], v[56:59]
    ds_read_b64_tr_b16 a[198:199], v166 offset:51200
    v_mfma_f32_16x16x32_bf16 v[56:59], a[52:55], a[76:79], v[56:59]
    ds_read_b64_tr_b16 a[204:205], v167 offset:49152
    v_mfma_f32_16x16x32_bf16 v[88:91], a[48:51], a[80:83], v[88:91]
    v_mfma_f32_16x16x32_bf16 v[88:91], a[52:55], a[84:87], v[88:91]
    ds_read_b64_tr_b16 a[206:207], v167 offset:51200
    v_mfma_f32_16x16x32_bf16 v[120:123], a[48:51], a[88:91], v[120:123]
    v_mfma_f32_16x16x32_bf16 v[120:123], a[52:55], a[92:95], v[120:123]
    v_mfma_f32_16x16x32_bf16 v[152:155], a[48:51], a[96:99], v[152:155]
    buffer_load_dwordx4 v253, s[16:19], s75 offen offset:3072 nt lds
    s_add_u32 s75, s75, 8192
    s_and_b32 s75, s75, 0x1e000
    s_or_b32 s75, s75, s60
    v_mfma_f32_16x16x32_bf16 v[152:155], a[52:55], a[100:103], v[152:155]
    v_mfma_f32_16x16x32_bf16 v[28:31], a[56:59], a[64:67], v[28:31]
    v_mfma_f32_16x16x32_bf16 v[28:31], a[60:63], a[68:71], v[28:31]
    v_mfma_f32_16x16x32_bf16 v[60:63], a[56:59], a[72:75], v[60:63]
    v_mfma_f32_16x16x32_bf16 v[60:63], a[60:63], a[76:79], v[60:63]
    v_mfma_f32_16x16x32_bf16 v[92:95], a[56:59], a[80:83], v[92:95]
    v_mfma_f32_16x16x32_bf16 v[92:95], a[60:63], a[84:87], v[92:95]
    v_mfma_f32_16x16x32_bf16 v[124:127], a[56:59], a[88:91], v[124:127]
    v_mfma_f32_16x16x32_bf16 v[124:127], a[60:63], a[92:95], v[124:127]
    v_mfma_f32_16x16x32_bf16 v[156:159], a[56:59], a[96:99], v[156:159]
    v_mfma_f32_16x16x32_bf16 v[156:159], a[60:63], a[100:103], v[156:159]
    s_waitcnt vmcnt(8) lgkmcnt(0)
    v_mfma_f32_16x16x32_bf16 v[0:3], a[144:147], a[208:211], v[0:3]
    s_barrier
    v_readfirstlane_b32 s80, v188
    v_readfirstlane_b32 s81, v189
    v_mfma_f32_16x16x32_bf16 v[0:3], a[148:151], a[212:215], v[0:3]
    s_nop 1
    s_cmp_eq_u32 s80, 0
    s_cbranch_scc1 K1_TWAIT
K1_TGO:
    v_mfma_f32_16x16x32_bf16 v[4:7], a[152:155], a[208:211], v[4:7]
    ds_read_b128 a[0:3], v225 offset:0
    ds_read_b128 a[4:7], v226 offset:0
    v_mfma_f32_16x16x32_bf16 v[4:7], a[156:159], a[212:215], v[4:7]
    ds_read_b128 a[8:11], v227 offset:0
    v_mfma_f32_16x16x32_bf16 v[8:11], a[160:163], a[208:211], v[8:11]
    ds_read_b128 a[12:15], v228 offset:0
    ds_read_b128 a[16:19], v225 offset:4096
    v_mfma_f32_16x16x32_bf16 v[8:11], a[164:167], a[212:215], v[8:11]
    ds_read_b128 a[20:23], v226 offset:4096
    v_mfma_f32_16x16x32_bf16 v[12:15], a[168:171], a[208:211], v[12:15]
    ds_read_b128 a[24:27], v227 offset:4096
    ds_read_b128 a[28:31], v228 offset:4096
    v_mfma_f32_16x16x32_bf16 v[12:15], a[172:175], a[212:215], v[12:15]
    ds_read_b64_tr_b16 a[32:33], v229 offset:0
    v_mfma_f32_16x16x32_bf16 v[16:19], a[176:179], a[208:211], v[16:19]
    s_add_u32 m0, s61, 32768
    s_nop 0
    buffer_load_dwordx4 v237, s[24:27], s75 offen offset:0 nt lds
    v_mfma_f32_16x16x32_bf16 v[16:19], a[180:183], a[212:215], v[16:19]
    v_mfma_f32_16x16x32_bf16 v[20:23], a[184:187], a[208:211], v[20:23]
    ds_read_b64_tr_b16 a[34:35], v229 offset:4096
    ds_read_b64_tr_b16 a[36:37], v230 offset:0
    v_mfma_f32_16x16x32_bf16 v[20:23], a[188:191], a[212:215], v[20:23]
    ds_read_b64_tr_b16 a[38:39], v230 offset:4096
    ds_read_b64_tr_b16 a[40:41], v231 offset:0
    v_mfma_f32_16x16x32_bf16 v[24:27], a[192:195], a[208:211], v[24:27]
    ds_read_b64_tr_b16 a[42:43], v231 offset:4096
    v_mfma_f32_16x16x32_bf16 v[24:27], a[196:199], a[212:215], v[24:27]
    ds_read_b64_tr_b16 a[44:45], v232 offset:0
    ds_read_b64_tr_b16 a[46:47], v232 offset:4096
    v_mfma_f32_16x16x32_bf16 v[28:31], a[200:203], a[208:211], v[28:31]
    ds_read_b64_tr_b16 a[48:49], v233 offset:0
    v_mfma_f32_16x16x32_bf16 v[28:31], a[204:207], a[212:215], v[28:31]
    ds_read_b64_tr_b16 a[50:51], v233 offset:4096
    ds_read_b64_tr_b16 a[52:53], v234 offset:0
    v_mfma_f32_16x16x32_bf16 v[32:35], a[144:147], a[216:219], v[32:35]
    ds_read_b64_tr_b16 a[54:55], v234 offset:4096
    v_mfma_f32_16x16x32_bf16 v[32:35], a[148:151], a[220:223], v[32:35]
    ds_read_b64_tr_b16 a[56:57], v235 offset:0
    buffer_load_dwordx4 v238, s[24:27], s75 offen offset:1024 nt lds
    v_mfma_f32_16x16x32_bf16 v[36:39], a[152:155], a[216:219], v[36:39]
    ds_read_b64_tr_b16 a[58:59], v235 offset:4096
    v_mfma_f32_16x16x32_bf16 v[36:39], a[156:159], a[220:223], v[36:39]
    ds_read_b64_tr_b16 a[60:61], v236 offset:0
    ds_read_b64_tr_b16 a[62:63], v236 offset:4096
    v_mfma_f32_16x16x32_bf16 v[40:43], a[160:163], a[216:219], v[40:43]
    v_pk_mul_f32 v[0:1], v[0:1], s[76:77]
    v_pk_mul_f32 v[2:3], v[2:3], s[76:77]
    v_pk_mul_f32 v[4:5], v[4:5], s[76:77]
    v_mfma_f32_16x16x32_bf16 v[40:43], a[164:167], a[220:223], v[40:43]
    v_pk_mul_f32 v[6:7], v[6:7], s[76:77]
    v_cvt_pk_bf16_f32 v0, v0, v1
    v_mfma_f32_16x16x32_bf16 v[44:47], a[168:171], a[216:219], v[44:47]
    v_cvt_pk_bf16_f32 v1, v2, v3
    v_cvt_pk_bf16_f32 v2, v4, v5
    v_cvt_pk_bf16_f32 v3, v6, v7
    v_mfma_f32_16x16x32_bf16 v[44:47], a[172:175], a[220:223], v[44:47]
    v_pk_mul_f32 v[8:9], v[8:9], s[76:77]
    v_pk_mul_f32 v[10:11], v[10:11], s[76:77]
    v_mfma_f32_16x16x32_bf16 v[48:51], a[176:179], a[216:219], v[48:51]
    v_pk_mul_f32 v[12:13], v[12:13], s[76:77]
    v_pk_mul_f32 v[14:15], v[14:15], s[76:77]
    v_cvt_pk_bf16_f32 v8, v8, v9
    v_mfma_f32_16x16x32_bf16 v[48:51], a[180:183], a[220:223], v[48:51]
    v_cvt_pk_bf16_f32 v9, v10, v11
    v_cvt_pk_bf16_f32 v10, v12, v13
    v_mfma_f32_16x16x32_bf16 v[52:55], a[184:187], a[216:219], v[52:55]
    buffer_load_dwordx4 v239, s[24:27], s75 offen offset:2048 nt lds
    v_cvt_pk_bf16_f32 v11, v14, v15
    v_pk_mul_f32 v[16:17], v[16:17], s[76:77]
    v_mfma_f32_16x16x32_bf16 v[52:55], a[188:191], a[220:223], v[52:55]
    v_pk_mul_f32 v[18:19], v[18:19], s[76:77]
    v_pk_mul_f32 v[20:21], v[20:21], s[76:77]
    v_mfma_f32_16x16x32_bf16 v[56:59], a[192:195], a[216:219], v[56:59]
    v_pk_mul_f32 v[22:23], v[22:23], s[76:77]
    v_cvt_pk_bf16_f32 v16, v16, v17
    v_cvt_pk_bf16_f32 v17, v18, v19
    v_mfma_f32_16x16x32_bf16 v[56:59], a[196:199], a[220:223], v[56:59]
    v_cvt_pk_bf16_f32 v18, v20, v21
    v_cvt_pk_bf16_f32 v19, v22, v23
    v_mfma_f32_16x16x32_bf16 v[60:63], a[200:203], a[216:219], v[60:63]
    v_pk_mul_f32 v[24:25], v[24:25], s[76:77]
    v_pk_mul_f32 v[26:27], v[26:27], s[76:77]
    v_pk_mul_f32 v[28:29], v[28:29], s[76:77]
    v_mfma_f32_16x16x32_bf16 v[60:63], a[204:207], a[220:223], v[60:63]
    v_pk_mul_f32 v[30:31], v[30:31], s[76:77]
    v_cvt_pk_bf16_f32 v24, v24, v25
    v_mfma_f32_16x16x32_bf16 v[64:67], a[144:147], a[224:227], v[64:67]
    v_cvt_pk_bf16_f32 v25, v26, v27
    v_cvt_pk_bf16_f32 v26, v28, v29
    v_cvt_pk_bf16_f32 v27, v30, v31
    v_mfma_f32_16x16x32_bf16 v[64:67], a[148:151], a[228:231], v[64:67]
    v_mfma_f32_16x16x32_bf16 v[68:71], a[152:155], a[224:227], v[68:71]
    v_mfma_f32_16x16x32_bf16 v[68:71], a[156:159], a[228:231], v[68:71]
    s_mov_b64 exec, s[78:79]
    v_swap_b32 v0, v2
    v_swap_b32 v1, v3
    v_swap_b32 v8, v10
    v_swap_b32 v9, v11
    v_swap_b32 v16, v18
    v_swap_b32 v17, v19
    v_swap_b32 v24, v26
    v_swap_b32 v25, v27
    s_mov_b64 exec, -1
    v_mfma_f32_16x16x32_bf16 v[72:75], a[160:163], a[224:227], v[72:75]
    v_mfma_f32_16x16x32_bf16 v[72:75], a[164:167], a[228:231], v[72:75]
    v_accvgpr_write_b32 a128, v0
    v_accvgpr_write_b32 a129, v1
    v_mfma_f32_16x16x32_bf16 v[76:79], a[168:171], a[224:227], v[76:79]
    buffer_load_dwordx4 v240, s[24:27], s75 offen offset:3072 nt lds
    v_accvgpr_write_b32 a130, v2
    v_accvgpr_write_b32 a131, v3
    v_mfma_f32_16x16x32_bf16 v[76:79], a[172:175], a[228:231], v[76:79]
    v_accvgpr_write_b32 a132, v8
    v_accvgpr_write_b32 a133, v9
    v_mfma_f32_16x16x32_bf16 v[80:83], a[176:179], a[224:227], v[80:83]
    v_accvgpr_write_b32 a134, v10
    v_accvgpr_write_b32 a135, v11
    v_accvgpr_write_b32 a136, v16
    v_mfma_f32_16x16x32_bf16 v[80:83], a[180:183], a[228:231], v[80:83]
    v_accvgpr_write_b32 a137, v17
    v_accvgpr_write_b32 a138, v18
    v_mfma_f32_16x16x32_bf16 v[84:87], a[184:187], a[224:227], v[84:87]
    v_accvgpr_write_b32 a139, v19
    v_accvgpr_write_b32 a140, v24
    v_accvgpr_write_b32 a141, v25
    v_mfma_f32_16x16x32_bf16 v[84:87], a[188:191], a[228:231], v[84:87]
    v_accvgpr_write_b32 a142, v26
    v_accvgpr_write_b32 a143, v27
    v_mfma_f32_16x16x32_bf16 v[88:91], a[192:195], a[224:227], v[88:91]
    v_pk_mul_f32 v[32:33], v[32:33], s[76:77]
    v_pk_mul_f32 v[34:35], v[34:35], s[76:77]
    v_pk_mul_f32 v[36:37], v[36:37], s[76:77]
    v_mfma_f32_16x16x32_bf16 v[88:91], a[196:199], a[228:231], v[88:91]
    v_pk_mul_f32 v[38:39], v[38:39], s[76:77]
    v_cvt_pk_bf16_f32 v32, v32, v33
    v_mfma_f32_16x16x32_bf16 v[92:95], a[200:203], a[224:227], v[92:95]
    v_cvt_pk_bf16_f32 v33, v34, v35
    v_cvt_pk_bf16_f32 v34, v36, v37
    v_cvt_pk_bf16_f32 v35, v38, v39
    v_mfma_f32_16x16x32_bf16 v[92:95], a[204:207], a[228:231], v[92:95]
    v_pk_mul_f32 v[40:41], v[40:41], s[76:77]
    v_pk_mul_f32 v[42:43], v[42:43], s[76:77]
    v_mfma_f32_16x16x32_bf16 v[96:99], a[144:147], a[232:235], v[96:99]
    v_pk_mul_f32 v[44:45], v[44:45], s[76:77]
    v_pk_mul_f32 v[46:47], v[46:47], s[76:77]
    v_cvt_pk_bf16_f32 v40, v40, v41
    v_mfma_f32_16x16x32_bf16 v[96:99], a[148:151], a[236:239], v[96:99]
    v_cvt_pk_bf16_f32 v41, v42, v43
    v_cvt_pk_bf16_f32 v42, v44, v45
    v_mfma_f32_16x16x32_bf16 v[100:103], a[152:155], a[232:235], v[100:103]
    v_cvt_pk_bf16_f32 v43, v46, v47
    s_add_u32 m0, s61, 40960
    s_nop 0
    buffer_load_dwordx4 v244, s[16:19], s75 offen offset:0 nt lds
    v_mfma_f32_16x16x32_bf16 v[100:103], a[156:159], a[236:239], v[100:103]
    v_pk_mul_f32 v[48:49], v[48:49], s[76:77]
    v_mfma_f32_16x16x32_bf16 v[104:107], a[160:163], a[232:235], v[104:107]
    v_pk_mul_f32 v[50:51], v[50:51], s[76:77]
    v_pk_mul_f32 v[52:53], v[52:53], s[76:77]
    v_pk_mul_f32 v[54:55], v[54:55], s[76:77]
    v_mfma_f32_16x16x32_bf16 v[104:107], a[164:167], a[236:239], v[104:107]
    v_cvt_pk_bf16_f32 v48, v48, v49
    v_cvt_pk_bf16_f32 v49, v50, v51
    v_cvt_pk_bf16_f32 v50, v52, v53
    v_mfma_f32_16x16x32_bf16 v[108:111], a[168:171], a[232:235], v[108:111]
    v_cvt_pk_bf16_f32 v51, v54, v55
    v_pk_mul_f32 v[56:57], v[56:57], s[76:77]
    v_mfma_f32_16x16x32_bf16 v[108:111], a[172:175], a[236:239], v[108:111]
    v_pk_mul_f32 v[58:59], v[58:59], s[76:77]
    v_pk_mul_f32 v[60:61], v[60:61], s[76:77]
    v_pk_mul_f32 v[62:63], v[62:63], s[76:77]
    v_mfma_f32_16x16x32_bf16 v[112:115], a[176:179], a[232:235], v[112:115]
    v_cvt_pk_bf16_f32 v56, v56, v57
    v_cvt_pk_bf16_f32 v57, v58, v59
    v_mfma_f32_16x16x32_bf16 v[112:115], a[180:183], a[236:239], v[112:115]
    v_cvt_pk_bf16_f32 v58, v60, v61
    v_cvt_pk_bf16_f32 v59, v62, v63
    buffer_load_dwordx4 v253, s[16:19], s75 offen offset:1024 nt lds
    v_mfma_f32_16x16x32_bf16 v[116:119], a[184:187], a[232:235], v[116:119]
    v_mfma_f32_16x16x32_bf16 v[116:119], a[188:191], a[236:239], v[116:119]
    v_mfma_f32_16x16x32_bf16 v[120:123], a[192:195], a[232:235], v[120:123]
    s_mov_b64 exec, s[78:79]
    v_swap_b32 v32, v34
    v_swap_b32 v33, v35
    v_swap_b32 v40, v42
    v_swap_b32 v41, v43
    v_swap_b32 v48, v50
    v_swap_b32 v49, v51
    v_swap_b32 v56, v58
    v_swap_b32 v57, v59
    s_mov_b64 exec, -1
    v_mfma_f32_16x16x32_bf16 v[120:123], a[196:199], a[236:239], v[120:123]
    v_mfma_f32_16x16x32_bf16 v[124:127], a[200:203], a[232:235], v[124:127]
    v_pk_mul_f32 v[64:65], v[64:65], s[76:77]
    v_pk_mul_f32 v[66:67], v[66:67], s[76:77]
    v_pk_mul_f32 v[68:69], v[68:69], s[76:77]
    v_mfma_f32_16x16x32_bf16 v[124:127], a[204:207], a[236:239], v[124:127]
    v_pk_mul_f32 v[70:71], v[70:71], s[76:77]
    buffer_load_dwordx4 v244, s[16:19], s75 offen offset:2048 nt lds
    v_mfma_f32_16x16x32_bf16 v[128:131], a[144:147], a[240:243], v[128:131]
    v_cvt_pk_bf16_f32 v64, v64, v65
    v_cvt_pk_bf16_f32 v65, v66, v67
    v_cvt_pk_bf16_f32 v66, v68, v69
    v_mfma_f32_16x16x32_bf16 v[128:131], a[148:151], a[244:247], v[128:131]
    v_cvt_pk_bf16_f32 v67, v70, v71
    v_pk_mul_f32 v[72:73], v[72:73], s[76:77]
    v_mfma_f32_16x16x32_bf16 v[132:135], a[152:155], a[240:243], v[132:135]
    v_pk_mul_f32 v[74:75], v[74:75], s[76:77]
    v_pk_mul_f32 v[76:77], v[76:77], s[76:77]
    v_pk_mul_f32 v[78:79], v[78:79], s[76:77]
    v_mfma_f32_16x16x32_bf16 v[132:135], a[156:159], a[244:247], v[132:135]
    v_cvt_pk_bf16_f32 v72, v72, v73
    v_cvt_pk_bf16_f32 v73, v74, v75
    v_cvt_pk_bf16_f32 v74, v76, v77
    v_mfma_f32_16x16x32_bf16 v[136:139], a[160:163], a[240:243], v[136:139]
    v_cvt_pk_bf16_f32 v75, v78, v79
    v_pk_mul_f32 v[80:81], v[80:81], s[76:77]
    v_mfma_f32_16x16x32_bf16 v[136:139], a[164:167], a[244:247], v[136:139]
    v_pk_mul_f32 v[82:83], v[82:83], s[76:77]
    v_pk_mul_f32 v[84:85], v[84:85], s[76:77]
    v_pk_mul_f32 v[86:87], v[86:87], s[76:77]
    v_mfma_f32_16x16x32_bf16 v[140:143], a[168:171], a[240:243], v[140:143]
    v_cvt_pk_bf16_f32 v80, v80, v81
    v_cvt_pk_bf16_f32 v81, v82, v83
    v_cvt_pk_bf16_f32 v82, v84, v85
    v_mfma_f32_16x16x32_bf16 v[140:143], a[172:175], a[244:247], v[140:143]
    v_cvt_pk_bf16_f32 v83, v86, v87
    v_pk_mul_f32 v[88:89], v[88:89], s[76:77]
    v_mfma_f32_16x16x32_bf16 v[144:147], a[176:179], a[240:243], v[144:147]
    buffer_load_dwordx4 v253, s[16:19], s75 offen offset:3072 nt lds
    s_add_u32 s75, s75, 8192
    s_and_b32 s75, s75, 0x1e000
    s_or_b32 s75, s75, s60
    v_mfma_f32_16x16x32_bf16 v[144:147], a[180:183], a[244:247], v[144:147]
    v_pk_mul_f32 v[90:91], v[90:91], s[76:77]
    v_mfma_f32_16x16x32_bf16 v[148:151], a[184:187], a[240:243], v[148:151]
    v_pk_mul_f32 v[92:93], v[92:93], s[76:77]
    v_pk_mul_f32 v[94:95], v[94:95], s[76:77]
    v_cvt_pk_bf16_f32 v88, v88, v89
    v_mfma_f32_16x16x32_bf16 v[148:151], a[188:191], a[244:247], v[148:151]
    v_cvt_pk_bf16_f32 v89, v90, v91
    v_cvt_pk_bf16_f32 v90, v92, v93
    v_cvt_pk_bf16_f32 v91, v94, v95
    v_mfma_f32_16x16x32_bf16 v[152:155], a[192:195], a[240:243], v[152:155]
    v_mfma_f32_16x16x32_bf16 v[152:155], a[196:199], a[244:247], v[152:155]
    v_mfma_f32_16x16x32_bf16 v[156:159], a[200:203], a[240:243], v[156:159]
    s_mov_b64 exec, s[78:79]
    v_swap_b32 v64, v66
    v_swap_b32 v65, v67
    v_swap_b32 v72, v74
    v_swap_b32 v73, v75
    v_swap_b32 v80, v82
    v_swap_b32 v81, v83
    v_swap_b32 v88, v90
    v_swap_b32 v89, v91
    s_mov_b64 exec, -1
    v_mfma_f32_16x16x32_bf16 v[156:159], a[204:207], a[244:247], v[156:159]
    s_waitcnt lgkmcnt(0)
    v_mfma_f32_16x16x32_bf16 v[160:163], a[0:3], a[128:131], 0
    v_accvgpr_write_b32 a144, v32
    v_accvgpr_write_b32 a145, v33
    v_accvgpr_write_b32 a146, v34
    v_mfma_f32_16x16x32_bf16 v[160:163], a[4:7], a[132:135], v[160:163]
    v_accvgpr_write_b32 a147, v35
    v_accvgpr_write_b32 a148, v40
    v_accvgpr_write_b32 a149, v41
    v_accvgpr_write_b32 a150, v42
    v_mfma_f32_16x16x32_bf16 v[160:163], a[8:11], a[136:139], v[160:163]
    v_accvgpr_write_b32 a151, v43
    v_accvgpr_write_b32 a152, v48
    v_accvgpr_write_b32 a153, v49
    v_mfma_f32_16x16x32_bf16 v[160:163], a[12:15], a[140:143], v[160:163]
    v_accvgpr_write_b32 a154, v50
    v_accvgpr_write_b32 a155, v51
    s_add_u32 m0, s61, 49152
    s_nop 0
    buffer_load_dwordx4 v237, s[24:27], s75 offen offset:0 nt lds
    v_mfma_f32_16x16x32_bf16 v[164:167], a[16:19], a[128:131], 0
    v_accvgpr_write_b32 a156, v56
    v_accvgpr_write_b32 a157, v57
    v_mfma_f32_16x16x32_bf16 v[164:167], a[20:23], a[132:135], v[164:167]
    v_accvgpr_write_b32 a158, v58
    v_accvgpr_write_b32 a159, v59
    v_accvgpr_write_b32 a160, v64
    v_mfma_f32_16x16x32_bf16 v[164:167], a[24:27], a[136:139], v[164:167]
    v_accvgpr_write_b32 a161, v65
    v_accvgpr_write_b32 a162, v66
    v_accvgpr_write_b32 a163, v67
    v_accvgpr_write_b32 a164, v72
    v_mfma_f32_16x16x32_bf16 v[164:167], a[28:31], a[140:143], v[164:167]
    v_accvgpr_write_b32 a165, v73
    v_accvgpr_write_b32 a166, v74
    v_accvgpr_write_b32 a167, v75
    v_mfma_f32_16x16x32_bf16 v[168:171], a[0:3], a[144:147], 0
    v_accvgpr_write_b32 a168, v80
    v_accvgpr_write_b32 a169, v81
    v_accvgpr_write_b32 a170, v82
    v_accvgpr_write_b32 a171, v83
    v_accvgpr_write_b32 a172, v88
    v_accvgpr_write_b32 a173, v89
    v_accvgpr_write_b32 a174, v90
    v_mfma_f32_16x16x32_bf16 v[168:171], a[4:7], a[148:151], v[168:171]
    v_accvgpr_write_b32 a175, v91
    v_pk_mul_f32 v[96:97], v[96:97], s[76:77]
    v_pk_mul_f32 v[98:99], v[98:99], s[76:77]
    v_pk_mul_f32 v[100:101], v[100:101], s[76:77]
    v_pk_mul_f32 v[102:103], v[102:103], s[76:77]
    v_cvt_pk_bf16_f32 v96, v96, v97
    v_mfma_f32_16x16x32_bf16 v[168:171], a[8:11], a[152:155], v[168:171]
    buffer_load_dwordx4 v238, s[24:27], s75 offen offset:1024 nt lds
    v_cvt_pk_bf16_f32 v97, v98, v99
    v_cvt_pk_bf16_f32 v98, v100, v101
    v_cvt_pk_bf16_f32 v99, v102, v103
    v_pk_mul_f32 v[104:105], v[104:105], s[76:77]
    v_pk_mul_f32 v[106:107], v[106:107], s[76:77]
    v_pk_mul_f32 v[108:109], v[108:109], s[76:77]
    v_mfma_f32_16x16x32_bf16 v[168:171], a[12:15], a[156:159], v[168:171]
    v_pk_mul_f32 v[110:111], v[110:111], s[76:77]
    v_cvt_pk_bf16_f32 v104, v104, v105
    v_cvt_pk_bf16_f32 v105, v106, v107
    v_cvt_pk_bf16_f32 v106, v108, v109
    v_cvt_pk_bf16_f32 v107, v110, v111
    v_pk_mul_f32 v[112:113], v[112:113], s[76:77]
    v_mfma_f32_16x16x32_bf16 v[172:175], a[16:19], a[144:147], 0
    v_pk_mul_f32 v[114:115], v[114:115], s[76:77]
    v_pk_mul_f32 v[116:117], v[116:117], s[76:77]
    v_pk_mul_f32 v[118:119], v[118:119], s[76:77]
    v_cvt_pk_bf16_f32 v112, v112, v113
    v_cvt_pk_bf16_f32 v113, v114, v115
    v_cvt_pk_bf16_f32 v114, v116, v117
    v_cvt_pk_bf16_f32 v115, v118, v119
    v_mfma_f32_16x16x32_bf16 v[172:175], a[20:23], a[148:151], v[172:175]
    v_pk_mul_f32 v[120:121], v[120:121], s[76:77]
    v_pk_mul_f32 v[122:123], v[122:123], s[76:77]
    v_pk_mul_f32 v[124:125], v[124:125], s[76:77]
    v_pk_mul_f32 v[126:127], v[126:127], s[76:77]
    v_cvt_pk_bf16_f32 v120, v120, v121
    v_cvt_pk_bf16_f32 v121, v122, v123
    v_mfma_f32_16x16x32_bf16 v[172:175], a[24:27], a[152:155], v[172:175]
    buffer_load_dwordx4 v239, s[24:27], s75 offen offset:2048 nt lds
    v_cvt_pk_bf16_f32 v122, v124, v125
    v_cvt_pk_bf16_f32 v123, v126, v127
    v_mfma_f32_16x16x32_bf16 v[172:175], a[28:31], a[156:159], v[172:175]
    s_mov_b64 exec, s[78:79]
    v_swap_b32 v96, v98
    v_swap_b32 v97, v99
    v_swap_b32 v104, v106
    v_swap_b32 v105, v107
    v_swap_b32 v112, v114
    v_swap_b32 v113, v115
    v_swap_b32 v120, v122
    v_swap_b32 v121, v123
    s_mov_b64 exec, -1
    v_mfma_f32_16x16x32_bf16 v[176:179], a[0:3], a[160:163], 0
    v_max3_f32 v200, v160, v161, v162
    v_accvgpr_write_b32 a176, v96
    v_max3_f32 v200, v200, v163, v164
    v_accvgpr_write_b32 a177, v97
    v_max3_f32 v200, v200, v165, v166
    v_mfma_f32_16x16x32_bf16 v[176:179], a[4:7], a[164:167], v[176:179]
    v_accvgpr_write_b32 a178, v98
    v_max_f32 v200, v200, v167
    v_mov_b32 v201, v200
    v_accvgpr_write_b32 a179, v99
    s_nop 0
    v_permlane16_swap_b32 v200, v201
    v_mfma_f32_16x16x32_bf16 v[176:179], a[8:11], a[168:171], v[176:179]
    v_accvgpr_write_b32 a180, v104
    v_max_f32 v200, v200, v201
    v_mov_b32 v201, v200
    v_accvgpr_write_b32 a181, v105
    s_nop 0
    v_permlane32_swap_b32 v200, v201
    v_mfma_f32_16x16x32_bf16 v[176:179], a[12:15], a[172:175], v[176:179]
    v_accvgpr_write_b32 a182, v106
    v_max_f32 v200, v200, v201
    v_accvgpr_write_b32 a183, v107
    v_sub_f32 v200, 0, v200
    buffer_load_dwordx4 v240, s[24:27], s75 offen offset:3072 nt lds
    v_mfma_f32_16x16x32_bf16 v[180:183], a[16:19], a[160:163], 0
    v_mov_b32 v201, v200
    v_accvgpr_write_b32 a184, v112
    v_mov_b32 v202, v200
    v_accvgpr_write_b32 a185, v113
    v_mfma_f32_16x16x32_bf16 v[180:183], a[20:23], a[164:167], v[180:183]
    v_mov_b32 v203, v200
    v_accvgpr_write_b32 a186, v114
    v_add_f32 v160, v160, v200
    v_add_f32 v161, v161, v200
    v_accvgpr_write_b32 a187, v115
    v_mfma_f32_16x16x32_bf16 v[180:183], a[24:27], a[168:171], v[180:183]
    v_add_f32 v162, v162, v200
    v_accvgpr_write_b32 a188, v120
    v_add_f32 v163, v163, v200
    v_add_f32 v164, v164, v200
    v_accvgpr_write_b32 a189, v121
    v_mfma_f32_16x16x32_bf16 v[180:183], a[28:31], a[172:175], v[180:183]
    v_add_f32 v165, v165, v200
    v_accvgpr_write_b32 a190, v122
    v_add_f32 v166, v166, v200
    v_accvgpr_write_b32 a191, v123
    v_add_f32 v167, v167, v200
    v_mfma_f32_16x16x32_bf16 v[184:187], a[0:3], a[176:179], 0
    v_pk_mul_f32 v[128:129], v[128:129], s[76:77]
    v_max3_f32 v204, v168, v169, v170
    v_pk_mul_f32 v[130:131], v[130:131], s[76:77]
    v_pk_mul_f32 v[132:133], v[132:133], s[76:77]
    v_pk_mul_f32 v[134:135], v[134:135], s[76:77]
    v_max3_f32 v204, v204, v171, v172
    v_cvt_pk_bf16_f32 v128, v128, v129
    v_cvt_pk_bf16_f32 v129, v130, v131
    v_cvt_pk_bf16_f32 v130, v132, v133
    v_max3_f32 v204, v204, v173, v174
    v_cvt_pk_bf16_f32 v131, v134, v135
    v_mfma_f32_16x16x32_bf16 v[184:187], a[4:7], a[180:183], v[184:187]
    v_pk_mul_f32 v[136:137], v[136:137], s[76:77]
    v_max_f32 v204, v204, v175
    v_pk_mul_f32 v[138:139], v[138:139], s[76:77]
    v_pk_mul_f32 v[140:141], v[140:141], s[76:77]
    v_pk_mul_f32 v[142:143], v[142:143], s[76:77]
    v_mov_b32 v205, v204
    v_cvt_pk_bf16_f32 v136, v136, v137
    v_cvt_pk_bf16_f32 v137, v138, v139
    v_cvt_pk_bf16_f32 v138, v140, v141
    v_permlane16_swap_b32 v204, v205
    v_mfma_f32_16x16x32_bf16 v[184:187], a[8:11], a[184:187], v[184:187]
    v_cvt_pk_bf16_f32 v139, v142, v143
    v_pk_mul_f32 v[144:145], v[144:145], s[76:77]
    v_max_f32 v204, v204, v205
    v_pk_mul_f32 v[146:147], v[146:147], s[76:77]
    v_pk_mul_f32 v[148:149], v[148:149], s[76:77]
    v_pk_mul_f32 v[150:151], v[150:151], s[76:77]
    v_mov_b32 v205, v204
    v_cvt_pk_bf16_f32 v144, v144, v145
    v_cvt_pk_bf16_f32 v145, v146, v147
    s_add_u32 m0, s61, 57344
    s_nop 0
    buffer_load_dwordx4 v244, s[16:19], s75 offen offset:0 nt lds
    v_mfma_f32_16x16x32_bf16 v[184:187], a[12:15], a[188:191], v[184:187]
    v_permlane32_swap_b32 v204, v205
    v_cvt_pk_bf16_f32 v146, v148, v149
    v_cvt_pk_bf16_f32 v147, v150, v151
    v_pk_mul_f32 v[152:153], v[152:153], s[76:77]
    v_max_f32 v204, v204, v205
    v_pk_mul_f32 v[154:155], v[154:155], s[76:77]
    v_pk_mul_f32 v[156:157], v[156:157], s[76:77]
    v_pk_mul_f32 v[158:159], v[158:159], s[76:77]
    v_sub_f32 v204, 0, v204
    v_mfma_f32_16x16x32_bf16 v[188:191], a[16:19], a[176:179], 0
    v_cvt_pk_bf16_f32 v152, v152, v153
    v_cvt_pk_bf16_f32 v153, v154, v155
    v_mov_b32 v205, v204
    v_cvt_pk_bf16_f32 v154, v156, v157
    v_cvt_pk_bf16_f32 v155, v158, v159
    v_mov_b32 v206, v204
    v_mov_b32 v207, v204
    v_mfma_f32_16x16x32_bf16 v[188:191], a[20:23], a[180:183], v[188:191]
    s_mov_b64 exec, s[78:79]
    v_swap_b32 v128, v130
    v_swap_b32 v129, v131
    v_swap_b32 v136, v138
    v_swap_b32 v137, v139
    v_swap_b32 v144, v146
    v_swap_b32 v145, v147
    v_swap_b32 v152, v154
    v_swap_b32 v153, v155
    s_mov_b64 exec, -1
    v_add_f32 v168, v168, v204
    v_add_f32 v169, v169, v204
    v_accvgpr_write_b32 a192, v128
    v_accvgpr_write_b32 a193, v129
    v_mfma_f32_16x16x32_bf16 v[188:191], a[24:27], a[184:187], v[188:191]
    v_add_f32 v170, v170, v204
    v_accvgpr_write_b32 a194, v130
    v_accvgpr_write_b32 a195, v131
    v_add_f32 v171, v171, v204
    v_accvgpr_write_b32 a196, v136
    v_accvgpr_write_b32 a197, v137
    v_accvgpr_write_b32 a198, v138
    v_add_f32 v172, v172, v204
    v_accvgpr_write_b32 a199, v139
    v_accvgpr_write_b32 a200, v144
    buffer_load_dwordx4 v253, s[16:19], s75 offen offset:1024 nt lds
    v_mfma_f32_16x16x32_bf16 v[188:191], a[28:31], a[188:191], v[188:191]
    v_add_f32 v173, v173, v204
    v_accvgpr_write_b32 a201, v145
    v_accvgpr_write_b32 a202, v146
    v_accvgpr_write_b32 a203, v147
    v_add_f32 v174, v174, v204
    v_accvgpr_write_b32 a204, v152
    v_accvgpr_write_b32 a205, v153
    v_accvgpr_write_b32 a206, v154
    v_add_f32 v175, v175, v204
    v_accvgpr_write_b32 a207, v155
    v_exp_f32 v160, v160
    v_exp_f32 v161, v161
    v_exp_f32 v162, v162
    v_cvt_pk_bf16_f32 v160, v160, v161
    v_mfma_f32_16x16x32_bf16 v[192:195], a[0:3], a[192:195], 0
    v_max3_f32 v208, v176, v177, v178
    v_exp_f32 v163, v163
    v_max3_f32 v208, v208, v179, v180
    buffer_load_dwordx4 v244, s[16:19], s75 offen offset:2048 nt lds
    v_max3_f32 v208, v208, v181, v182
    v_mfma_f32_16x16x32_bf16 v[192:195], a[4:7], a[196:199], v[192:195]
    v_max_f32 v208, v208, v183
    v_exp_f32 v164, v164
    v_mov_b32 v209, v208
    v_cvt_pk_bf16_f32 v161, v162, v163
    v_mfma_f32_16x16x32_bf16 v[192:195], a[8:11], a[200:203], v[192:195]
    v_permlane16_swap_b32 v208, v209
    v_max_f32 v208, v208, v209
    v_exp_f32 v165, v165
    v_mov_b32 v209, v208
    s_nop 1
    v_permlane32_swap_b32 v208, v209
    v_mfma_f32_16x16x32_bf16 v[192:195], a[12:15], a[204:207], v[192:195]
    v_max_f32 v208, v208, v209
    v_exp_f32 v166, v166
    v_sub_f32 v208, 0, v208
    v_mov_b32 v209, v208
    v_cvt_pk_bf16_f32 v162, v164, v165
    v_mfma_f32_16x16x32_bf16 v[196:199], a[16:19], a[192:195], 0
    v_mov_b32 v210, v208
    buffer_load_dwordx4 v253, s[16:19], s75 offen offset:3072 nt lds
    s_add_u32 s75, s75, 8192
    s_and_b32 s75, s75, 0x1e000
    s_or_b32 s75, s75, s60
    v_mfma_f32_16x16x32_bf16 v[196:199], a[20:23], a[196:199], v[196:199]
    v_exp_f32 v167, v167
    v_mov_b32 v211, v208
    v_add_f32 v176, v176, v208
    v_cvt_pk_bf16_f32 v163, v166, v167
    v_add_f32 v177, v177, v208
    v_mfma_f32_16x16x32_bf16 v[196:199], a[24:27], a[200:203], v[196:199]
    v_mov_b32 v245, 0x3f803f80
    v_add_f32 v178, v178, v208
    v_add_f32 v179, v179, v208
    v_accvgpr_write_b32 a228, v245
    v_add_f32 v180, v180, v208
    v_mfma_f32_16x16x32_bf16 v[196:199], a[28:31], a[204:207], v[196:199]
    v_accvgpr_write_b32 a229, v245
    v_add_f32 v181, v181, v208
    v_accvgpr_write_b32 a230, v245
    v_add_f32 v182, v182, v208
    v_accvgpr_write_b32 a231, v245
    v_add_f32 v183, v183, v208
    v_max3_f32 v212, v184, v185, v186
    v_max3_f32 v212, v212, v187, v188
    v_max3_f32 v212, v212, v189, v190
    v_max_f32 v212, v212, v191
    v_mov_b32 v213, v212
    s_nop 1
    v_permlane16_swap_b32 v212, v213
    v_max_f32 v212, v212, v213
    v_mov_b32 v213, v212
    s_nop 1
    v_permlane32_swap_b32 v212, v213
    v_max_f32 v212, v212, v213
    v_sub_f32 v212, 0, v212
    v_mov_b32 v213, v212
    v_mov_b32 v214, v212
    v_mov_b32 v215, v212
    v_add_f32 v184, v184, v212
    v_add_f32 v185, v185, v212
    v_add_f32 v186, v186, v212
    v_add_f32 v187, v187, v212
    v_add_f32 v188, v188, v212
    v_add_f32 v189, v189, v212
    v_add_f32 v190, v190, v212
    v_add_f32 v191, v191, v212
    v_max3_f32 v216, v192, v193, v194
    v_max3_f32 v216, v216, v195, v196
    v_max3_f32 v216, v216, v197, v198
    v_max_f32 v216, v216, v199
    v_mov_b32 v217, v216
    s_nop 1
    v_permlane16_swap_b32 v216, v217
    v_max_f32 v216, v216, v217
    v_mov_b32 v217, v216
    s_nop 1
    v_permlane32_swap_b32 v216, v217
    v_max_f32 v216, v216, v217
    v_sub_f32 v216, 0, v216
    v_mov_b32 v217, v216
    v_mov_b32 v218, v216
    v_mov_b32 v219, v216
    v_add_f32 v192, v192, v216
    v_add_f32 v193, v193, v216
    v_add_f32 v194, v194, v216
    v_add_f32 v195, v195, v216
    v_add_f32 v196, v196, v216
    v_add_f32 v197, v197, v216
    v_add_f32 v198, v198, v216
    v_add_f32 v199, v199, v216
K1_IT0:
    s_waitcnt vmcnt(16)
    s_barrier
    v_mfma_f32_16x16x32_bf16 v[0:3], a[32:35], v[160:163], 0
    v_exp_f32 v168, v168
    ds_read_b128 a[64:67], v225 offset:16384
    v_mfma_f32_16x16x32_bf16 v[4:7], a[36:39], v[160:163], 0
    v_exp_f32 v169, v169
    v_exp_f32 v170, v170
    v_mfma_f32_16x16x32_bf16 v[8:11], a[40:43], v[160:163], 0
    v_cvt_pk_bf16_f32 v168, v168, v169
    ds_read_b128 a[68:71], v226 offset:16384
    v_mfma_f32_16x16x32_bf16 v[12:15], a[44:47], v[160:163], 0
    v_exp_f32 v171, v171
    v_exp_f32 v172, v172
    v_mfma_f32_16x16x32_bf16 v[16:19], a[48:51], v[160:163], 0
    s_add_u32 m0, s61, 0
    s_nop 0
    buffer_load_dwordx4 v237, s[24:27], s75 offen offset:0 nt lds
    v_mfma_f32_16x16x32_bf16 v[20:23], a[52:55], v[160:163], 0
    v_cvt_pk_bf16_f32 v169, v170, v171
    ds_read_b128 a[72:75], v227 offset:16384
    v_mfma_f32_16x16x32_bf16 v[24:27], a[56:59], v[160:163], 0
    v_exp_f32 v173, v173
    v_exp_f32 v174, v174
    v_mfma_f32_16x16x32_bf16 v[28:31], a[60:63], v[160:163], 0
    v_cvt_pk_bf16_f32 v170, v172, v173
    ds_read_b128 a[76:79], v228 offset:16384
    v_mfma_f32_16x16x32_bf16 a[208:211], a[228:231], v[160:163], 0
    v_exp_f32 v175, v175
    s_nop 0
    v_cvt_pk_bf16_f32 v171, v174, v175
    s_nop 1
    v_mfma_f32_16x16x32_bf16 v[32:35], a[32:35], v[168:171], 0
    v_exp_f32 v176, v176
    ds_read_b128 a[80:83], v225 offset:20480
    v_mfma_f32_16x16x32_bf16 v[36:39], a[36:39], v[168:171], 0
    v_exp_f32 v177, v177
    v_mfma_f32_16x16x32_bf16 v[40:43], a[40:43], v[168:171], 0
    v_exp_f32 v178, v178
    buffer_load_dwordx4 v238, s[24:27], s75 offen offset:1024 nt lds
    v_cvt_pk_bf16_f32 v176, v176, v177
    v_mfma_f32_16x16x32_bf16 v[44:47], a[44:47], v[168:171], 0
    ds_read_b128 a[84:87], v226 offset:20480
    v_exp_f32 v179, v179
    v_mfma_f32_16x16x32_bf16 v[48:51], a[48:51], v[168:171], 0
    v_exp_f32 v180, v180
    v_mfma_f32_16x16x32_bf16 v[52:55], a[52:55], v[168:171], 0
    v_cvt_pk_bf16_f32 v177, v178, v179
    ds_read_b128 a[88:91], v227 offset:20480
    v_exp_f32 v181, v181
    v_mfma_f32_16x16x32_bf16 v[56:59], a[56:59], v[168:171], 0
    v_exp_f32 v182, v182
    v_mfma_f32_16x16x32_bf16 v[60:63], a[60:63], v[168:171], 0
    buffer_load_dwordx4 v239, s[24:27], s75 offen offset:2048 nt lds
    v_cvt_pk_bf16_f32 v178, v180, v181
    ds_read_b128 a[92:95], v228 offset:20480
    v_mfma_f32_16x16x32_bf16 a[212:215], a[228:231], v[168:171], 0
    v_exp_f32 v183, v183
    s_nop 0
    v_cvt_pk_bf16_f32 v179, v182, v183
    s_nop 1
    v_mfma_f32_16x16x32_bf16 v[64:67], a[32:35], v[176:179], 0
    v_exp_f32 v184, v184
    ds_read_b64_tr_b16 a[96:97], v229 offset:16384
    v_mfma_f32_16x16x32_bf16 v[68:71], a[36:39], v[176:179], 0
    v_exp_f32 v185, v185
    v_mfma_f32_16x16x32_bf16 v[72:75], a[40:43], v[176:179], 0
    v_exp_f32 v186, v186
    v_cvt_pk_bf16_f32 v184, v184, v185
    v_mfma_f32_16x16x32_bf16 v[76:79], a[44:47], v[176:179], 0
    ds_read_b64_tr_b16 a[98:99], v229 offset:20480
    v_exp_f32 v187, v187
    v_mfma_f32_16x16x32_bf16 v[80:83], a[48:51], v[176:179], 0
    v_exp_f32 v188, v188
    buffer_load_dwordx4 v240, s[24:27], s75 offen offset:3072 nt lds
    v_mfma_f32_16x16x32_bf16 v[84:87], a[52:55], v[176:179], 0
    v_cvt_pk_bf16_f32 v185, v186, v187
    ds_read_b64_tr_b16 a[100:101], v230 offset:16384
    v_mfma_f32_16x16x32_bf16 v[88:91], a[56:59], v[176:179], 0
    v_exp_f32 v189, v189
    v_exp_f32 v190, v190
    v_mfma_f32_16x16x32_bf16 v[92:95], a[60:63], v[176:179], 0
    v_cvt_pk_bf16_f32 v186, v188, v189
    ds_read_b64_tr_b16 a[102:103], v230 offset:20480
    v_mfma_f32_16x16x32_bf16 a[216:219], a[228:231], v[176:179], 0
    v_exp_f32 v191, v191
    s_nop 0
    v_cvt_pk_bf16_f32 v187, v190, v191
    s_waitcnt lgkmcnt(4)
    v_mfma_f32_16x16x32_bf16 v[160:163], a[64:67], a[128:131], v[200:203]
    v_exp_f32 v192, v192
    v_mfma_f32_16x16x32_bf16 v[160:163], a[68:71], a[132:135], v[160:163]
    ds_read_b64_tr_b16 a[104:105], v231 offset:16384
    ds_read_b64_tr_b16 a[106:107], v231 offset:20480
    v_mfma_f32_16x16x32_bf16 v[160:163], a[72:75], a[136:139], v[160:163]
    v_exp_f32 v193, v193
    v_mfma_f32_16x16x32_bf16 v[160:163], a[76:79], a[140:143], v[160:163]
    v_cvt_pk_bf16_f32 v192, v192, v193
    v_mfma_f32_16x16x32_bf16 v[164:167], a[80:83], a[128:131], v[200:203]
    v_exp_f32 v194, v194
    v_mfma_f32_16x16x32_bf16 v[164:167], a[84:87], a[132:135], v[164:167]
    ds_read_b64_tr_b16 a[108:109], v232 offset:16384
    s_add_u32 m0, s61, 8192
    s_nop 0
    buffer_load_dwordx4 v244, s[16:19], s75 offen offset:0 nt lds
    v_mfma_f32_16x16x32_bf16 v[164:167], a[88:91], a[136:139], v[164:167]
    v_exp_f32 v195, v195
    v_mfma_f32_16x16x32_bf16 v[164:167], a[92:95], a[140:143], v[164:167]
    v_cvt_pk_bf16_f32 v193, v194, v195
    v_mfma_f32_16x16x32_bf16 v[96:99], a[32:35], v[184:187], 0
    v_exp_f32 v196, v196
    v_mfma_f32_16x16x32_bf16 v[100:103], a[36:39], v[184:187], 0
    ds_read_b64_tr_b16 a[110:111], v232 offset:20480
    ds_read_b64_tr_b16 a[112:113], v233 offset:16384
    v_mfma_f32_16x16x32_bf16 v[104:107], a[40:43], v[184:187], 0
    v_exp_f32 v197, v197
    v_mfma_f32_16x16x32_bf16 v[108:111], a[44:47], v[184:187], 0
    v_cvt_pk_bf16_f32 v194, v196, v197
    v_mfma_f32_16x16x32_bf16 v[112:115], a[48:51], v[184:187], 0
    v_exp_f32 v198, v198
    v_mfma_f32_16x16x32_bf16 v[116:119], a[52:55], v[184:187], 0
    ds_read_b64_tr_b16 a[114:115], v233 offset:20480
    ds_read_b64_tr_b16 a[116:117], v234 offset:16384
    v_mfma_f32_16x16x32_bf16 v[120:123], a[56:59], v[184:187], 0
    v_exp_f32 v199, v199
    v_mfma_f32_16x16x32_bf16 v[124:127], a[60:63], v[184:187], 0
    v_cvt_pk_bf16_f32 v195, v198, v199
    v_mfma_f32_16x16x32_bf16 a[220:223], a[228:231], v[184:187], 0
    buffer_load_dwordx4 v253, s[16:19], s75 offen offset:1024 nt lds
    ds_read_b64_tr_b16 a[118:119], v234 offset:20480
    v_mfma_f32_16x16x32_bf16 v[168:171], a[64:67], a[144:147], v[204:207]
    v_exp_f32 v160, v160
    v_mfma_f32_16x16x32_bf16 v[168:171], a[68:71], a[148:151], v[168:171]
    buffer_load_dwordx4 v244, s[16:19], s75 offen offset:2048 nt lds
    ds_read_b64_tr_b16 a[120:121], v235 offset:16384
    v_mfma_f32_16x16x32_bf16 v[168:171], a[72:75], a[152:155], v[168:171]
    v_exp_f32 v161, v161
    v_mfma_f32_16x16x32_bf16 v[168:171], a[76:79], a[156:159], v[168:171]
    v_cvt_pk_bf16_f32 v160, v160, v161
    v_mfma_f32_16x16x32_bf16 v[172:175], a[80:83], a[144:147], v[204:207]
    v_exp_f32 v162, v162
    v_mfma_f32_16x16x32_bf16 v[172:175], a[84:87], a[148:151], v[172:175]
    ds_read_b64_tr_b16 a[122:123], v235 offset:20480
    v_mfma_f32_16x16x32_bf16 v[172:175], a[88:91], a[152:155], v[172:175]
    v_exp_f32 v163, v163
    v_mfma_f32_16x16x32_bf16 v[172:175], a[92:95], a[156:159], v[172:175]
    v_cvt_pk_bf16_f32 v161, v162, v163
    v_mfma_f32_16x16x32_bf16 v[128:131], a[32:35], v[192:195], 0
    v_exp_f32 v164, v164
    v_mfma_f32_16x16x32_bf16 v[132:135], a[36:39], v[192:195], 0
    buffer_load_dwordx4 v253, s[16:19], s75 offen offset:3072 nt lds
    s_add_u32 s75, s75, 8192
    s_and_b32 s75, s75, 0x1e000
    s_or_b32 s75, s75, s60
    v_mfma_f32_16x16x32_bf16 v[136:139], a[40:43], v[192:195], 0
    v_exp_f32 v165, v165
    v_mfma_f32_16x16x32_bf16 v[140:143], a[44:47], v[192:195], 0
    v_cvt_pk_bf16_f32 v162, v164, v165
    v_mfma_f32_16x16x32_bf16 v[144:147], a[48:51], v[192:195], 0
    v_exp_f32 v166, v166
    v_mfma_f32_16x16x32_bf16 v[148:151], a[52:55], v[192:195], 0
    ds_read_b64_tr_b16 a[124:125], v236 offset:16384
    v_mfma_f32_16x16x32_bf16 v[152:155], a[56:59], v[192:195], 0
    v_exp_f32 v167, v167
    v_mfma_f32_16x16x32_bf16 v[156:159], a[60:63], v[192:195], 0
    v_cvt_pk_bf16_f32 v163, v166, v167
    v_mfma_f32_16x16x32_bf16 a[224:227], a[228:231], v[192:195], 0
    ds_read_b64_tr_b16 a[126:127], v236 offset:20480
    v_mfma_f32_16x16x32_bf16 v[176:179], a[64:67], a[160:163], v[208:211]
    v_exp_f32 v168, v168
    v_mfma_f32_16x16x32_bf16 v[176:179], a[68:71], a[164:167], v[176:179]
    v_mfma_f32_16x16x32_bf16 v[176:179], a[72:75], a[168:171], v[176:179]
    v_exp_f32 v169, v169
    v_mfma_f32_16x16x32_bf16 v[176:179], a[76:79], a[172:175], v[176:179]
    v_cvt_pk_bf16_f32 v168, v168, v169
    v_mfma_f32_16x16x32_bf16 v[180:183], a[80:83], a[160:163], v[208:211]
    v_exp_f32 v170, v170
    v_mfma_f32_16x16x32_bf16 v[180:183], a[84:87], a[164:167], v[180:183]
    v_mfma_f32_16x16x32_bf16 v[180:183], a[88:91], a[168:171], v[180:183]
    v_exp_f32 v171, v171
    v_mfma_f32_16x16x32_bf16 v[180:183], a[92:95], a[172:175], v[180:183]
    v_cvt_pk_bf16_f32 v169, v170, v171
    s_waitcnt lgkmcnt(0)
    v_mfma_f32_16x16x32_bf16 v[0:3], a[96:99], v[160:163], v[0:3]
    v_exp_f32 v172, v172
    v_mfma_f32_16x16x32_bf16 v[4:7], a[100:103], v[160:163], v[4:7]
    v_mfma_f32_16x16x32_bf16 v[8:11], a[104:107], v[160:163], v[8:11]
    v_exp_f32 v173, v173
    v_mfma_f32_16x16x32_bf16 v[12:15], a[108:111], v[160:163], v[12:15]
    v_cvt_pk_bf16_f32 v170, v172, v173
    v_mfma_f32_16x16x32_bf16 v[16:19], a[112:115], v[160:163], v[16:19]
    v_exp_f32 v174, v174
    v_mfma_f32_16x16x32_bf16 v[20:23], a[116:119], v[160:163], v[20:23]
    v_mfma_f32_16x16x32_bf16 v[24:27], a[120:123], v[160:163], v[24:27]
    v_exp_f32 v175, v175
    v_mfma_f32_16x16x32_bf16 v[28:31], a[124:127], v[160:163], v[28:31]
    v_cvt_pk_bf16_f32 v171, v174, v175
    v_mfma_f32_16x16x32_bf16 a[208:211], a[228:231], v[160:163], a[208:211]
    s_waitcnt vmcnt(20)
    s_barrier
    v_mfma_f32_16x16x32_bf16 v[184:187], a[64:67], a[176:179], v[212:215]
    v_exp_f32 v176, v176
    v_mfma_f32_16x16x32_bf16 v[184:187], a[68:71], a[180:183], v[184:187]
    ds_read_b128 a[0:3], v225 offset:32768
    ds_read_b128 a[4:7], v226 offset:32768
    v_mfma_f32_16x16x32_bf16 v[184:187], a[72:75], a[184:187], v[184:187]
    v_exp_f32 v177, v177
    v_mfma_f32_16x16x32_bf16 v[184:187], a[76:79], a[188:191], v[184:187]
    v_cvt_pk_bf16_f32 v176, v176, v177
    v_mfma_f32_16x16x32_bf16 v[188:191], a[80:83], a[176:179], v[212:215]
    v_exp_f32 v178, v178
    v_mfma_f32_16x16x32_bf16 v[188:191], a[84:87], a[180:183], v[188:191]
    ds_read_b128 a[8:11], v227 offset:32768
    s_add_u32 m0, s61, 16384
    s_nop 0
    buffer_load_dwordx4 v237, s[24:27], s75 offen offset:0 nt lds
    v_mfma_f32_16x16x32_bf16 v[188:191], a[88:91], a[184:187], v[188:191]
    v_exp_f32 v179, v179
    v_mfma_f32_16x16x32_bf16 v[188:191], a[92:95], a[188:191], v[188:191]
    v_cvt_pk_bf16_f32 v177, v178, v179
    v_mfma_f32_16x16x32_bf16 v[32:35], a[96:99], v[168:171], v[32:35]
    v_exp_f32 v180, v180
    v_mfma_f32_16x16x32_bf16 v[36:39], a[100:103], v[168:171], v[36:39]
    ds_read_b128 a[12:15], v228 offset:32768
    ds_read_b128 a[16:19], v225 offset:36864
    v_mfma_f32_16x16x32_bf16 v[40:43], a[104:107], v[168:171], v[40:43]
    v_exp_f32 v181, v181
    v_mfma_f32_16x16x32_bf16 v[44:47], a[108:111], v[168:171], v[44:47]
    v_cvt_pk_bf16_f32 v178, v180, v181
    v_mfma_f32_16x16x32_bf16 v[48:51], a[112:115], v[168:171], v[48:51]
    v_exp_f32 v182, v182
    v_mfma_f32_16x16x32_bf16 v[52:55], a[116:119], v[168:171], v[52:55]
    ds_read_b128 a[20:23], v226 offset:36864
    ds_read_b128 a[24:27], v227 offset:36864
    v_mfma_f32_16x16x32_bf16 v[56:59], a[120:123], v[168:171], v[56:59]
    v_exp_f32 v183, v183
    v_mfma_f32_16x16x32_bf16 v[60:63], a[124:127], v[168:171], v[60:63]
    v_cvt_pk_bf16_f32 v179, v182, v183
    v_mfma_f32_16x16x32_bf16 a[212:215], a[228:231], v[168:171], a[212:215]
    buffer_load_dwordx4 v238, s[24:27], s75 offen offset:1024 nt lds
    ds_read_b128 a[28:31], v228 offset:36864
    v_mfma_f32_16x16x32_bf16 v[192:195], a[64:67], a[192:195], v[216:219]
    v_exp_f32 v184, v184
    v_mfma_f32_16x16x32_bf16 v[192:195], a[68:71], a[196:199], v[192:195]
    buffer_load_dwordx4 v239, s[24:27], s75 offen offset:2048 nt lds
    v_mfma_f32_16x16x32_bf16 v[192:195], a[72:75], a[200:203], v[192:195]
    v_exp_f32 v185, v185
    v_mfma_f32_16x16x32_bf16 v[192:195], a[76:79], a[204:207], v[192:195]
    v_cvt_pk_bf16_f32 v184, v184, v185
    v_mfma_f32_16x16x32_bf16 v[196:199], a[80:83], a[192:195], v[216:219]
    v_exp_f32 v186, v186
    v_mfma_f32_16x16x32_bf16 v[196:199], a[84:87], a[196:199], v[196:199]
    v_mfma_f32_16x16x32_bf16 v[196:199], a[88:91], a[200:203], v[196:199]
    v_exp_f32 v187, v187
    v_mfma_f32_16x16x32_bf16 v[196:199], a[92:95], a[204:207], v[196:199]
    v_cvt_pk_bf16_f32 v185, v186, v187
    v_mfma_f32_16x16x32_bf16 v[64:67], a[96:99], v[176:179], v[64:67]
    v_exp_f32 v188, v188
    v_mfma_f32_16x16x32_bf16 v[68:71], a[100:103], v[176:179], v[68:71]
    buffer_load_dwordx4 v240, s[24:27], s75 offen offset:3072 nt lds
    v_mfma_f32_16x16x32_bf16 v[72:75], a[104:107], v[176:179], v[72:75]
    v_exp_f32 v189, v189
    v_mfma_f32_16x16x32_bf16 v[76:79], a[108:111], v[176:179], v[76:79]
    v_cvt_pk_bf16_f32 v186, v188, v189
    v_mfma_f32_16x16x32_bf16 v[80:83], a[112:115], v[176:179], v[80:83]
    v_exp_f32 v190, v190
    v_mfma_f32_16x16x32_bf16 v[84:87], a[116:119], v[176:179], v[84:87]
    v_mfma_f32_16x16x32_bf16 v[88:91], a[120:123], v[176:179], v[88:91]
    v_exp_f32 v191, v191
    v_mfma_f32_16x16x32_bf16 v[92:95], a[124:127], v[176:179], v[92:95]
    v_cvt_pk_bf16_f32 v187, v190, v191
    v_mfma_f32_16x16x32_bf16 a[216:219], a[228:231], v[176:179], a[216:219]
    s_waitcnt vmcnt(20) lgkmcnt(0)
    s_barrier
    v_mfma_f32_16x16x32_bf16 v[160:163], a[0:3], a[128:131], v[200:203]
    v_exp_f32 v192, v192
    v_mfma_f32_16x16x32_bf16 v[160:163], a[4:7], a[132:135], v[160:163]
    ds_read_b64_tr_b16 a[32:33], v229 offset:32768
    ds_read_b64_tr_b16 a[34:35], v229 offset:36864
    v_mfma_f32_16x16x32_bf16 v[160:163], a[8:11], a[136:139], v[160:163]
    v_exp_f32 v193, v193
    v_mfma_f32_16x16x32_bf16 v[160:163], a[12:15], a[140:143], v[160:163]
    v_cvt_pk_bf16_f32 v192, v192, v193
    ds_read_b64_tr_b16 a[36:37], v230 offset:32768
    v_mfma_f32_16x16x32_bf16 v[164:167], a[16:19], a[128:131], v[200:203]
    v_exp_f32 v194, v194
    v_mfma_f32_16x16x32_bf16 v[164:167], a[20:23], a[132:135], v[164:167]
    s_add_u32 m0, s61, 24576
    s_nop 0
    buffer_load_dwordx4 v244, s[16:19], s75 offen offset:0 nt lds
    ds_read_b64_tr_b16 a[38:39], v230 offset:36864
    v_mfma_f32_16x16x32_bf16 v[164:167], a[24:27], a[136:139], v[164:167]
    v_exp_f32 v195, v195
    v_mfma_f32_16x16x32_bf16 v[164:167], a[28:31], a[140:143], v[164:167]
    v_cvt_pk_bf16_f32 v193, v194, v195
    v_mfma_f32_16x16x32_bf16 v[96:99], a[96:99], v[184:187], v[96:99]
    v_exp_f32 v196, v196
    v_mfma_f32_16x16x32_bf16 v[100:103], a[100:103], v[184:187], v[100:103]
    ds_read_b64_tr_b16 a[40:41], v231 offset:32768
    ds_read_b64_tr_b16 a[42:43], v231 offset:36864
    v_mfma_f32_16x16x32_bf16 v[104:107], a[104:107], v[184:187], v[104:107]
    v_exp_f32 v197, v197
    v_mfma_f32_16x16x32_bf16 v[108:111], a[108:111], v[184:187], v[108:111]
    v_cvt_pk_bf16_f32 v194, v196, v197
    v_mfma_f32_16x16x32_bf16 v[112:115], a[112:115], v[184:187], v[112:115]
    v_exp_f32 v198, v198
    v_mfma_f32_16x16x32_bf16 v[116:119], a[116:119], v[184:187], v[116:119]
    ds_read_b64_tr_b16 a[44:45], v232 offset:32768
    ds_read_b64_tr_b16 a[46:47], v232 offset:36864
    v_mfma_f32_16x16x32_bf16 v[120:123], a[120:123], v[184:187], v[120:123]
    v_exp_f32 v199, v199
    v_mfma_f32_16x16x32_bf16 v[124:127], a[124:127], v[184:187], v[124:127]
    v_cvt_pk_bf16_f32 v195, v198, v199
    v_mfma_f32_16x16x32_bf16 a[220:223], a[228:231], v[184:187], a[220:223]
    buffer_load_dwordx4 v253, s[16:19], s75 offen offset:1024 nt lds
    ds_read_b64_tr_b16 a[48:49], v233 offset:32768
    v_mfma_f32_16x16x32_bf16 v[168:171], a[0:3], a[144:147], v[204:207]
    v_exp_f32 v160, v160
    v_mfma_f32_16x16x32_bf16 v[168:171], a[4:7], a[148:151], v[168:171]
    ds_read_b64_tr_b16 a[50:51], v233 offset:36864
    ds_read_b64_tr_b16 a[52:53], v234 offset:32768
    v_mfma_f32_16x16x32_bf16 v[168:171], a[8:11], a[152:155], v[168:171]
    v_exp_f32 v161, v161
    v_mfma_f32_16x16x32_bf16 v[168:171], a[12:15], a[156:159], v[168:171]
    v_cvt_pk_bf16_f32 v160, v160, v161
    v_mfma_f32_16x16x32_bf16 v[172:175], a[16:19], a[144:147], v[204:207]
    v_exp_f32 v162, v162
    v_mfma_f32_16x16x32_bf16 v[172:175], a[20:23], a[148:151], v[172:175]
    ds_read_b64_tr_b16 a[54:55], v234 offset:36864
    ds_read_b64_tr_b16 a[56:57], v235 offset:32768
    v_mfma_f32_16x16x32_bf16 v[172:175], a[24:27], a[152:155], v[172:175]
    v_exp_f32 v163, v163
    v_mfma_f32_16x16x32_bf16 v[172:175], a[28:31], a[156:159], v[172:175]
    v_cvt_pk_bf16_f32 v161, v162, v163
    v_mfma_f32_16x16x32_bf16 v[128:131], a[96:99], v[192:195], v[128:131]
    v_exp_f32 v164, v164
    v_mfma_f32_16x16x32_bf16 v[132:135], a[100:103], v[192:195], v[132:135]
    buffer_load_dwordx4 v244, s[16:19], s75 offen offset:2048 nt lds
    ds_read_b64_tr_b16 a[58:59], v235 offset:36864
    v_mfma_f32_16x16x32_bf16 v[136:139], a[104:107], v[192:195], v[136:139]
    v_exp_f32 v165, v165
    v_mfma_f32_16x16x32_bf16 v[140:143], a[108:111], v[192:195], v[140:143]
    v_cvt_pk_bf16_f32 v162, v164, v165
    v_mfma_f32_16x16x32_bf16 v[144:147], a[112:115], v[192:195], v[144:147]
    v_exp_f32 v166, v166
    v_mfma_f32_16x16x32_bf16 v[148:151], a[116:119], v[192:195], v[148:151]
    ds_read_b64_tr_b16 a[60:61], v236 offset:32768
    v_mfma_f32_16x16x32_bf16 v[152:155], a[120:123], v[192:195], v[152:155]
    v_exp_f32 v167, v167
    v_mfma_f32_16x16x32_bf16 v[156:159], a[124:127], v[192:195], v[156:159]
    v_cvt_pk_bf16_f32 v163, v166, v167
    v_mfma_f32_16x16x32_bf16 a[224:227], a[228:231], v[192:195], a[224:227]
    ds_read_b64_tr_b16 a[62:63], v236 offset:36864
    v_mfma_f32_16x16x32_bf16 v[176:179], a[0:3], a[160:163], v[208:211]
    v_exp_f32 v168, v168
    v_mfma_f32_16x16x32_bf16 v[176:179], a[4:7], a[164:167], v[176:179]
    v_mfma_f32_16x16x32_bf16 v[176:179], a[8:11], a[168:171], v[176:179]
    v_exp_f32 v169, v169
    v_mfma_f32_16x16x32_bf16 v[176:179], a[12:15], a[172:175], v[176:179]
    v_cvt_pk_bf16_f32 v168, v168, v169
    v_mfma_f32_16x16x32_bf16 v[180:183], a[16:19], a[160:163], v[208:211]
    v_exp_f32 v170, v170
    v_mfma_f32_16x16x32_bf16 v[180:183], a[20:23], a[164:167], v[180:183]
    v_mfma_f32_16x16x32_bf16 v[180:183], a[24:27], a[168:171], v[180:183]
    v_exp_f32 v171, v171
    v_mfma_f32_16x16x32_bf16 v[180:183], a[28:31], a[172:175], v[180:183]
    v_cvt_pk_bf16_f32 v169, v170, v171
    s_waitcnt lgkmcnt(0)
    v_mfma_f32_16x16x32_bf16 v[0:3], a[32:35], v[160:163], v[0:3]
    v_exp_f32 v172, v172
    v_mfma_f32_16x16x32_bf16 v[4:7], a[36:39], v[160:163], v[4:7]
    v_mfma_f32_16x16x32_bf16 v[8:11], a[40:43], v[160:163], v[8:11]
    v_exp_f32 v173, v173
    v_mfma_f32_16x16x32_bf16 v[12:15], a[44:47], v[160:163], v[12:15]
    v_cvt_pk_bf16_f32 v170, v172, v173
    v_mfma_f32_16x16x32_bf16 v[16:19], a[48:51], v[160:163], v[16:19]
    v_exp_f32 v174, v174
    v_mfma_f32_16x16x32_bf16 v[20:23], a[52:55], v[160:163], v[20:23]
    v_mfma_f32_16x16x32_bf16 v[24:27], a[56:59], v[160:163], v[24:27]
    v_exp_f32 v175, v175
    v_mfma_f32_16x16x32_bf16 v[28:31], a[60:63], v[160:163], v[28:31]
    v_cvt_pk_bf16_f32 v171, v174, v175
    v_mfma_f32_16x16x32_bf16 a[208:211], a[228:231], v[160:163], a[208:211]
    s_waitcnt vmcnt(19)
    s_barrier
    v_mfma_f32_16x16x32_bf16 v[184:187], a[0:3], a[176:179], v[212:215]
    v_exp_f32 v176, v176
    v_mfma_f32_16x16x32_bf16 v[184:187], a[4:7], a[180:183], v[184:187]
    ds_read_b128 a[64:67], v225 offset:49152
    ds_read_b128 a[68:71], v226 offset:49152
    v_mfma_f32_16x16x32_bf16 v[184:187], a[8:11], a[184:187], v[184:187]
    v_exp_f32 v177, v177
    v_mfma_f32_16x16x32_bf16 v[184:187], a[12:15], a[188:191], v[184:187]
    v_cvt_pk_bf16_f32 v176, v176, v177
    v_mfma_f32_16x16x32_bf16 v[188:191], a[16:19], a[176:179], v[212:215]
    v_exp_f32 v178, v178
    v_mfma_f32_16x16x32_bf16 v[188:191], a[20:23], a[180:183], v[188:191]
    buffer_load_dwordx4 v253, s[16:19], s75 offen offset:3072 nt lds
    s_add_u32 s75, s75, 8192
    s_and_b32 s75, s75, 0x1e000
    s_or_b32 s75, s75, s60
    ds_read_b128 a[72:75], v227 offset:49152
    v_mfma_f32_16x16x32_bf16 v[188:191], a[24:27], a[184:187], v[188:191]
    v_exp_f32 v179, v179
    v_mfma_f32_16x16x32_bf16 v[188:191], a[28:31], a[188:191], v[188:191]
    v_cvt_pk_bf16_f32 v177, v178, v179
    v_mfma_f32_16x16x32_bf16 v[32:35], a[32:35], v[168:171], v[32:35]
    v_exp_f32 v180, v180
    v_mfma_f32_16x16x32_bf16 v[36:39], a[36:39], v[168:171], v[36:39]
    ds_read_b128 a[76:79], v228 offset:49152
    ds_read_b128 a[80:83], v225 offset:53248
    v_mfma_f32_16x16x32_bf16 v[40:43], a[40:43], v[168:171], v[40:43]
    v_exp_f32 v181, v181
    v_mfma_f32_16x16x32_bf16 v[44:47], a[44:47], v[168:171], v[44:47]
    v_cvt_pk_bf16_f32 v178, v180, v181
    v_mfma_f32_16x16x32_bf16 v[48:51], a[48:51], v[168:171], v[48:51]
    v_exp_f32 v182, v182
    v_mfma_f32_16x16x32_bf16 v[52:55], a[52:55], v[168:171], v[52:55]
    ds_read_b128 a[84:87], v226 offset:53248
    s_add_u32 m0, s61, 32768
    s_nop 0
    buffer_load_dwordx4 v237, s[24:27], s75 offen offset:0 nt lds
    v_mfma_f32_16x16x32_bf16 v[56:59], a[56:59], v[168:171], v[56:59]
    v_exp_f32 v183, v183
    v_mfma_f32_16x16x32_bf16 v[60:63], a[60:63], v[168:171], v[60:63]
    v_cvt_pk_bf16_f32 v179, v182, v183
    v_mfma_f32_16x16x32_bf16 a[212:215], a[228:231], v[168:171], a[212:215]
    ds_read_b128 a[88:91], v227 offset:53248
    ds_read_b128 a[92:95], v228 offset:53248
    v_mfma_f32_16x16x32_bf16 v[192:195], a[0:3], a[192:195], v[216:219]
    v_exp_f32 v184, v184
    v_mfma_f32_16x16x32_bf16 v[192:195], a[4:7], a[196:199], v[192:195]
    buffer_load_dwordx4 v238, s[24:27], s75 offen offset:1024 nt lds
    v_mfma_f32_16x16x32_bf16 v[192:195], a[8:11], a[200:203], v[192:195]
    v_exp_f32 v185, v185
    v_mfma_f32_16x16x32_bf16 v[192:195], a[12:15], a[204:207], v[192:195]
    v_cvt_pk_bf16_f32 v184, v184, v185
    v_mfma_f32_16x16x32_bf16 v[196:199], a[16:19], a[192:195], v[216:219]
    v_exp_f32 v186, v186
    v_mfma_f32_16x16x32_bf16 v[196:199], a[20:23], a[196:199], v[196:199]
    v_mfma_f32_16x16x32_bf16 v[196:199], a[24:27], a[200:203], v[196:199]
    v_exp_f32 v187, v187
    v_mfma_f32_16x16x32_bf16 v[196:199], a[28:31], a[204:207], v[196:199]
    v_cvt_pk_bf16_f32 v185, v186, v187
    v_mfma_f32_16x16x32_bf16 v[64:67], a[32:35], v[176:179], v[64:67]
    v_exp_f32 v188, v188
    v_mfma_f32_16x16x32_bf16 v[68:71], a[36:39], v[176:179], v[68:71]
    buffer_load_dwordx4 v239, s[24:27], s75 offen offset:2048 nt lds
    v_mfma_f32_16x16x32_bf16 v[72:75], a[40:43], v[176:179], v[72:75]
    v_exp_f32 v189, v189
    v_mfma_f32_16x16x32_bf16 v[76:79], a[44:47], v[176:179], v[76:79]
    v_cvt_pk_bf16_f32 v186, v188, v189
    v_mfma_f32_16x16x32_bf16 v[80:83], a[48:51], v[176:179], v[80:83]
    v_exp_f32 v190, v190
    v_mfma_f32_16x16x32_bf16 v[84:87], a[52:55], v[176:179], v[84:87]
    v_mfma_f32_16x16x32_bf16 v[88:91], a[56:59], v[176:179], v[88:91]
    v_exp_f32 v191, v191
    v_mfma_f32_16x16x32_bf16 v[92:95], a[60:63], v[176:179], v[92:95]
    v_cvt_pk_bf16_f32 v187, v190, v191
    v_mfma_f32_16x16x32_bf16 a[216:219], a[228:231], v[176:179], a[216:219]
    s_waitcnt vmcnt(19) lgkmcnt(0)
    s_barrier
    v_mfma_f32_16x16x32_bf16 v[160:163], a[64:67], a[128:131], v[200:203]
    v_exp_f32 v192, v192
    v_mfma_f32_16x16x32_bf16 v[160:163], a[68:71], a[132:135], v[160:163]
    ds_read_b64_tr_b16 a[96:97], v229 offset:49152
    buffer_load_dwordx4 v240, s[24:27], s75 offen offset:3072 nt lds
    v_mfma_f32_16x16x32_bf16 v[160:163], a[72:75], a[136:139], v[160:163]
    v_exp_f32 v193, v193
    v_mfma_f32_16x16x32_bf16 v[160:163], a[76:79], a[140:143], v[160:163]
    v_cvt_pk_bf16_f32 v192, v192, v193
    ds_read_b64_tr_b16 a[98:99], v229 offset:53248
    v_mfma_f32_16x16x32_bf16 v[164:167], a[80:83], a[128:131], v[200:203]
    v_exp_f32 v194, v194
    v_mfma_f32_16x16x32_bf16 v[164:167], a[84:87], a[132:135], v[164:167]
    ds_read_b64_tr_b16 a[100:101], v230 offset:49152
    ds_read_b64_tr_b16 a[102:103], v230 offset:53248
    v_mfma_f32_16x16x32_bf16 v[164:167], a[88:91], a[136:139], v[164:167]
    v_exp_f32 v195, v195
    v_mfma_f32_16x16x32_bf16 v[164:167], a[92:95], a[140:143], v[164:167]
    v_cvt_pk_bf16_f32 v193, v194, v195
    v_mfma_f32_16x16x32_bf16 v[96:99], a[32:35], v[184:187], v[96:99]
    v_exp_f32 v196, v196
    v_mfma_f32_16x16x32_bf16 v[100:103], a[36:39], v[184:187], v[100:103]
    ds_read_b64_tr_b16 a[104:105], v231 offset:49152
    ds_read_b64_tr_b16 a[106:107], v231 offset:53248
    v_mfma_f32_16x16x32_bf16 v[104:107], a[40:43], v[184:187], v[104:107]
    v_exp_f32 v197, v197
    v_mfma_f32_16x16x32_bf16 v[108:111], a[44:47], v[184:187], v[108:111]
    v_cvt_pk_bf16_f32 v194, v196, v197
    v_mfma_f32_16x16x32_bf16 v[112:115], a[48:51], v[184:187], v[112:115]
    v_exp_f32 v198, v198
    v_mfma_f32_16x16x32_bf16 v[116:119], a[52:55], v[184:187], v[116:119]
    s_add_u32 m0, s61, 40960
    s_nop 0
    buffer_load_dwordx4 v244, s[16:19], s75 offen offset:0 nt lds
    ds_read_b64_tr_b16 a[108:109], v232 offset:49152
    v_mfma_f32_16x16x32_bf16 v[120:123], a[56:59], v[184:187], v[120:123]
    v_exp_f32 v199, v199
    v_mfma_f32_16x16x32_bf16 v[124:127], a[60:63], v[184:187], v[124:127]
    v_cvt_pk_bf16_f32 v195, v198, v199
    v_mfma_f32_16x16x32_bf16 a[220:223], a[228:231], v[184:187], a[220:223]
    ds_read_b64_tr_b16 a[110:111], v232 offset:53248
    ds_read_b64_tr_b16 a[112:113], v233 offset:49152
    v_mfma_f32_16x16x32_bf16 v[168:171], a[64:67], a[144:147], v[204:207]
    v_exp_f32 v160, v160
    v_mfma_f32_16x16x32_bf16 v[168:171], a[68:71], a[148:151], v[168:171]
    ds_read_b64_tr_b16 a[114:115], v233 offset:53248
    ds_read_b64_tr_b16 a[116:117], v234 offset:49152
    v_mfma_f32_16x16x32_bf16 v[168:171], a[72:75], a[152:155], v[168:171]
    v_exp_f32 v161, v161
    v_mfma_f32_16x16x32_bf16 v[168:171], a[76:79], a[156:159], v[168:171]
    v_cvt_pk_bf16_f32 v160, v160, v161
    v_mfma_f32_16x16x32_bf16 v[172:175], a[80:83], a[144:147], v[204:207]
    v_exp_f32 v162, v162
    v_mfma_f32_16x16x32_bf16 v[172:175], a[84:87], a[148:151], v[172:175]
    buffer_load_dwordx4 v253, s[16:19], s75 offen offset:1024 nt lds
    ds_read_b64_tr_b16 a[118:119], v234 offset:53248
    v_mfma_f32_16x16x32_bf16 v[172:175], a[88:91], a[152:155], v[172:175]
    v_exp_f32 v163, v163
    v_mfma_f32_16x16x32_bf16 v[172:175], a[92:95], a[156:159], v[172:175]
    v_cvt_pk_bf16_f32 v161, v162, v163
    v_mfma_f32_16x16x32_bf16 v[128:131], a[32:35], v[192:195], v[128:131]
    v_exp_f32 v164, v164
    v_mfma_f32_16x16x32_bf16 v[132:135], a[36:39], v[192:195], v[132:135]
    ds_read_b64_tr_b16 a[120:121], v235 offset:49152
    ds_read_b64_tr_b16 a[122:123], v235 offset:53248
    v_mfma_f32_16x16x32_bf16 v[136:139], a[40:43], v[192:195], v[136:139]
    v_exp_f32 v165, v165
    v_mfma_f32_16x16x32_bf16 v[140:143], a[44:47], v[192:195], v[140:143]
    v_cvt_pk_bf16_f32 v162, v164, v165
    v_mfma_f32_16x16x32_bf16 v[144:147], a[48:51], v[192:195], v[144:147]
    v_exp_f32 v166, v166
    v_mfma_f32_16x16x32_bf16 v[148:151], a[52:55], v[192:195], v[148:151]
    buffer_load_dwordx4 v244, s[16:19], s75 offen offset:2048 nt lds
    ds_read_b64_tr_b16 a[124:125], v236 offset:49152
    v_mfma_f32_16x16x32_bf16 v[152:155], a[56:59], v[192:195], v[152:155]
    v_exp_f32 v167, v167
    v_mfma_f32_16x16x32_bf16 v[156:159], a[60:63], v[192:195], v[156:159]
    v_cvt_pk_bf16_f32 v163, v166, v167
    v_mfma_f32_16x16x32_bf16 a[224:227], a[228:231], v[192:195], a[224:227]
    ds_read_b64_tr_b16 a[126:127], v236 offset:53248
    v_mfma_f32_16x16x32_bf16 v[176:179], a[64:67], a[160:163], v[208:211]
    v_exp_f32 v168, v168
    v_mfma_f32_16x16x32_bf16 v[176:179], a[68:71], a[164:167], v[176:179]
    v_mfma_f32_16x16x32_bf16 v[176:179], a[72:75], a[168:171], v[176:179]
    v_exp_f32 v169, v169
    v_mfma_f32_16x16x32_bf16 v[176:179], a[76:79], a[172:175], v[176:179]
    v_cvt_pk_bf16_f32 v168, v168, v169
    v_mfma_f32_16x16x32_bf16 v[180:183], a[80:83], a[160:163], v[208:211]
    v_exp_f32 v170, v170
    v_mfma_f32_16x16x32_bf16 v[180:183], a[84:87], a[164:167], v[180:183]
    v_mfma_f32_16x16x32_bf16 v[180:183], a[88:91], a[168:171], v[180:183]
    v_exp_f32 v171, v171
    v_mfma_f32_16x16x32_bf16 v[180:183], a[92:95], a[172:175], v[180:183]
    v_cvt_pk_bf16_f32 v169, v170, v171
    s_waitcnt lgkmcnt(0)
    v_mfma_f32_16x16x32_bf16 v[0:3], a[96:99], v[160:163], v[0:3]
    v_exp_f32 v172, v172
    v_mfma_f32_16x16x32_bf16 v[4:7], a[100:103], v[160:163], v[4:7]
    v_mfma_f32_16x16x32_bf16 v[8:11], a[104:107], v[160:163], v[8:11]
    v_exp_f32 v173, v173
    v_mfma_f32_16x16x32_bf16 v[12:15], a[108:111], v[160:163], v[12:15]
    v_cvt_pk_bf16_f32 v170, v172, v173
    v_mfma_f32_16x16x32_bf16 v[16:19], a[112:115], v[160:163], v[16:19]
    v_exp_f32 v174, v174
    v_mfma_f32_16x16x32_bf16 v[20:23], a[116:119], v[160:163], v[20:23]
    v_mfma_f32_16x16x32_bf16 v[24:27], a[120:123], v[160:163], v[24:27]
    v_exp_f32 v175, v175
    v_mfma_f32_16x16x32_bf16 v[28:31], a[124:127], v[160:163], v[28:31]
    v_cvt_pk_bf16_f32 v171, v174, v175
    v_mfma_f32_16x16x32_bf16 a[208:211], a[228:231], v[160:163], a[208:211]
    s_waitcnt vmcnt(19)
    s_barrier
    v_mfma_f32_16x16x32_bf16 v[184:187], a[64:67], a[176:179], v[212:215]
    v_exp_f32 v176, v176
    v_mfma_f32_16x16x32_bf16 v[184:187], a[68:71], a[180:183], v[184:187]
    ds_read_b128 a[0:3], v225 offset:0
    ds_read_b128 a[4:7], v226 offset:0
    v_mfma_f32_16x16x32_bf16 v[184:187], a[72:75], a[184:187], v[184:187]
    v_exp_f32 v177, v177
    v_mfma_f32_16x16x32_bf16 v[184:187], a[76:79], a[188:191], v[184:187]
    v_cvt_pk_bf16_f32 v176, v176, v177
    v_mfma_f32_16x16x32_bf16 v[188:191], a[80:83], a[176:179], v[212:215]
    v_exp_f32 v178, v178
    v_mfma_f32_16x16x32_bf16 v[188:191], a[84:87], a[180:183], v[188:191]
    buffer_load_dwordx4 v253, s[16:19], s75 offen offset:3072 nt lds
    s_add_u32 s75, s75, 8192
    s_and_b32 s75, s75, 0x1e000
    s_or_b32 s75, s75, s60
    ds_read_b128 a[8:11], v227 offset:0
    v_mfma_f32_16x16x32_bf16 v[188:191], a[88:91], a[184:187], v[188:191]
    v_exp_f32 v179, v179
    v_mfma_f32_16x16x32_bf16 v[188:191], a[92:95], a[188:191], v[188:191]
    v_cvt_pk_bf16_f32 v177, v178, v179
    v_mfma_f32_16x16x32_bf16 v[32:35], a[96:99], v[168:171], v[32:35]
    v_exp_f32 v180, v180
    v_mfma_f32_16x16x32_bf16 v[36:39], a[100:103], v[168:171], v[36:39]
    ds_read_b128 a[12:15], v228 offset:0
    ds_read_b128 a[16:19], v225 offset:4096
    v_mfma_f32_16x16x32_bf16 v[40:43], a[104:107], v[168:171], v[40:43]
    v_exp_f32 v181, v181
    v_mfma_f32_16x16x32_bf16 v[44:47], a[108:111], v[168:171], v[44:47]
    v_cvt_pk_bf16_f32 v178, v180, v181
    v_mfma_f32_16x16x32_bf16 v[48:51], a[112:115], v[168:171], v[48:51]
    v_exp_f32 v182, v182
    v_mfma_f32_16x16x32_bf16 v[52:55], a[116:119], v[168:171], v[52:55]
    ds_read_b128 a[20:23], v226 offset:4096
    s_add_u32 m0, s61, 49152
    s_nop 0
    buffer_load_dwordx4 v237, s[24:27], s75 offen offset:0 nt lds
    v_mfma_f32_16x16x32_bf16 v[56:59], a[120:123], v[168:171], v[56:59]
    v_exp_f32 v183, v183
    v_mfma_f32_16x16x32_bf16 v[60:63], a[124:127], v[168:171], v[60:63]
    v_cvt_pk_bf16_f32 v179, v182, v183
    v_mfma_f32_16x16x32_bf16 a[212:215], a[228:231], v[168:171], a[212:215]
    ds_read_b128 a[24:27], v227 offset:4096
    ds_read_b128 a[28:31], v228 offset:4096
    v_mfma_f32_16x16x32_bf16 v[192:195], a[64:67], a[192:195], v[216:219]
    v_exp_f32 v184, v184
    v_mfma_f32_16x16x32_bf16 v[192:195], a[68:71], a[196:199], v[192:195]
    buffer_load_dwordx4 v238, s[24:27], s75 offen offset:1024 nt lds
    v_mfma_f32_16x16x32_bf16 v[192:195], a[72:75], a[200:203], v[192:195]
    v_exp_f32 v185, v185
    v_mfma_f32_16x16x32_bf16 v[192:195], a[76:79], a[204:207], v[192:195]
    v_cvt_pk_bf16_f32 v184, v184, v185
    v_mfma_f32_16x16x32_bf16 v[196:199], a[80:83], a[192:195], v[216:219]
    v_exp_f32 v186, v186
    v_mfma_f32_16x16x32_bf16 v[196:199], a[84:87], a[196:199], v[196:199]
    v_mfma_f32_16x16x32_bf16 v[196:199], a[88:91], a[200:203], v[196:199]
    v_exp_f32 v187, v187
    v_mfma_f32_16x16x32_bf16 v[196:199], a[92:95], a[204:207], v[196:199]
    v_cvt_pk_bf16_f32 v185, v186, v187
    v_mfma_f32_16x16x32_bf16 v[64:67], a[96:99], v[176:179], v[64:67]
    v_exp_f32 v188, v188
    v_mfma_f32_16x16x32_bf16 v[68:71], a[100:103], v[176:179], v[68:71]
    v_mfma_f32_16x16x32_bf16 v[72:75], a[104:107], v[176:179], v[72:75]
    v_exp_f32 v189, v189
    v_mfma_f32_16x16x32_bf16 v[76:79], a[108:111], v[176:179], v[76:79]
    v_cvt_pk_bf16_f32 v186, v188, v189
    v_mfma_f32_16x16x32_bf16 v[80:83], a[112:115], v[176:179], v[80:83]
    v_exp_f32 v190, v190
    v_mfma_f32_16x16x32_bf16 v[84:87], a[116:119], v[176:179], v[84:87]
    v_mfma_f32_16x16x32_bf16 v[88:91], a[120:123], v[176:179], v[88:91]
    v_exp_f32 v191, v191
    v_mfma_f32_16x16x32_bf16 v[92:95], a[124:127], v[176:179], v[92:95]
    v_cvt_pk_bf16_f32 v187, v190, v191
    v_mfma_f32_16x16x32_bf16 a[216:219], a[228:231], v[176:179], a[216:219]
    s_waitcnt vmcnt(18) lgkmcnt(0)
    s_barrier
    v_mfma_f32_16x16x32_bf16 v[160:163], a[0:3], a[128:131], v[200:203]
    v_exp_f32 v192, v192
    v_mfma_f32_16x16x32_bf16 v[160:163], a[4:7], a[132:135], v[160:163]
    ds_read_b64_tr_b16 a[32:33], v229 offset:0
    ds_read_b64_tr_b16 a[34:35], v229 offset:4096
    v_mfma_f32_16x16x32_bf16 v[160:163], a[8:11], a[136:139], v[160:163]
    v_exp_f32 v193, v193
    v_mfma_f32_16x16x32_bf16 v[160:163], a[12:15], a[140:143], v[160:163]
    v_cvt_pk_bf16_f32 v192, v192, v193
    buffer_load_dwordx4 v239, s[24:27], s75 offen offset:2048 nt lds
    v_mfma_f32_16x16x32_bf16 v[164:167], a[16:19], a[128:131], v[200:203]
    v_exp_f32 v194, v194
    v_mfma_f32_16x16x32_bf16 v[164:167], a[20:23], a[132:135], v[164:167]
    ds_read_b64_tr_b16 a[36:37], v230 offset:0
    ds_read_b64_tr_b16 a[38:39], v230 offset:4096
    v_mfma_f32_16x16x32_bf16 v[164:167], a[24:27], a[136:139], v[164:167]
    v_exp_f32 v195, v195
    v_mfma_f32_16x16x32_bf16 v[164:167], a[28:31], a[140:143], v[164:167]
    v_cvt_pk_bf16_f32 v193, v194, v195
    v_mfma_f32_16x16x32_bf16 v[96:99], a[96:99], v[184:187], v[96:99]
    v_exp_f32 v196, v196
    v_mfma_f32_16x16x32_bf16 v[100:103], a[100:103], v[184:187], v[100:103]
    ds_read_b64_tr_b16 a[40:41], v231 offset:0
    ds_read_b64_tr_b16 a[42:43], v231 offset:4096
    v_mfma_f32_16x16x32_bf16 v[104:107], a[104:107], v[184:187], v[104:107]
    v_exp_f32 v197, v197
    v_mfma_f32_16x16x32_bf16 v[108:111], a[108:111], v[184:187], v[108:111]
    v_cvt_pk_bf16_f32 v194, v196, v197
    v_mfma_f32_16x16x32_bf16 v[112:115], a[112:115], v[184:187], v[112:115]
    v_exp_f32 v198, v198
    v_mfma_f32_16x16x32_bf16 v[116:119], a[116:119], v[184:187], v[116:119]
    ds_read_b64_tr_b16 a[44:45], v232 offset:0
    buffer_load_dwordx4 v240, s[24:27], s75 offen offset:3072 nt lds
    v_mfma_f32_16x16x32_bf16 v[120:123], a[120:123], v[184:187], v[120:123]
    v_exp_f32 v199, v199
    v_mfma_f32_16x16x32_bf16 v[124:127], a[124:127], v[184:187], v[124:127]
    v_cvt_pk_bf16_f32 v195, v198, v199
    v_mfma_f32_16x16x32_bf16 a[220:223], a[228:231], v[184:187], a[220:223]
    ds_read_b64_tr_b16 a[46:47], v232 offset:4096
    ds_read_b64_tr_b16 a[48:49], v233 offset:0
    v_mfma_f32_16x16x32_bf16 v[168:171], a[0:3], a[144:147], v[204:207]
    v_exp_f32 v160, v160
    v_mfma_f32_16x16x32_bf16 v[168:171], a[4:7], a[148:151], v[168:171]
    ds_read_b64_tr_b16 a[50:51], v233 offset:4096
    ds_read_b64_tr_b16 a[52:53], v234 offset:0
    v_mfma_f32_16x16x32_bf16 v[168:171], a[8:11], a[152:155], v[168:171]
    v_exp_f32 v161, v161
    v_mfma_f32_16x16x32_bf16 v[168:171], a[12:15], a[156:159], v[168:171]
    v_cvt_pk_bf16_f32 v160, v160, v161
    v_mfma_f32_16x16x32_bf16 v[172:175], a[16:19], a[144:147], v[204:207]
    v_exp_f32 v162, v162
    v_mfma_f32_16x16x32_bf16 v[172:175], a[20:23], a[148:151], v[172:175]
    ds_read_b64_tr_b16 a[54:55], v234 offset:4096
    s_add_u32 m0, s61, 57344
    s_nop 0
    buffer_load_dwordx4 v244, s[16:19], s75 offen offset:0 nt lds
    v_mfma_f32_16x16x32_bf16 v[172:175], a[24:27], a[152:155], v[172:175]
    v_exp_f32 v163, v163
    v_mfma_f32_16x16x32_bf16 v[172:175], a[28:31], a[156:159], v[172:175]
    v_cvt_pk_bf16_f32 v161, v162, v163
    v_mfma_f32_16x16x32_bf16 v[128:131], a[96:99], v[192:195], v[128:131]
    v_exp_f32 v164, v164
    v_mfma_f32_16x16x32_bf16 v[132:135], a[100:103], v[192:195], v[132:135]
    ds_read_b64_tr_b16 a[56:57], v235 offset:0
    ds_read_b64_tr_b16 a[58:59], v235 offset:4096
    v_mfma_f32_16x16x32_bf16 v[136:139], a[104:107], v[192:195], v[136:139]
    v_exp_f32 v165, v165
    v_mfma_f32_16x16x32_bf16 v[140:143], a[108:111], v[192:195], v[140:143]
    v_cvt_pk_bf16_f32 v162, v164, v165
    v_mfma_f32_16x16x32_bf16 v[144:147], a[112:115], v[192:195], v[144:147]
    v_exp_f32 v166, v166
    v_mfma_f32_16x16x32_bf16 v[148:151], a[116:119], v[192:195], v[148:151]
    ds_read_b64_tr_b16 a[60:61], v236 offset:0
    buffer_load_dwordx4 v253, s[16:19], s75 offen offset:1024 nt lds
    v_mfma_f32_16x16x32_bf16 v[152:155], a[120:123], v[192:195], v[152:155]
    v_exp_f32 v167, v167
    v_mfma_f32_16x16x32_bf16 v[156:159], a[124:127], v[192:195], v[156:159]
    v_cvt_pk_bf16_f32 v163, v166, v167
    v_mfma_f32_16x16x32_bf16 a[224:227], a[228:231], v[192:195], a[224:227]
    ds_read_b64_tr_b16 a[62:63], v236 offset:4096
    v_mfma_f32_16x16x32_bf16 v[176:179], a[0:3], a[160:163], v[208:211]
    v_exp_f32 v168, v168
    v_mfma_f32_16x16x32_bf16 v[176:179], a[4:7], a[164:167], v[176:179]
    v_mfma_f32_16x16x32_bf16 v[176:179], a[8:11], a[168:171], v[176:179]
    v_exp_f32 v169, v169
    v_mfma_f32_16x16x32_bf16 v[176:179], a[12:15], a[172:175], v[176:179]
    v_cvt_pk_bf16_f32 v168, v168, v169
    v_mfma_f32_16x16x32_bf16 v[180:183], a[16:19], a[160:163], v[208:211]
    v_exp_f32 v170, v170
    v_mfma_f32_16x16x32_bf16 v[180:183], a[20:23], a[164:167], v[180:183]
    v_mfma_f32_16x16x32_bf16 v[180:183], a[24:27], a[168:171], v[180:183]
    v_exp_f32 v171, v171
    v_mfma_f32_16x16x32_bf16 v[180:183], a[28:31], a[172:175], v[180:183]
    v_cvt_pk_bf16_f32 v169, v170, v171
    s_waitcnt lgkmcnt(0)
    v_mfma_f32_16x16x32_bf16 v[0:3], a[32:35], v[160:163], v[0:3]
    v_exp_f32 v172, v172
    v_mfma_f32_16x16x32_bf16 v[4:7], a[36:39], v[160:163], v[4:7]
    v_mfma_f32_16x16x32_bf16 v[8:11], a[40:43], v[160:163], v[8:11]
    v_exp_f32 v173, v173
    v_mfma_f32_16x16x32_bf16 v[12:15], a[44:47], v[160:163], v[12:15]
    v_cvt_pk_bf16_f32 v170, v172, v173
    v_mfma_f32_16x16x32_bf16 v[16:19], a[48:51], v[160:163], v[16:19]
    v_exp_f32 v174, v174
    v_mfma_f32_16x16x32_bf16 v[20:23], a[52:55], v[160:163], v[20:23]
    v_mfma_f32_16x16x32_bf16 v[24:27], a[56:59], v[160:163], v[24:27]
    v_exp_f32 v175, v175
    v_mfma_f32_16x16x32_bf16 v[28:31], a[60:63], v[160:163], v[28:31]
    v_cvt_pk_bf16_f32 v171, v174, v175
    v_mfma_f32_16x16x32_bf16 a[208:211], a[228:231], v[160:163], a[208:211]
    s_waitcnt vmcnt(18)
    s_barrier
    v_mfma_f32_16x16x32_bf16 v[184:187], a[0:3], a[176:179], v[212:215]
    v_exp_f32 v176, v176
    v_mfma_f32_16x16x32_bf16 v[184:187], a[4:7], a[180:183], v[184:187]
    ds_read_b128 a[64:67], v225 offset:16384
    buffer_load_dwordx4 v244, s[16:19], s75 offen offset:2048 nt lds
    v_mfma_f32_16x16x32_bf16 v[184:187], a[8:11], a[184:187], v[184:187]
    v_exp_f32 v177, v177
    v_mfma_f32_16x16x32_bf16 v[184:187], a[12:15], a[188:191], v[184:187]
    v_cvt_pk_bf16_f32 v176, v176, v177
    v_mfma_f32_16x16x32_bf16 v[188:191], a[16:19], a[176:179], v[212:215]
    v_exp_f32 v178, v178
    v_mfma_f32_16x16x32_bf16 v[188:191], a[20:23], a[180:183], v[188:191]
    ds_read_b128 a[68:71], v226 offset:16384
    ds_read_b128 a[72:75], v227 offset:16384
    v_mfma_f32_16x16x32_bf16 v[188:191], a[24:27], a[184:187], v[188:191]
    v_exp_f32 v179, v179
    v_mfma_f32_16x16x32_bf16 v[188:191], a[28:31], a[188:191], v[188:191]
    v_cvt_pk_bf16_f32 v177, v178, v179
    v_mfma_f32_16x16x32_bf16 v[32:35], a[32:35], v[168:171], v[32:35]
    v_exp_f32 v180, v180
    v_mfma_f32_16x16x32_bf16 v[36:39], a[36:39], v[168:171], v[36:39]
    ds_read_b128 a[76:79], v228 offset:16384
    ds_read_b128 a[80:83], v225 offset:20480
    v_mfma_f32_16x16x32_bf16 v[40:43], a[40:43], v[168:171], v[40:43]
    v_exp_f32 v181, v181
    v_mfma_f32_16x16x32_bf16 v[44:47], a[44:47], v[168:171], v[44:47]
    v_cvt_pk_bf16_f32 v178, v180, v181
    v_mfma_f32_16x16x32_bf16 v[48:51], a[48:51], v[168:171], v[48:51]
    v_exp_f32 v182, v182
    v_mfma_f32_16x16x32_bf16 v[52:55], a[52:55], v[168:171], v[52:55]
    buffer_load_dwordx4 v253, s[16:19], s75 offen offset:3072 nt lds
    s_add_u32 s75, s75, 8192
    s_and_b32 s75, s75, 0x1e000
    s_or_b32 s75, s75, s60
    ds_read_b128 a[84:87], v226 offset:20480
    v_mfma_f32_16x16x32_bf16 v[56:59], a[56:59], v[168:171], v[56:59]
    v_exp_f32 v183, v183
    v_mfma_f32_16x16x32_bf16 v[60:63], a[60:63], v[168:171], v[60:63]
    v_cvt_pk_bf16_f32 v179, v182, v183
    v_mfma_f32_16x16x32_bf16 a[212:215], a[228:231], v[168:171], a[212:215]
    ds_read_b128 a[88:91], v227 offset:20480
    ds_read_b128 a[92:95], v228 offset:20480
    v_mfma_f32_16x16x32_bf16 v[192:195], a[0:3], a[192:195], v[216:219]
    v_exp_f32 v184, v184
    v_mfma_f32_16x16x32_bf16 v[192:195], a[4:7], a[196:199], v[192:195]
    s_add_u32 m0, s61, 0
    s_nop 0
    buffer_load_dwordx4 v237, s[24:27], s75 offen offset:0 nt lds
    v_mfma_f32_16x16x32_bf16 v[192:195], a[8:11], a[200:203], v[192:195]
    v_exp_f32 v185, v185
    v_mfma_f32_16x16x32_bf16 v[192:195], a[12:15], a[204:207], v[192:195]
    v_cvt_pk_bf16_f32 v184, v184, v185
    v_mfma_f32_16x16x32_bf16 v[196:199], a[16:19], a[192:195], v[216:219]
    v_exp_f32 v186, v186
    v_mfma_f32_16x16x32_bf16 v[196:199], a[20:23], a[196:199], v[196:199]
    v_mfma_f32_16x16x32_bf16 v[196:199], a[24:27], a[200:203], v[196:199]
    v_exp_f32 v187, v187
    v_mfma_f32_16x16x32_bf16 v[196:199], a[28:31], a[204:207], v[196:199]
    v_cvt_pk_bf16_f32 v185, v186, v187
    v_mfma_f32_16x16x32_bf16 v[64:67], a[32:35], v[176:179], v[64:67]
    v_exp_f32 v188, v188
    v_mfma_f32_16x16x32_bf16 v[68:71], a[36:39], v[176:179], v[68:71]
    buffer_load_dwordx4 v238, s[24:27], s75 offen offset:1024 nt lds
    v_mfma_f32_16x16x32_bf16 v[72:75], a[40:43], v[176:179], v[72:75]
    v_exp_f32 v189, v189
    v_mfma_f32_16x16x32_bf16 v[76:79], a[44:47], v[176:179], v[76:79]
    v_cvt_pk_bf16_f32 v186, v188, v189
    v_mfma_f32_16x16x32_bf16 v[80:83], a[48:51], v[176:179], v[80:83]
    v_exp_f32 v190, v190
    v_mfma_f32_16x16x32_bf16 v[84:87], a[52:55], v[176:179], v[84:87]
    v_mfma_f32_16x16x32_bf16 v[88:91], a[56:59], v[176:179], v[88:91]
    v_exp_f32 v191, v191
    v_mfma_f32_16x16x32_bf16 v[92:95], a[60:63], v[176:179], v[92:95]
    v_cvt_pk_bf16_f32 v187, v190, v191
    v_mfma_f32_16x16x32_bf16 a[216:219], a[228:231], v[176:179], a[216:219]
    s_waitcnt vmcnt(18) lgkmcnt(0)
    s_barrier
    v_mfma_f32_16x16x32_bf16 v[160:163], a[64:67], a[128:131], v[200:203]
    v_exp_f32 v192, v192
    v_mfma_f32_16x16x32_bf16 v[160:163], a[68:71], a[132:135], v[160:163]
    ds_read_b64_tr_b16 a[96:97], v229 offset:16384
    ds_read_b64_tr_b16 a[98:99], v229 offset:20480
    v_mfma_f32_16x16x32_bf16 v[160:163], a[72:75], a[136:139], v[160:163]
    v_exp_f32 v193, v193
    v_mfma_f32_16x16x32_bf16 v[160:163], a[76:79], a[140:143], v[160:163]
    v_cvt_pk_bf16_f32 v192, v192, v193
    buffer_load_dwordx4 v239, s[24:27], s75 offen offset:2048 nt lds
    v_mfma_f32_16x16x32_bf16 v[164:167], a[80:83], a[128:131], v[200:203]
    v_exp_f32 v194, v194
    v_mfma_f32_16x16x32_bf16 v[164:167], a[84:87], a[132:135], v[164:167]
    ds_read_b64_tr_b16 a[100:101], v230 offset:16384
    ds_read_b64_tr_b16 a[102:103], v230 offset:20480
    v_mfma_f32_16x16x32_bf16 v[164:167], a[88:91], a[136:139], v[164:167]
    v_exp_f32 v195, v195
    v_mfma_f32_16x16x32_bf16 v[164:167], a[92:95], a[140:143], v[164:167]
    v_cvt_pk_bf16_f32 v193, v194, v195
    v_mfma_f32_16x16x32_bf16 v[96:99], a[32:35], v[184:187], v[96:99]
    v_exp_f32 v196, v196
    v_mfma_f32_16x16x32_bf16 v[100:103], a[36:39], v[184:187], v[100:103]
    ds_read_b64_tr_b16 a[104:105], v231 offset:16384
    ds_read_b64_tr_b16 a[106:107], v231 offset:20480
    v_mfma_f32_16x16x32_bf16 v[104:107], a[40:43], v[184:187], v[104:107]
    v_exp_f32 v197, v197
    v_mfma_f32_16x16x32_bf16 v[108:111], a[44:47], v[184:187], v[108:111]
    v_cvt_pk_bf16_f32 v194, v196, v197
    v_mfma_f32_16x16x32_bf16 v[112:115], a[48:51], v[184:187], v[112:115]
    v_exp_f32 v198, v198
    v_mfma_f32_16x16x32_bf16 v[116:119], a[52:55], v[184:187], v[116:119]
    ds_read_b64_tr_b16 a[108:109], v232 offset:16384
    buffer_load_dwordx4 v240, s[24:27], s75 offen offset:3072 nt lds
    v_mfma_f32_16x16x32_bf16 v[120:123], a[56:59], v[184:187], v[120:123]
    v_exp_f32 v199, v199
    v_mfma_f32_16x16x32_bf16 v[124:127], a[60:63], v[184:187], v[124:127]
    v_cvt_pk_bf16_f32 v195, v198, v199
    v_mfma_f32_16x16x32_bf16 a[220:223], a[228:231], v[184:187], a[220:223]
    ds_read_b64_tr_b16 a[110:111], v232 offset:20480
    ds_read_b64_tr_b16 a[112:113], v233 offset:16384
    v_mfma_f32_16x16x32_bf16 v[168:171], a[64:67], a[144:147], v[204:207]
    v_exp_f32 v160, v160
    v_mfma_f32_16x16x32_bf16 v[168:171], a[68:71], a[148:151], v[168:171]
    ds_read_b64_tr_b16 a[114:115], v233 offset:20480
    ds_read_b64_tr_b16 a[116:117], v234 offset:16384
    v_mfma_f32_16x16x32_bf16 v[168:171], a[72:75], a[152:155], v[168:171]
    v_exp_f32 v161, v161
    v_mfma_f32_16x16x32_bf16 v[168:171], a[76:79], a[156:159], v[168:171]
    v_cvt_pk_bf16_f32 v160, v160, v161
    v_mfma_f32_16x16x32_bf16 v[172:175], a[80:83], a[144:147], v[204:207]
    v_exp_f32 v162, v162
    v_mfma_f32_16x16x32_bf16 v[172:175], a[84:87], a[148:151], v[172:175]
    ds_read_b64_tr_b16 a[118:119], v234 offset:20480
    ds_read_b64_tr_b16 a[120:121], v235 offset:16384
    v_mfma_f32_16x16x32_bf16 v[172:175], a[88:91], a[152:155], v[172:175]
    v_exp_f32 v163, v163
    v_mfma_f32_16x16x32_bf16 v[172:175], a[92:95], a[156:159], v[172:175]
    v_cvt_pk_bf16_f32 v161, v162, v163
    v_mfma_f32_16x16x32_bf16 v[128:131], a[32:35], v[192:195], v[128:131]
    v_exp_f32 v164, v164
    v_mfma_f32_16x16x32_bf16 v[132:135], a[36:39], v[192:195], v[132:135]
    s_add_u32 m0, s61, 8192
    s_nop 0
    buffer_load_dwordx4 v244, s[16:19], s75 offen offset:0 nt lds
    ds_read_b64_tr_b16 a[122:123], v235 offset:20480
    v_mfma_f32_16x16x32_bf16 v[136:139], a[40:43], v[192:195], v[136:139]
    v_exp_f32 v165, v165
    v_mfma_f32_16x16x32_bf16 v[140:143], a[44:47], v[192:195], v[140:143]
    v_cvt_pk_bf16_f32 v162, v164, v165
    v_mfma_f32_16x16x32_bf16 v[144:147], a[48:51], v[192:195], v[144:147]
    v_exp_f32 v166, v166
    v_mfma_f32_16x16x32_bf16 v[148:151], a[52:55], v[192:195], v[148:151]
    ds_read_b64_tr_b16 a[124:125], v236 offset:16384
    v_mfma_f32_16x16x32_bf16 v[152:155], a[56:59], v[192:195], v[152:155]
    v_exp_f32 v167, v167
    v_mfma_f32_16x16x32_bf16 v[156:159], a[60:63], v[192:195], v[156:159]
    v_cvt_pk_bf16_f32 v163, v166, v167
    v_mfma_f32_16x16x32_bf16 a[224:227], a[228:231], v[192:195], a[224:227]
    ds_read_b64_tr_b16 a[126:127], v236 offset:20480
    v_mfma_f32_16x16x32_bf16 v[176:179], a[64:67], a[160:163], v[208:211]
    v_exp_f32 v168, v168
    v_mfma_f32_16x16x32_bf16 v[176:179], a[68:71], a[164:167], v[176:179]
    v_mfma_f32_16x16x32_bf16 v[176:179], a[72:75], a[168:171], v[176:179]
    v_exp_f32 v169, v169
    v_mfma_f32_16x16x32_bf16 v[176:179], a[76:79], a[172:175], v[176:179]
    v_cvt_pk_bf16_f32 v168, v168, v169
    v_mfma_f32_16x16x32_bf16 v[180:183], a[80:83], a[160:163], v[208:211]
    v_exp_f32 v170, v170
    v_mfma_f32_16x16x32_bf16 v[180:183], a[84:87], a[164:167], v[180:183]
    v_mfma_f32_16x16x32_bf16 v[180:183], a[88:91], a[168:171], v[180:183]
    v_exp_f32 v171, v171
    v_mfma_f32_16x16x32_bf16 v[180:183], a[92:95], a[172:175], v[180:183]
    v_cvt_pk_bf16_f32 v169, v170, v171
    s_waitcnt lgkmcnt(0)
    v_mfma_f32_16x16x32_bf16 v[0:3], a[96:99], v[160:163], v[0:3]
    v_exp_f32 v172, v172
    v_mfma_f32_16x16x32_bf16 v[4:7], a[100:103], v[160:163], v[4:7]
    v_mfma_f32_16x16x32_bf16 v[8:11], a[104:107], v[160:163], v[8:11]
    v_exp_f32 v173, v173
    v_mfma_f32_16x16x32_bf16 v[12:15], a[108:111], v[160:163], v[12:15]
    v_cvt_pk_bf16_f32 v170, v172, v173
    v_mfma_f32_16x16x32_bf16 v[16:19], a[112:115], v[160:163], v[16:19]
    v_exp_f32 v174, v174
    v_mfma_f32_16x16x32_bf16 v[20:23], a[116:119], v[160:163], v[20:23]
    v_mfma_f32_16x16x32_bf16 v[24:27], a[120:123], v[160:163], v[24:27]
    v_exp_f32 v175, v175
    v_mfma_f32_16x16x32_bf16 v[28:31], a[124:127], v[160:163], v[28:31]
    v_cvt_pk_bf16_f32 v171, v174, v175
    v_mfma_f32_16x16x32_bf16 a[208:211], a[228:231], v[160:163], a[208:211]
    s_waitcnt vmcnt(17)
    s_barrier
    v_mfma_f32_16x16x32_bf16 v[184:187], a[64:67], a[176:179], v[212:215]
    v_exp_f32 v176, v176
    v_mfma_f32_16x16x32_bf16 v[184:187], a[68:71], a[180:183], v[184:187]
    ds_read_b128 a[0:3], v225 offset:32768
    ds_read_b128 a[4:7], v226 offset:32768
    v_mfma_f32_16x16x32_bf16 v[184:187], a[72:75], a[184:187], v[184:187]
    v_exp_f32 v177, v177
    v_mfma_f32_16x16x32_bf16 v[184:187], a[76:79], a[188:191], v[184:187]
    v_cvt_pk_bf16_f32 v176, v176, v177
    v_mfma_f32_16x16x32_bf16 v[188:191], a[80:83], a[176:179], v[212:215]
    v_exp_f32 v178, v178
    v_mfma_f32_16x16x32_bf16 v[188:191], a[84:87], a[180:183], v[188:191]
    buffer_load_dwordx4 v253, s[16:19], s75 offen offset:1024 nt lds
    ds_read_b128 a[8:11], v227 offset:32768
    v_mfma_f32_16x16x32_bf16 v[188:191], a[88:91], a[184:187], v[188:191]
    v_exp_f32 v179, v179
    v_mfma_f32_16x16x32_bf16 v[188:191], a[92:95], a[188:191], v[188:191]
    v_cvt_pk_bf16_f32 v177, v178, v179
    v_mfma_f32_16x16x32_bf16 v[32:35], a[96:99], v[168:171], v[32:35]
    v_exp_f32 v180, v180
    v_mfma_f32_16x16x32_bf16 v[36:39], a[100:103], v[168:171], v[36:39]
    ds_read_b128 a[12:15], v228 offset:32768
    ds_read_b128 a[16:19], v225 offset:36864
    v_mfma_f32_16x16x32_bf16 v[40:43], a[104:107], v[168:171], v[40:43]
    v_exp_f32 v181, v181
    v_mfma_f32_16x16x32_bf16 v[44:47], a[108:111], v[168:171], v[44:47]
    v_cvt_pk_bf16_f32 v178, v180, v181
    v_mfma_f32_16x16x32_bf16 v[48:51], a[112:115], v[168:171], v[48:51]
    v_exp_f32 v182, v182
    v_mfma_f32_16x16x32_bf16 v[52:55], a[116:119], v[168:171], v[52:55]
    ds_read_b128 a[20:23], v226 offset:36864
    buffer_load_dwordx4 v244, s[16:19], s75 offen offset:2048 nt lds
    v_mfma_f32_16x16x32_bf16 v[56:59], a[120:123], v[168:171], v[56:59]
    v_exp_f32 v183, v183
    v_mfma_f32_16x16x32_bf16 v[60:63], a[124:127], v[168:171], v[60:63]
    v_cvt_pk_bf16_f32 v179, v182, v183
    v_mfma_f32_16x16x32_bf16 a[212:215], a[228:231], v[168:171], a[212:215]
    ds_read_b128 a[24:27], v227 offset:36864
    ds_read_b128 a[28:31], v228 offset:36864
    v_mfma_f32_16x16x32_bf16 v[192:195], a[64:67], a[192:195], v[216:219]
    v_exp_f32 v184, v184
    v_mfma_f32_16x16x32_bf16 v[192:195], a[68:71], a[196:199], v[192:195]
    buffer_load_dwordx4 v253, s[16:19], s75 offen offset:3072 nt lds
    s_add_u32 s75, s75, 8192
    s_and_b32 s75, s75, 0x1e000
    s_or_b32 s75, s75, s60
    v_mfma_f32_16x16x32_bf16 v[192:195], a[72:75], a[200:203], v[192:195]
    v_exp_f32 v185, v185
    v_mfma_f32_16x16x32_bf16 v[192:195], a[76:79], a[204:207], v[192:195]
    v_cvt_pk_bf16_f32 v184, v184, v185
    v_mfma_f32_16x16x32_bf16 v[196:199], a[80:83], a[192:195], v[216:219]
    v_exp_f32 v186, v186
    v_mfma_f32_16x16x32_bf16 v[196:199], a[84:87], a[196:199], v[196:199]
    v_mfma_f32_16x16x32_bf16 v[196:199], a[88:91], a[200:203], v[196:199]
    v_exp_f32 v187, v187
    v_mfma_f32_16x16x32_bf16 v[196:199], a[92:95], a[204:207], v[196:199]
    v_cvt_pk_bf16_f32 v185, v186, v187
    v_mfma_f32_16x16x32_bf16 v[64:67], a[96:99], v[176:179], v[64:67]
    v_exp_f32 v188, v188
    v_mfma_f32_16x16x32_bf16 v[68:71], a[100:103], v[176:179], v[68:71]
    s_add_u32 m0, s61, 16384
    s_nop 0
    buffer_load_dwordx4 v237, s[24:27], s75 offen offset:0 nt lds
    v_mfma_f32_16x16x32_bf16 v[72:75], a[104:107], v[176:179], v[72:75]
    v_exp_f32 v189, v189
    v_mfma_f32_16x16x32_bf16 v[76:79], a[108:111], v[176:179], v[76:79]
    v_cvt_pk_bf16_f32 v186, v188, v189
    v_mfma_f32_16x16x32_bf16 v[80:83], a[112:115], v[176:179], v[80:83]
    v_exp_f32 v190, v190
    v_mfma_f32_16x16x32_bf16 v[84:87], a[116:119], v[176:179], v[84:87]
    v_mfma_f32_16x16x32_bf16 v[88:91], a[120:123], v[176:179], v[88:91]
    v_exp_f32 v191, v191
    v_mfma_f32_16x16x32_bf16 v[92:95], a[124:127], v[176:179], v[92:95]
    v_cvt_pk_bf16_f32 v187, v190, v191
    v_mfma_f32_16x16x32_bf16 a[216:219], a[228:231], v[176:179], a[216:219]
    s_waitcnt vmcnt(17) lgkmcnt(0)
    s_barrier
    v_mfma_f32_16x16x32_bf16 v[160:163], a[0:3], a[128:131], v[200:203]
    v_exp_f32 v192, v192
    v_mfma_f32_16x16x32_bf16 v[160:163], a[4:7], a[132:135], v[160:163]
    ds_read_b64_tr_b16 a[32:33], v229 offset:32768
    ds_read_b64_tr_b16 a[34:35], v229 offset:36864
    v_mfma_f32_16x16x32_bf16 v[160:163], a[8:11], a[136:139], v[160:163]
    v_exp_f32 v193, v193
    v_mfma_f32_16x16x32_bf16 v[160:163], a[12:15], a[140:143], v[160:163]
    v_cvt_pk_bf16_f32 v192, v192, v193
    buffer_load_dwordx4 v238, s[24:27], s75 offen offset:1024 nt lds
    v_mfma_f32_16x16x32_bf16 v[164:167], a[16:19], a[128:131], v[200:203]
    v_exp_f32 v194, v194
    v_mfma_f32_16x16x32_bf16 v[164:167], a[20:23], a[132:135], v[164:167]
    ds_read_b64_tr_b16 a[36:37], v230 offset:32768
    ds_read_b64_tr_b16 a[38:39], v230 offset:36864
    v_mfma_f32_16x16x32_bf16 v[164:167], a[24:27], a[136:139], v[164:167]
    v_exp_f32 v195, v195
    v_mfma_f32_16x16x32_bf16 v[164:167], a[28:31], a[140:143], v[164:167]
    v_cvt_pk_bf16_f32 v193, v194, v195
    v_mfma_f32_16x16x32_bf16 v[96:99], a[96:99], v[184:187], v[96:99]
    v_exp_f32 v196, v196
    v_mfma_f32_16x16x32_bf16 v[100:103], a[100:103], v[184:187], v[100:103]
    ds_read_b64_tr_b16 a[40:41], v231 offset:32768
    ds_read_b64_tr_b16 a[42:43], v231 offset:36864
    v_mfma_f32_16x16x32_bf16 v[104:107], a[104:107], v[184:187], v[104:107]
    v_exp_f32 v197, v197
    v_mfma_f32_16x16x32_bf16 v[108:111], a[108:111], v[184:187], v[108:111]
    v_cvt_pk_bf16_f32 v194, v196, v197
    v_mfma_f32_16x16x32_bf16 v[112:115], a[112:115], v[184:187], v[112:115]
    v_exp_f32 v198, v198
    v_mfma_f32_16x16x32_bf16 v[116:119], a[116:119], v[184:187], v[116:119]
    ds_read_b64_tr_b16 a[44:45], v232 offset:32768
    buffer_load_dwordx4 v239, s[24:27], s75 offen offset:2048 nt lds
    v_mfma_f32_16x16x32_bf16 v[120:123], a[120:123], v[184:187], v[120:123]
    v_exp_f32 v199, v199
    v_mfma_f32_16x16x32_bf16 v[124:127], a[124:127], v[184:187], v[124:127]
    v_cvt_pk_bf16_f32 v195, v198, v199
    v_mfma_f32_16x16x32_bf16 a[220:223], a[228:231], v[184:187], a[220:223]
    ds_read_b64_tr_b16 a[46:47], v232 offset:36864
    ds_read_b64_tr_b16 a[48:49], v233 offset:32768
    v_mfma_f32_16x16x32_bf16 v[168:171], a[0:3], a[144:147], v[204:207]
    v_exp_f32 v160, v160
    v_mfma_f32_16x16x32_bf16 v[168:171], a[4:7], a[148:151], v[168:171]
    ds_read_b64_tr_b16 a[50:51], v233 offset:36864
    buffer_load_dwordx4 v240, s[24:27], s75 offen offset:3072 nt lds
    v_mfma_f32_16x16x32_bf16 v[168:171], a[8:11], a[152:155], v[168:171]
    v_exp_f32 v161, v161
    v_mfma_f32_16x16x32_bf16 v[168:171], a[12:15], a[156:159], v[168:171]
    v_cvt_pk_bf16_f32 v160, v160, v161
    v_mfma_f32_16x16x32_bf16 v[172:175], a[16:19], a[144:147], v[204:207]
    v_exp_f32 v162, v162
    v_mfma_f32_16x16x32_bf16 v[172:175], a[20:23], a[148:151], v[172:175]
    ds_read_b64_tr_b16 a[52:53], v234 offset:32768
    ds_read_b64_tr_b16 a[54:55], v234 offset:36864
    v_mfma_f32_16x16x32_bf16 v[172:175], a[24:27], a[152:155], v[172:175]
    v_exp_f32 v163, v163
    v_mfma_f32_16x16x32_bf16 v[172:175], a[28:31], a[156:159], v[172:175]
    v_cvt_pk_bf16_f32 v161, v162, v163
    v_mfma_f32_16x16x32_bf16 v[128:131], a[96:99], v[192:195], v[128:131]
    v_exp_f32 v164, v164
    v_mfma_f32_16x16x32_bf16 v[132:135], a[100:103], v[192:195], v[132:135]
    ds_read_b64_tr_b16 a[56:57], v235 offset:32768
    s_add_u32 m0, s61, 24576
    s_nop 0
    buffer_load_dwordx4 v244, s[16:19], s75 offen offset:0 nt lds
    v_mfma_f32_16x16x32_bf16 v[136:139], a[104:107], v[192:195], v[136:139]
    v_exp_f32 v165, v165
    v_mfma_f32_16x16x32_bf16 v[140:143], a[108:111], v[192:195], v[140:143]
    v_cvt_pk_bf16_f32 v162, v164, v165
    v_mfma_f32_16x16x32_bf16 v[144:147], a[112:115], v[192:195], v[144:147]
    v_exp_f32 v166, v166
    v_mfma_f32_16x16x32_bf16 v[148:151], a[116:119], v[192:195], v[148:151]
    ds_read_b64_tr_b16 a[58:59], v235 offset:36864
    ds_read_b64_tr_b16 a[60:61], v236 offset:32768
    v_mfma_f32_16x16x32_bf16 v[152:155], a[120:123], v[192:195], v[152:155]
    v_exp_f32 v167, v167
    v_mfma_f32_16x16x32_bf16 v[156:159], a[124:127], v[192:195], v[156:159]
    v_cvt_pk_bf16_f32 v163, v166, v167
    v_mfma_f32_16x16x32_bf16 a[224:227], a[228:231], v[192:195], a[224:227]
    ds_read_b64_tr_b16 a[62:63], v236 offset:36864
    v_mfma_f32_16x16x32_bf16 v[176:179], a[0:3], a[160:163], v[208:211]
    v_exp_f32 v168, v168
    v_mfma_f32_16x16x32_bf16 v[176:179], a[4:7], a[164:167], v[176:179]
    v_mfma_f32_16x16x32_bf16 v[176:179], a[8:11], a[168:171], v[176:179]
    v_exp_f32 v169, v169
    v_mfma_f32_16x16x32_bf16 v[176:179], a[12:15], a[172:175], v[176:179]
    v_cvt_pk_bf16_f32 v168, v168, v169
    v_mfma_f32_16x16x32_bf16 v[180:183], a[16:19], a[160:163], v[208:211]
    v_exp_f32 v170, v170
    v_mfma_f32_16x16x32_bf16 v[180:183], a[20:23], a[164:167], v[180:183]
    v_mfma_f32_16x16x32_bf16 v[180:183], a[24:27], a[168:171], v[180:183]
    v_exp_f32 v171, v171
    v_mfma_f32_16x16x32_bf16 v[180:183], a[28:31], a[172:175], v[180:183]
    v_cvt_pk_bf16_f32 v169, v170, v171
    s_waitcnt lgkmcnt(0)
    v_mfma_f32_16x16x32_bf16 v[0:3], a[32:35], v[160:163], v[0:3]
    v_exp_f32 v172, v172
    v_mfma_f32_16x16x32_bf16 v[4:7], a[36:39], v[160:163], v[4:7]
    v_mfma_f32_16x16x32_bf16 v[8:11], a[40:43], v[160:163], v[8:11]
    v_exp_f32 v173, v173
    v_mfma_f32_16x16x32_bf16 v[12:15], a[44:47], v[160:163], v[12:15]
    v_cvt_pk_bf16_f32 v170, v172, v173
    v_mfma_f32_16x16x32_bf16 v[16:19], a[48:51], v[160:163], v[16:19]
    v_exp_f32 v174, v174
    v_mfma_f32_16x16x32_bf16 v[20:23], a[52:55], v[160:163], v[20:23]
    v_mfma_f32_16x16x32_bf16 v[24:27], a[56:59], v[160:163], v[24:27]
    v_exp_f32 v175, v175
    v_mfma_f32_16x16x32_bf16 v[28:31], a[60:63], v[160:163], v[28:31]
    v_cvt_pk_bf16_f32 v171, v174, v175
    v_mfma_f32_16x16x32_bf16 a[208:211], a[228:231], v[160:163], a[208:211]
    s_waitcnt vmcnt(17)
    s_barrier
    v_mfma_f32_16x16x32_bf16 v[184:187], a[0:3], a[176:179], v[212:215]
    v_exp_f32 v176, v176
    v_mfma_f32_16x16x32_bf16 v[184:187], a[4:7], a[180:183], v[184:187]
    ds_read_b128 a[64:67], v225 offset:49152
    ds_read_b128 a[68:71], v226 offset:49152
    v_mfma_f32_16x16x32_bf16 v[184:187], a[8:11], a[184:187], v[184:187]
    v_exp_f32 v177, v177
    v_mfma_f32_16x16x32_bf16 v[184:187], a[12:15], a[188:191], v[184:187]
    v_cvt_pk_bf16_f32 v176, v176, v177
    v_mfma_f32_16x16x32_bf16 v[188:191], a[16:19], a[176:179], v[212:215]
    v_exp_f32 v178, v178
    v_mfma_f32_16x16x32_bf16 v[188:191], a[20:23], a[180:183], v[188:191]
    buffer_load_dwordx4 v253, s[16:19], s75 offen offset:1024 nt lds
    ds_read_b128 a[72:75], v227 offset:49152
    v_mfma_f32_16x16x32_bf16 v[188:191], a[24:27], a[184:187], v[188:191]
    v_exp_f32 v179, v179
    v_mfma_f32_16x16x32_bf16 v[188:191], a[28:31], a[188:191], v[188:191]
    v_cvt_pk_bf16_f32 v177, v178, v179
    v_mfma_f32_16x16x32_bf16 v[32:35], a[32:35], v[168:171], v[32:35]
    v_exp_f32 v180, v180
    v_mfma_f32_16x16x32_bf16 v[36:39], a[36:39], v[168:171], v[36:39]
    ds_read_b128 a[76:79], v228 offset:49152
    ds_read_b128 a[80:83], v225 offset:53248
    v_mfma_f32_16x16x32_bf16 v[40:43], a[40:43], v[168:171], v[40:43]
    v_exp_f32 v181, v181
    v_mfma_f32_16x16x32_bf16 v[44:47], a[44:47], v[168:171], v[44:47]
    v_cvt_pk_bf16_f32 v178, v180, v181
    v_mfma_f32_16x16x32_bf16 v[48:51], a[48:51], v[168:171], v[48:51]
    v_exp_f32 v182, v182
    v_mfma_f32_16x16x32_bf16 v[52:55], a[52:55], v[168:171], v[52:55]
    ds_read_b128 a[84:87], v226 offset:53248
    buffer_load_dwordx4 v244, s[16:19], s75 offen offset:2048 nt lds
    v_mfma_f32_16x16x32_bf16 v[56:59], a[56:59], v[168:171], v[56:59]
    v_exp_f32 v183, v183
    v_mfma_f32_16x16x32_bf16 v[60:63], a[60:63], v[168:171], v[60:63]
    v_cvt_pk_bf16_f32 v179, v182, v183
    v_mfma_f32_16x16x32_bf16 a[212:215], a[228:231], v[168:171], a[212:215]
    ds_read_b128 a[88:91], v227 offset:53248
    ds_read_b128 a[92:95], v228 offset:53248
    v_mfma_f32_16x16x32_bf16 v[192:195], a[0:3], a[192:195], v[216:219]
    v_exp_f32 v184, v184
    v_mfma_f32_16x16x32_bf16 v[192:195], a[4:7], a[196:199], v[192:195]
    buffer_load_dwordx4 v253, s[16:19], s75 offen offset:3072 nt lds
    s_add_u32 s75, s75, 8192
    s_and_b32 s75, s75, 0x1e000
    s_or_b32 s75, s75, s60
    v_mfma_f32_16x16x32_bf16 v[192:195], a[8:11], a[200:203], v[192:195]
    v_exp_f32 v185, v185
    v_mfma_f32_16x16x32_bf16 v[192:195], a[12:15], a[204:207], v[192:195]
    v_cvt_pk_bf16_f32 v184, v184, v185
    v_mfma_f32_16x16x32_bf16 v[196:199], a[16:19], a[192:195], v[216:219]
    v_exp_f32 v186, v186
    v_mfma_f32_16x16x32_bf16 v[196:199], a[20:23], a[196:199], v[196:199]
    v_mfma_f32_16x16x32_bf16 v[196:199], a[24:27], a[200:203], v[196:199]
    v_exp_f32 v187, v187
    v_mfma_f32_16x16x32_bf16 v[196:199], a[28:31], a[204:207], v[196:199]
    v_cvt_pk_bf16_f32 v185, v186, v187
    v_mfma_f32_16x16x32_bf16 v[64:67], a[32:35], v[176:179], v[64:67]
    v_exp_f32 v188, v188
    v_mfma_f32_16x16x32_bf16 v[68:71], a[36:39], v[176:179], v[68:71]
    v_mfma_f32_16x16x32_bf16 v[72:75], a[40:43], v[176:179], v[72:75]
    v_exp_f32 v189, v189
    v_mfma_f32_16x16x32_bf16 v[76:79], a[44:47], v[176:179], v[76:79]
    v_cvt_pk_bf16_f32 v186, v188, v189
    v_mfma_f32_16x16x32_bf16 v[80:83], a[48:51], v[176:179], v[80:83]
    v_exp_f32 v190, v190
    v_mfma_f32_16x16x32_bf16 v[84:87], a[52:55], v[176:179], v[84:87]
    v_mfma_f32_16x16x32_bf16 v[88:91], a[56:59], v[176:179], v[88:91]
    v_exp_f32 v191, v191
    v_mfma_f32_16x16x32_bf16 v[92:95], a[60:63], v[176:179], v[92:95]
    v_cvt_pk_bf16_f32 v187, v190, v191
    v_mfma_f32_16x16x32_bf16 a[216:219], a[228:231], v[176:179], a[216:219]
    s_waitcnt vmcnt(16) lgkmcnt(0)
    s_barrier
    v_mfma_f32_16x16x32_bf16 v[160:163], a[64:67], a[128:131], v[200:203]
    v_exp_f32 v192, v192
    v_mfma_f32_16x16x32_bf16 v[160:163], a[68:71], a[132:135], v[160:163]
    ds_read_b64_tr_b16 a[96:97], v229 offset:49152
    ds_read_b64_tr_b16 a[98:99], v229 offset:53248
    v_mfma_f32_16x16x32_bf16 v[160:163], a[72:75], a[136:139], v[160:163]
    v_exp_f32 v193, v193
    v_mfma_f32_16x16x32_bf16 v[160:163], a[76:79], a[140:143], v[160:163]
    v_cvt_pk_bf16_f32 v192, v192, v193
    ds_read_b64_tr_b16 a[100:101], v230 offset:49152
    v_mfma_f32_16x16x32_bf16 v[164:167], a[80:83], a[128:131], v[200:203]
    v_exp_f32 v194, v194
    v_mfma_f32_16x16x32_bf16 v[164:167], a[84:87], a[132:135], v[164:167]
    s_add_u32 m0, s61, 32768
    s_nop 0
    buffer_load_dwordx4 v237, s[24:27], s75 offen offset:0 nt lds
    ds_read_b64_tr_b16 a[102:103], v230 offset:53248
    v_mfma_f32_16x16x32_bf16 v[164:167], a[88:91], a[136:139], v[164:167]
    v_exp_f32 v195, v195
    v_mfma_f32_16x16x32_bf16 v[164:167], a[92:95], a[140:143], v[164:167]
    v_cvt_pk_bf16_f32 v193, v194, v195
    v_mfma_f32_16x16x32_bf16 v[96:99], a[32:35], v[184:187], v[96:99]
    v_exp_f32 v196, v196
    v_mfma_f32_16x16x32_bf16 v[100:103], a[36:39], v[184:187], v[100:103]
    ds_read_b64_tr_b16 a[104:105], v231 offset:49152
    ds_read_b64_tr_b16 a[106:107], v231 offset:53248
    v_mfma_f32_16x16x32_bf16 v[104:107], a[40:43], v[184:187], v[104:107]
    v_exp_f32 v197, v197
    v_mfma_f32_16x16x32_bf16 v[108:111], a[44:47], v[184:187], v[108:111]
    v_cvt_pk_bf16_f32 v194, v196, v197
    v_mfma_f32_16x16x32_bf16 v[112:115], a[48:51], v[184:187], v[112:115]
    v_exp_f32 v198, v198
    v_mfma_f32_16x16x32_bf16 v[116:119], a[52:55], v[184:187], v[116:119]
    ds_read_b64_tr_b16 a[108:109], v232 offset:49152
    ds_read_b64_tr_b16 a[110:111], v232 offset:53248
    v_mfma_f32_16x16x32_bf16 v[120:123], a[56:59], v[184:187], v[120:123]
    v_exp_f32 v199, v199
    v_mfma_f32_16x16x32_bf16 v[124:127], a[60:63], v[184:187], v[124:127]
    v_cvt_pk_bf16_f32 v195, v198, v199
    v_mfma_f32_16x16x32_bf16 a[220:223], a[228:231], v[184:187], a[220:223]
    buffer_load_dwordx4 v238, s[24:27], s75 offen offset:1024 nt lds
    ds_read_b64_tr_b16 a[112:113], v233 offset:49152
    v_mfma_f32_16x16x32_bf16 v[168:171], a[64:67], a[144:147], v[204:207]
    v_exp_f32 v160, v160
    v_mfma_f32_16x16x32_bf16 v[168:171], a[68:71], a[148:151], v[168:171]
    ds_read_b64_tr_b16 a[114:115], v233 offset:53248
    ds_read_b64_tr_b16 a[116:117], v234 offset:49152
    v_mfma_f32_16x16x32_bf16 v[168:171], a[72:75], a[152:155], v[168:171]
    v_exp_f32 v161, v161
    v_mfma_f32_16x16x32_bf16 v[168:171], a[76:79], a[156:159], v[168:171]
    v_cvt_pk_bf16_f32 v160, v160, v161
    v_mfma_f32_16x16x32_bf16 v[172:175], a[80:83], a[144:147], v[204:207]
    v_exp_f32 v162, v162
    v_mfma_f32_16x16x32_bf16 v[172:175], a[84:87], a[148:151], v[172:175]
    buffer_load_dwordx4 v239, s[24:27], s75 offen offset:2048 nt lds
    ds_read_b64_tr_b16 a[118:119], v234 offset:53248
    v_mfma_f32_16x16x32_bf16 v[172:175], a[88:91], a[152:155], v[172:175]
    v_exp_f32 v163, v163
    v_mfma_f32_16x16x32_bf16 v[172:175], a[92:95], a[156:159], v[172:175]
    v_cvt_pk_bf16_f32 v161, v162, v163
    v_mfma_f32_16x16x32_bf16 v[128:131], a[32:35], v[192:195], v[128:131]
    v_exp_f32 v164, v164
    v_mfma_f32_16x16x32_bf16 v[132:135], a[36:39], v[192:195], v[132:135]
    ds_read_b64_tr_b16 a[120:121], v235 offset:49152
    ds_read_b64_tr_b16 a[122:123], v235 offset:53248
    v_mfma_f32_16x16x32_bf16 v[136:139], a[40:43], v[192:195], v[136:139]
    v_exp_f32 v165, v165
    v_mfma_f32_16x16x32_bf16 v[140:143], a[44:47], v[192:195], v[140:143]
    v_cvt_pk_bf16_f32 v162, v164, v165
    v_mfma_f32_16x16x32_bf16 v[144:147], a[48:51], v[192:195], v[144:147]
    v_exp_f32 v166, v166
    v_mfma_f32_16x16x32_bf16 v[148:151], a[52:55], v[192:195], v[148:151]
    buffer_load_dwordx4 v240, s[24:27], s75 offen offset:3072 nt lds
    ds_read_b64_tr_b16 a[124:125], v236 offset:49152
    v_mfma_f32_16x16x32_bf16 v[152:155], a[56:59], v[192:195], v[152:155]
    v_exp_f32 v167, v167
    v_mfma_f32_16x16x32_bf16 v[156:159], a[60:63], v[192:195], v[156:159]
    v_cvt_pk_bf16_f32 v163, v166, v167
    v_mfma_f32_16x16x32_bf16 a[224:227], a[228:231], v[192:195], a[224:227]
    ds_read_b64_tr_b16 a[126:127], v236 offset:53248
    v_mfma_f32_16x16x32_bf16 v[176:179], a[64:67], a[160:163], v[208:211]
    v_exp_f32 v168, v168
    v_mfma_f32_16x16x32_bf16 v[176:179], a[68:71], a[164:167], v[176:179]
    v_mfma_f32_16x16x32_bf16 v[176:179], a[72:75], a[168:171], v[176:179]
    v_exp_f32 v169, v169
    v_mfma_f32_16x16x32_bf16 v[176:179], a[76:79], a[172:175], v[176:179]
    v_cvt_pk_bf16_f32 v168, v168, v169
    v_mfma_f32_16x16x32_bf16 v[180:183], a[80:83], a[160:163], v[208:211]
    v_exp_f32 v170, v170
    v_mfma_f32_16x16x32_bf16 v[180:183], a[84:87], a[164:167], v[180:183]
    v_mfma_f32_16x16x32_bf16 v[180:183], a[88:91], a[168:171], v[180:183]
    v_exp_f32 v171, v171
    v_mfma_f32_16x16x32_bf16 v[180:183], a[92:95], a[172:175], v[180:183]
    v_cvt_pk_bf16_f32 v169, v170, v171
    s_waitcnt lgkmcnt(0)
    v_mfma_f32_16x16x32_bf16 v[0:3], a[96:99], v[160:163], v[0:3]
    v_exp_f32 v172, v172
    v_mfma_f32_16x16x32_bf16 v[4:7], a[100:103], v[160:163], v[4:7]
    v_mfma_f32_16x16x32_bf16 v[8:11], a[104:107], v[160:163], v[8:11]
    v_exp_f32 v173, v173
    v_mfma_f32_16x16x32_bf16 v[12:15], a[108:111], v[160:163], v[12:15]
    v_cvt_pk_bf16_f32 v170, v172, v173
    v_mfma_f32_16x16x32_bf16 v[16:19], a[112:115], v[160:163], v[16:19]
    v_exp_f32 v174, v174
    v_mfma_f32_16x16x32_bf16 v[20:23], a[116:119], v[160:163], v[20:23]
    v_mfma_f32_16x16x32_bf16 v[24:27], a[120:123], v[160:163], v[24:27]
    v_exp_f32 v175, v175
    v_mfma_f32_16x16x32_bf16 v[28:31], a[124:127], v[160:163], v[28:31]
    v_cvt_pk_bf16_f32 v171, v174, v175
    v_mfma_f32_16x16x32_bf16 a[208:211], a[228:231], v[160:163], a[208:211]
    s_waitcnt vmcnt(16)
    s_barrier
    v_mfma_f32_16x16x32_bf16 v[184:187], a[64:67], a[176:179], v[212:215]
    v_exp_f32 v176, v176
    v_mfma_f32_16x16x32_bf16 v[184:187], a[68:71], a[180:183], v[184:187]
    ds_read_b128 a[0:3], v225 offset:0
    ds_read_b128 a[4:7], v226 offset:0
    v_mfma_f32_16x16x32_bf16 v[184:187], a[72:75], a[184:187], v[184:187]
    v_exp_f32 v177, v177
    v_mfma_f32_16x16x32_bf16 v[184:187], a[76:79], a[188:191], v[184:187]
    v_cvt_pk_bf16_f32 v176, v176, v177
    v_mfma_f32_16x16x32_bf16 v[188:191], a[80:83], a[176:179], v[212:215]
    v_exp_f32 v178, v178
    v_mfma_f32_16x16x32_bf16 v[188:191], a[84:87], a[180:183], v[188:191]
    ds_read_b128 a[8:11], v227 offset:0
    s_add_u32 m0, s61, 40960
    s_nop 0
    buffer_load_dwordx4 v244, s[16:19], s75 offen offset:0 nt lds
    v_mfma_f32_16x16x32_bf16 v[188:191], a[88:91], a[184:187], v[188:191]
    v_exp_f32 v179, v179
    v_mfma_f32_16x16x32_bf16 v[188:191], a[92:95], a[188:191], v[188:191]
    v_cvt_pk_bf16_f32 v177, v178, v179
    v_mfma_f32_16x16x32_bf16 v[32:35], a[96:99], v[168:171], v[32:35]
    v_exp_f32 v180, v180
    v_mfma_f32_16x16x32_bf16 v[36:39], a[100:103], v[168:171], v[36:39]
    ds_read_b128 a[12:15], v228 offset:0
    ds_read_b128 a[16:19], v225 offset:4096
    v_mfma_f32_16x16x32_bf16 v[40:43], a[104:107], v[168:171], v[40:43]
    v_exp_f32 v181, v181
    v_mfma_f32_16x16x32_bf16 v[44:47], a[108:111], v[168:171], v[44:47]
    v_cvt_pk_bf16_f32 v178, v180, v181
    v_mfma_f32_16x16x32_bf16 v[48:51], a[112:115], v[168:171], v[48:51]
    v_exp_f32 v182, v182
    v_mfma_f32_16x16x32_bf16 v[52:55], a[116:119], v[168:171], v[52:55]
    ds_read_b128 a[20:23], v226 offset:4096
    ds_read_b128 a[24:27], v227 offset:4096
    v_mfma_f32_16x16x32_bf16 v[56:59], a[120:123], v[168:171], v[56:59]
    v_exp_f32 v183, v183
    v_mfma_f32_16x16x32_bf16 v[60:63], a[124:127], v[168:171], v[60:63]
    v_cvt_pk_bf16_f32 v179, v182, v183
    v_mfma_f32_16x16x32_bf16 a[212:215], a[228:231], v[168:171], a[212:215]
    buffer_load_dwordx4 v253, s[16:19], s75 offen offset:1024 nt lds
    ds_read_b128 a[28:31], v228 offset:4096
    v_mfma_f32_16x16x32_bf16 v[192:195], a[64:67], a[192:195], v[216:219]
    v_exp_f32 v184, v184
    v_mfma_f32_16x16x32_bf16 v[192:195], a[68:71], a[196:199], v[192:195]
    buffer_load_dwordx4 v244, s[16:19], s75 offen offset:2048 nt lds
    v_mfma_f32_16x16x32_bf16 v[192:195], a[72:75], a[200:203], v[192:195]
    v_exp_f32 v185, v185
    v_mfma_f32_16x16x32_bf16 v[192:195], a[76:79], a[204:207], v[192:195]
    v_cvt_pk_bf16_f32 v184, v184, v185
    v_mfma_f32_16x16x32_bf16 v[196:199], a[80:83], a[192:195], v[216:219]
    v_exp_f32 v186, v186
    v_mfma_f32_16x16x32_bf16 v[196:199], a[84:87], a[196:199], v[196:199]
    v_mfma_f32_16x16x32_bf16 v[196:199], a[88:91], a[200:203], v[196:199]
    v_exp_f32 v187, v187
    v_mfma_f32_16x16x32_bf16 v[196:199], a[92:95], a[204:207], v[196:199]
    v_cvt_pk_bf16_f32 v185, v186, v187
    v_mfma_f32_16x16x32_bf16 v[64:67], a[96:99], v[176:179], v[64:67]
    v_exp_f32 v188, v188
    v_mfma_f32_16x16x32_bf16 v[68:71], a[100:103], v[176:179], v[68:71]
    buffer_load_dwordx4 v253, s[16:19], s75 offen offset:3072 nt lds
    s_add_u32 s75, s75, 8192
    s_and_b32 s75, s75, 0x1e000
    s_or_b32 s75, s75, s60
    v_mfma_f32_16x16x32_bf16 v[72:75], a[104:107], v[176:179], v[72:75]
    v_exp_f32 v189, v189
    v_mfma_f32_16x16x32_bf16 v[76:79], a[108:111], v[176:179], v[76:79]
    v_cvt_pk_bf16_f32 v186, v188, v189
    v_mfma_f32_16x16x32_bf16 v[80:83], a[112:115], v[176:179], v[80:83]
    v_exp_f32 v190, v190
    v_mfma_f32_16x16x32_bf16 v[84:87], a[116:119], v[176:179], v[84:87]
    v_mfma_f32_16x16x32_bf16 v[88:91], a[120:123], v[176:179], v[88:91]
    v_exp_f32 v191, v191
    v_mfma_f32_16x16x32_bf16 v[92:95], a[124:127], v[176:179], v[92:95]
    v_cvt_pk_bf16_f32 v187, v190, v191
    v_mfma_f32_16x16x32_bf16 a[216:219], a[228:231], v[176:179], a[216:219]
    s_waitcnt vmcnt(16) lgkmcnt(0)
    s_barrier
    v_mfma_f32_16x16x32_bf16 v[160:163], a[0:3], a[128:131], v[200:203]
    v_exp_f32 v192, v192
    v_mfma_f32_16x16x32_bf16 v[160:163], a[4:7], a[132:135], v[160:163]
    ds_read_b64_tr_b16 a[32:33], v229 offset:0
    ds_read_b64_tr_b16 a[34:35], v229 offset:4096
    v_mfma_f32_16x16x32_bf16 v[160:163], a[8:11], a[136:139], v[160:163]
    v_exp_f32 v193, v193
    v_mfma_f32_16x16x32_bf16 v[160:163], a[12:15], a[140:143], v[160:163]
    v_cvt_pk_bf16_f32 v192, v192, v193
    ds_read_b64_tr_b16 a[36:37], v230 offset:0
    v_mfma_f32_16x16x32_bf16 v[164:167], a[16:19], a[128:131], v[200:203]
    v_exp_f32 v194, v194
    v_mfma_f32_16x16x32_bf16 v[164:167], a[20:23], a[132:135], v[164:167]
    s_add_u32 m0, s61, 49152
    s_nop 0
    buffer_load_dwordx4 v237, s[24:27], s75 offen offset:0 nt lds
    ds_read_b64_tr_b16 a[38:39], v230 offset:4096
    v_mfma_f32_16x16x32_bf16 v[164:167], a[24:27], a[136:139], v[164:167]
    v_exp_f32 v195, v195
    v_mfma_f32_16x16x32_bf16 v[164:167], a[28:31], a[140:143], v[164:167]
    v_cvt_pk_bf16_f32 v193, v194, v195
    v_mfma_f32_16x16x32_bf16 v[96:99], a[96:99], v[184:187], v[96:99]
    v_exp_f32 v196, v196
    v_mfma_f32_16x16x32_bf16 v[100:103], a[100:103], v[184:187], v[100:103]
    ds_read_b64_tr_b16 a[40:41], v231 offset:0
    ds_read_b64_tr_b16 a[42:43], v231 offset:4096
    v_mfma_f32_16x16x32_bf16 v[104:107], a[104:107], v[184:187], v[104:107]
    v_exp_f32 v197, v197
    v_mfma_f32_16x16x32_bf16 v[108:111], a[108:111], v[184:187], v[108:111]
    v_cvt_pk_bf16_f32 v194, v196, v197
    v_mfma_f32_16x16x32_bf16 v[112:115], a[112:115], v[184:187], v[112:115]
    v_exp_f32 v198, v198
    v_mfma_f32_16x16x32_bf16 v[116:119], a[116:119], v[184:187], v[116:119]
    ds_read_b64_tr_b16 a[44:45], v232 offset:0
    ds_read_b64_tr_b16 a[46:47], v232 offset:4096
    v_mfma_f32_16x16x32_bf16 v[120:123], a[120:123], v[184:187], v[120:123]
    v_exp_f32 v199, v199
    v_mfma_f32_16x16x32_bf16 v[124:127], a[124:127], v[184:187], v[124:127]
    v_cvt_pk_bf16_f32 v195, v198, v199
    v_mfma_f32_16x16x32_bf16 a[220:223], a[228:231], v[184:187], a[220:223]
    buffer_load_dwordx4 v238, s[24:27], s75 offen offset:1024 nt lds
    ds_read_b64_tr_b16 a[48:49], v233 offset:0
    v_mfma_f32_16x16x32_bf16 v[168:171], a[0:3], a[144:147], v[204:207]
    v_exp_f32 v160, v160
    v_mfma_f32_16x16x32_bf16 v[168:171], a[4:7], a[148:151], v[168:171]
    ds_read_b64_tr_b16 a[50:51], v233 offset:4096
    ds_read_b64_tr_b16 a[52:53], v234 offset:0
    v_mfma_f32_16x16x32_bf16 v[168:171], a[8:11], a[152:155], v[168:171]
    v_exp_f32 v161, v161
    v_mfma_f32_16x16x32_bf16 v[168:171], a[12:15], a[156:159], v[168:171]
    v_cvt_pk_bf16_f32 v160, v160, v161
    v_mfma_f32_16x16x32_bf16 v[172:175], a[16:19], a[144:147], v[204:207]
    v_exp_f32 v162, v162
    v_mfma_f32_16x16x32_bf16 v[172:175], a[20:23], a[148:151], v[172:175]
    buffer_load_dwordx4 v239, s[24:27], s75 offen offset:2048 nt lds
    ds_read_b64_tr_b16 a[54:55], v234 offset:4096
    v_mfma_f32_16x16x32_bf16 v[172:175], a[24:27], a[152:155], v[172:175]
    v_exp_f32 v163, v163
    v_mfma_f32_16x16x32_bf16 v[172:175], a[28:31], a[156:159], v[172:175]
    v_cvt_pk_bf16_f32 v161, v162, v163
    v_mfma_f32_16x16x32_bf16 v[128:131], a[96:99], v[192:195], v[128:131]
    v_exp_f32 v164, v164
    v_mfma_f32_16x16x32_bf16 v[132:135], a[100:103], v[192:195], v[132:135]
    ds_read_b64_tr_b16 a[56:57], v235 offset:0
    ds_read_b64_tr_b16 a[58:59], v235 offset:4096
    v_mfma_f32_16x16x32_bf16 v[136:139], a[104:107], v[192:195], v[136:139]
    v_exp_f32 v165, v165
    v_mfma_f32_16x16x32_bf16 v[140:143], a[108:111], v[192:195], v[140:143]
    v_cvt_pk_bf16_f32 v162, v164, v165
    v_mfma_f32_16x16x32_bf16 v[144:147], a[112:115], v[192:195], v[144:147]
    v_exp_f32 v166, v166
    v_mfma_f32_16x16x32_bf16 v[148:151], a[116:119], v[192:195], v[148:151]
    buffer_load_dwordx4 v240, s[24:27], s75 offen offset:3072 nt lds
    ds_read_b64_tr_b16 a[60:61], v236 offset:0
    v_mfma_f32_16x16x32_bf16 v[152:155], a[120:123], v[192:195], v[152:155]
    v_exp_f32 v167, v167
    v_mfma_f32_16x16x32_bf16 v[156:159], a[124:127], v[192:195], v[156:159]
    v_cvt_pk_bf16_f32 v163, v166, v167
    v_mfma_f32_16x16x32_bf16 a[224:227], a[228:231], v[192:195], a[224:227]
    ds_read_b64_tr_b16 a[62:63], v236 offset:4096
    v_mfma_f32_16x16x32_bf16 v[176:179], a[0:3], a[160:163], v[208:211]
    v_exp_f32 v168, v168
    v_mfma_f32_16x16x32_bf16 v[176:179], a[4:7], a[164:167], v[176:179]
    v_mfma_f32_16x16x32_bf16 v[176:179], a[8:11], a[168:171], v[176:179]
    v_exp_f32 v169, v169
    v_mfma_f32_16x16x32_bf16 v[176:179], a[12:15], a[172:175], v[176:179]
    v_cvt_pk_bf16_f32 v168, v168, v169
    v_mfma_f32_16x16x32_bf16 v[180:183], a[16:19], a[160:163], v[208:211]
    v_exp_f32 v170, v170
    v_mfma_f32_16x16x32_bf16 v[180:183], a[20:23], a[164:167], v[180:183]
    v_mfma_f32_16x16x32_bf16 v[180:183], a[24:27], a[168:171], v[180:183]
    v_exp_f32 v171, v171
    v_mfma_f32_16x16x32_bf16 v[180:183], a[28:31], a[172:175], v[180:183]
    v_cvt_pk_bf16_f32 v169, v170, v171
    s_waitcnt lgkmcnt(0)
    v_mfma_f32_16x16x32_bf16 v[0:3], a[32:35], v[160:163], v[0:3]
    v_exp_f32 v172, v172
    v_mfma_f32_16x16x32_bf16 v[4:7], a[36:39], v[160:163], v[4:7]
    v_mfma_f32_16x16x32_bf16 v[8:11], a[40:43], v[160:163], v[8:11]
    v_exp_f32 v173, v173
    v_mfma_f32_16x16x32_bf16 v[12:15], a[44:47], v[160:163], v[12:15]
    v_cvt_pk_bf16_f32 v170, v172, v173
    v_mfma_f32_16x16x32_bf16 v[16:19], a[48:51], v[160:163], v[16:19]
    v_exp_f32 v174, v174
    v_mfma_f32_16x16x32_bf16 v[20:23], a[52:55], v[160:163], v[20:23]
    v_mfma_f32_16x16x32_bf16 v[24:27], a[56:59], v[160:163], v[24:27]
    v_exp_f32 v175, v175
    v_mfma_f32_16x16x32_bf16 v[28:31], a[60:63], v[160:163], v[28:31]
    v_cvt_pk_bf16_f32 v171, v174, v175
    v_mfma_f32_16x16x32_bf16 a[208:211], a[228:231], v[160:163], a[208:211]
    s_waitcnt vmcnt(16)
    s_barrier
    v_mfma_f32_16x16x32_bf16 v[184:187], a[0:3], a[176:179], v[212:215]
    v_exp_f32 v176, v176
    v_mfma_f32_16x16x32_bf16 v[184:187], a[4:7], a[180:183], v[184:187]
    ds_read_b128 a[64:67], v225 offset:16384
    ds_read_b128 a[68:71], v226 offset:16384
    v_mfma_f32_16x16x32_bf16 v[184:187], a[8:11], a[184:187], v[184:187]
    v_exp_f32 v177, v177
    v_mfma_f32_16x16x32_bf16 v[184:187], a[12:15], a[188:191], v[184:187]
    v_cvt_pk_bf16_f32 v176, v176, v177
    v_mfma_f32_16x16x32_bf16 v[188:191], a[16:19], a[176:179], v[212:215]
    v_exp_f32 v178, v178
    v_mfma_f32_16x16x32_bf16 v[188:191], a[20:23], a[180:183], v[188:191]
    ds_read_b128 a[72:75], v227 offset:16384
    s_add_u32 m0, s61, 57344
    s_nop 0
    buffer_load_dwordx4 v244, s[16:19], s75 offen offset:0 nt lds
    v_mfma_f32_16x16x32_bf16 v[188:191], a[24:27], a[184:187], v[188:191]
    v_exp_f32 v179, v179
    v_mfma_f32_16x16x32_bf16 v[188:191], a[28:31], a[188:191], v[188:191]
    v_cvt_pk_bf16_f32 v177, v178, v179
    v_mfma_f32_16x16x32_bf16 v[32:35], a[32:35], v[168:171], v[32:35]
    v_exp_f32 v180, v180
    v_mfma_f32_16x16x32_bf16 v[36:39], a[36:39], v[168:171], v[36:39]
    ds_read_b128 a[76:79], v228 offset:16384
    ds_read_b128 a[80:83], v225 offset:20480
    v_mfma_f32_16x16x32_bf16 v[40:43], a[40:43], v[168:171], v[40:43]
    v_exp_f32 v181, v181
    v_mfma_f32_16x16x32_bf16 v[44:47], a[44:47], v[168:171], v[44:47]
    v_cvt_pk_bf16_f32 v178, v180, v181
    v_mfma_f32_16x16x32_bf16 v[48:51], a[48:51], v[168:171], v[48:51]
    v_exp_f32 v182, v182
    v_mfma_f32_16x16x32_bf16 v[52:55], a[52:55], v[168:171], v[52:55]
    ds_read_b128 a[84:87], v226 offset:20480
    ds_read_b128 a[88:91], v227 offset:20480
    v_mfma_f32_16x16x32_bf16 v[56:59], a[56:59], v[168:171], v[56:59]
    v_exp_f32 v183, v183
    v_mfma_f32_16x16x32_bf16 v[60:63], a[60:63], v[168:171], v[60:63]
    v_cvt_pk_bf16_f32 v179, v182, v183
    v_mfma_f32_16x16x32_bf16 a[212:215], a[228:231], v[168:171], a[212:215]
    buffer_load_dwordx4 v253, s[16:19], s75 offen offset:1024 nt lds
    ds_read_b128 a[92:95], v228 offset:20480
    v_mfma_f32_16x16x32_bf16 v[192:195], a[0:3], a[192:195], v[216:219]
    v_exp_f32 v184, v184
    v_mfma_f32_16x16x32_bf16 v[192:195], a[4:7], a[196:199], v[192:195]
    buffer_load_dwordx4 v244, s[16:19], s75 offen offset:2048 nt lds
    v_mfma_f32_16x16x32_bf16 v[192:195], a[8:11], a[200:203], v[192:195]
    v_exp_f32 v185, v185
    v_mfma_f32_16x16x32_bf16 v[192:195], a[12:15], a[204:207], v[192:195]
    v_cvt_pk_bf16_f32 v184, v184, v185
    v_mfma_f32_16x16x32_bf16 v[196:199], a[16:19], a[192:195], v[216:219]
    v_exp_f32 v186, v186
    v_mfma_f32_16x16x32_bf16 v[196:199], a[20:23], a[196:199], v[196:199]
    v_mfma_f32_16x16x32_bf16 v[196:199], a[24:27], a[200:203], v[196:199]
    v_exp_f32 v187, v187
    v_mfma_f32_16x16x32_bf16 v[196:199], a[28:31], a[204:207], v[196:199]
    v_cvt_pk_bf16_f32 v185, v186, v187
    v_mfma_f32_16x16x32_bf16 v[64:67], a[32:35], v[176:179], v[64:67]
    v_exp_f32 v188, v188
    v_mfma_f32_16x16x32_bf16 v[68:71], a[36:39], v[176:179], v[68:71]
    v_mfma_f32_16x16x32_bf16 v[72:75], a[40:43], v[176:179], v[72:75]
    v_exp_f32 v189, v189
    v_mfma_f32_16x16x32_bf16 v[76:79], a[44:47], v[176:179], v[76:79]
    v_cvt_pk_bf16_f32 v186, v188, v189
    v_mfma_f32_16x16x32_bf16 v[80:83], a[48:51], v[176:179], v[80:83]
    v_exp_f32 v190, v190
    v_mfma_f32_16x16x32_bf16 v[84:87], a[52:55], v[176:179], v[84:87]
    v_mfma_f32_16x16x32_bf16 v[88:91], a[56:59], v[176:179], v[88:91]
    v_exp_f32 v191, v191
    v_mfma_f32_16x16x32_bf16 v[92:95], a[60:63], v[176:179], v[92:95]
    v_cvt_pk_bf16_f32 v187, v190, v191
    v_mfma_f32_16x16x32_bf16 a[216:219], a[228:231], v[176:179], a[216:219]
    s_waitcnt vmcnt(15) lgkmcnt(0)
    s_barrier
    v_mfma_f32_16x16x32_bf16 v[160:163], a[64:67], a[128:131], v[200:203]
    v_exp_f32 v192, v192
    v_mfma_f32_16x16x32_bf16 v[160:163], a[68:71], a[132:135], v[160:163]
    ds_read_b64_tr_b16 a[96:97], v229 offset:16384
    ds_read_b64_tr_b16 a[98:99], v229 offset:20480
    v_mfma_f32_16x16x32_bf16 v[160:163], a[72:75], a[136:139], v[160:163]
    v_exp_f32 v193, v193
    v_mfma_f32_16x16x32_bf16 v[160:163], a[76:79], a[140:143], v[160:163]
    v_cvt_pk_bf16_f32 v192, v192, v193
    ds_read_b64_tr_b16 a[100:101], v230 offset:16384
    v_mfma_f32_16x16x32_bf16 v[164:167], a[80:83], a[128:131], v[200:203]
    v_exp_f32 v194, v194
    v_mfma_f32_16x16x32_bf16 v[164:167], a[84:87], a[132:135], v[164:167]
    buffer_load_dwordx4 v253, s[16:19], s75 offen offset:3072 nt lds
    s_add_u32 s75, s75, 8192
    s_and_b32 s75, s75, 0x1e000
    s_or_b32 s75, s75, s60
    ds_read_b64_tr_b16 a[102:103], v230 offset:20480
    v_mfma_f32_16x16x32_bf16 v[164:167], a[88:91], a[136:139], v[164:167]
    v_exp_f32 v195, v195
    v_mfma_f32_16x16x32_bf16 v[164:167], a[92:95], a[140:143], v[164:167]
    v_cvt_pk_bf16_f32 v193, v194, v195
    v_mfma_f32_16x16x32_bf16 v[96:99], a[32:35], v[184:187], v[96:99]
    v_exp_f32 v196, v196
    v_mfma_f32_16x16x32_bf16 v[100:103], a[36:39], v[184:187], v[100:103]
    ds_read_b64_tr_b16 a[104:105], v231 offset:16384
    ds_read_b64_tr_b16 a[106:107], v231 offset:20480
    v_mfma_f32_16x16x32_bf16 v[104:107], a[40:43], v[184:187], v[104:107]
    v_exp_f32 v197, v197
    v_mfma_f32_16x16x32_bf16 v[108:111], a[44:47], v[184:187], v[108:111]
    v_cvt_pk_bf16_f32 v194, v196, v197
    v_mfma_f32_16x16x32_bf16 v[112:115], a[48:51], v[184:187], v[112:115]
    v_exp_f32 v198, v198
    v_mfma_f32_16x16x32_bf16 v[116:119], a[52:55], v[184:187], v[116:119]
    ds_read_b64_tr_b16 a[108:109], v232 offset:16384
    s_add_u32 m0, s61, 0
    s_nop 0
    buffer_load_dwordx4 v237, s[24:27], s75 offen offset:0 nt lds
    v_mfma_f32_16x16x32_bf16 v[120:123], a[56:59], v[184:187], v[120:123]
    v_exp_f32 v199, v199
    v_mfma_f32_16x16x32_bf16 v[124:127], a[60:63], v[184:187], v[124:127]
    v_cvt_pk_bf16_f32 v195, v198, v199
    v_mfma_f32_16x16x32_bf16 a[220:223], a[228:231], v[184:187], a[220:223]
    ds_read_b64_tr_b16 a[110:111], v232 offset:20480
    ds_read_b64_tr_b16 a[112:113], v233 offset:16384
    v_mfma_f32_16x16x32_bf16 v[168:171], a[64:67], a[144:147], v[204:207]
    v_exp_f32 v160, v160
    v_mfma_f32_16x16x32_bf16 v[168:171], a[68:71], a[148:151], v[168:171]
    ds_read_b64_tr_b16 a[114:115], v233 offset:20480
    ds_read_b64_tr_b16 a[116:117], v234 offset:16384
    v_mfma_f32_16x16x32_bf16 v[168:171], a[72:75], a[152:155], v[168:171]
    v_exp_f32 v161, v161
    v_mfma_f32_16x16x32_bf16 v[168:171], a[76:79], a[156:159], v[168:171]
    v_cvt_pk_bf16_f32 v160, v160, v161
    v_mfma_f32_16x16x32_bf16 v[172:175], a[80:83], a[144:147], v[204:207]
    v_exp_f32 v162, v162
    v_mfma_f32_16x16x32_bf16 v[172:175], a[84:87], a[148:151], v[172:175]
    buffer_load_dwordx4 v238, s[24:27], s75 offen offset:1024 nt lds
    ds_read_b64_tr_b16 a[118:119], v234 offset:20480
    v_mfma_f32_16x16x32_bf16 v[172:175], a[88:91], a[152:155], v[172:175]
    v_exp_f32 v163, v163
    v_mfma_f32_16x16x32_bf16 v[172:175], a[92:95], a[156:159], v[172:175]
    v_cvt_pk_bf16_f32 v161, v162, v163
    v_mfma_f32_16x16x32_bf16 v[128:131], a[32:35], v[192:195], v[128:131]
    v_exp_f32 v164, v164
    v_mfma_f32_16x16x32_bf16 v[132:135], a[36:39], v[192:195], v[132:135]
    ds_read_b64_tr_b16 a[120:121], v235 offset:16384
    ds_read_b64_tr_b16 a[122:123], v235 offset:20480
    v_mfma_f32_16x16x32_bf16 v[136:139], a[40:43], v[192:195], v[136:139]
    v_exp_f32 v165, v165
    v_mfma_f32_16x16x32_bf16 v[140:143], a[44:47], v[192:195], v[140:143]
    v_cvt_pk_bf16_f32 v162, v164, v165
    v_mfma_f32_16x16x32_bf16 v[144:147], a[48:51], v[192:195], v[144:147]
    v_exp_f32 v166, v166
    v_mfma_f32_16x16x32_bf16 v[148:151], a[52:55], v[192:195], v[148:151]
    buffer_load_dwordx4 v239, s[24:27], s75 offen offset:2048 nt lds
    ds_read_b64_tr_b16 a[124:125], v236 offset:16384
    v_mfma_f32_16x16x32_bf16 v[152:155], a[56:59], v[192:195], v[152:155]
    v_exp_f32 v167, v167
    v_mfma_f32_16x16x32_bf16 v[156:159], a[60:63], v[192:195], v[156:159]
    v_cvt_pk_bf16_f32 v163, v166, v167
    v_mfma_f32_16x16x32_bf16 a[224:227], a[228:231], v[192:195], a[224:227]
    ds_read_b64_tr_b16 a[126:127], v236 offset:20480
    v_mfma_f32_16x16x32_bf16 v[176:179], a[64:67], a[160:163], v[208:211]
    v_exp_f32 v168, v168
    v_mfma_f32_16x16x32_bf16 v[176:179], a[68:71], a[164:167], v[176:179]
    v_mfma_f32_16x16x32_bf16 v[176:179], a[72:75], a[168:171], v[176:179]
    v_exp_f32 v169, v169
    v_mfma_f32_16x16x32_bf16 v[176:179], a[76:79], a[172:175], v[176:179]
    v_cvt_pk_bf16_f32 v168, v168, v169
    v_mfma_f32_16x16x32_bf16 v[180:183], a[80:83], a[160:163], v[208:211]
    v_exp_f32 v170, v170
    v_mfma_f32_16x16x32_bf16 v[180:183], a[84:87], a[164:167], v[180:183]
    v_mfma_f32_16x16x32_bf16 v[180:183], a[88:91], a[168:171], v[180:183]
    v_exp_f32 v171, v171
    v_mfma_f32_16x16x32_bf16 v[180:183], a[92:95], a[172:175], v[180:183]
    v_cvt_pk_bf16_f32 v169, v170, v171
    s_waitcnt lgkmcnt(0)
    v_mfma_f32_16x16x32_bf16 v[0:3], a[96:99], v[160:163], v[0:3]
    v_exp_f32 v172, v172
    v_mfma_f32_16x16x32_bf16 v[4:7], a[100:103], v[160:163], v[4:7]
    v_mfma_f32_16x16x32_bf16 v[8:11], a[104:107], v[160:163], v[8:11]
    v_exp_f32 v173, v173
    v_mfma_f32_16x16x32_bf16 v[12:15], a[108:111], v[160:163], v[12:15]
    v_cvt_pk_bf16_f32 v170, v172, v173
    v_mfma_f32_16x16x32_bf16 v[16:19], a[112:115], v[160:163], v[16:19]
    v_exp_f32 v174, v174
    v_mfma_f32_16x16x32_bf16 v[20:23], a[116:119], v[160:163], v[20:23]
    v_mfma_f32_16x16x32_bf16 v[24:27], a[120:123], v[160:163], v[24:27]
    v_exp_f32 v175, v175
    v_mfma_f32_16x16x32_bf16 v[28:31], a[124:127], v[160:163], v[28:31]
    v_cvt_pk_bf16_f32 v171, v174, v175
    v_mfma_f32_16x16x32_bf16 a[208:211], a[228:231], v[160:163], a[208:211]
    s_waitcnt vmcnt(15)
    s_barrier
    v_mfma_f32_16x16x32_bf16 v[184:187], a[64:67], a[176:179], v[212:215]
    v_exp_f32 v176, v176
    v_mfma_f32_16x16x32_bf16 v[184:187], a[68:71], a[180:183], v[184:187]
    ds_read_b128 a[0:3], v225 offset:32768
    buffer_load_dwordx4 v240, s[24:27], s75 offen offset:3072 nt lds
    v_mfma_f32_16x16x32_bf16 v[184:187], a[72:75], a[184:187], v[184:187]
    v_exp_f32 v177, v177
    v_mfma_f32_16x16x32_bf16 v[184:187], a[76:79], a[188:191], v[184:187]
    v_cvt_pk_bf16_f32 v176, v176, v177
    v_mfma_f32_16x16x32_bf16 v[188:191], a[80:83], a[176:179], v[212:215]
    v_exp_f32 v178, v178
    v_mfma_f32_16x16x32_bf16 v[188:191], a[84:87], a[180:183], v[188:191]
    ds_read_b128 a[4:7], v226 offset:32768
    ds_read_b128 a[8:11], v227 offset:32768
    v_mfma_f32_16x16x32_bf16 v[188:191], a[88:91], a[184:187], v[188:191]
    v_exp_f32 v179, v179
    v_mfma_f32_16x16x32_bf16 v[188:191], a[92:95], a[188:191], v[188:191]
    v_cvt_pk_bf16_f32 v177, v178, v179
    v_mfma_f32_16x16x32_bf16 v[32:35], a[96:99], v[168:171], v[32:35]
    v_exp_f32 v180, v180
    v_mfma_f32_16x16x32_bf16 v[36:39], a[100:103], v[168:171], v[36:39]
    ds_read_b128 a[12:15], v228 offset:32768
    ds_read_b128 a[16:19], v225 offset:36864
    v_mfma_f32_16x16x32_bf16 v[40:43], a[104:107], v[168:171], v[40:43]
    v_exp_f32 v181, v181
    v_mfma_f32_16x16x32_bf16 v[44:47], a[108:111], v[168:171], v[44:47]
    v_cvt_pk_bf16_f32 v178, v180, v181
    v_mfma_f32_16x16x32_bf16 v[48:51], a[112:115], v[168:171], v[48:51]
    v_exp_f32 v182, v182
    v_mfma_f32_16x16x32_bf16 v[52:55], a[116:119], v[168:171], v[52:55]
    s_add_u32 m0, s61, 8192
    s_nop 0
    buffer_load_dwordx4 v244, s[16:19], s75 offen offset:0 nt lds
    ds_read_b128 a[20:23], v226 offset:36864
    v_mfma_f32_16x16x32_bf16 v[56:59], a[120:123], v[168:171], v[56:59]
    v_exp_f32 v183, v183
    v_mfma_f32_16x16x32_bf16 v[60:63], a[124:127], v[168:171], v[60:63]
    v_cvt_pk_bf16_f32 v179, v182, v183
    v_mfma_f32_16x16x32_bf16 a[212:215], a[228:231], v[168:171], a[212:215]
    ds_read_b128 a[24:27], v227 offset:36864
    ds_read_b128 a[28:31], v228 offset:36864
    v_mfma_f32_16x16x32_bf16 v[192:195], a[64:67], a[192:195], v[216:219]
    v_exp_f32 v184, v184
    v_mfma_f32_16x16x32_bf16 v[192:195], a[68:71], a[196:199], v[192:195]
    buffer_load_dwordx4 v253, s[16:19], s75 offen offset:1024 nt lds
    v_mfma_f32_16x16x32_bf16 v[192:195], a[72:75], a[200:203], v[192:195]
    v_exp_f32 v185, v185
    v_mfma_f32_16x16x32_bf16 v[192:195], a[76:79], a[204:207], v[192:195]
    v_cvt_pk_bf16_f32 v184, v184, v185
    v_mfma_f32_16x16x32_bf16 v[196:199], a[80:83], a[192:195], v[216:219]
    v_exp_f32 v186, v186
    v_mfma_f32_16x16x32_bf16 v[196:199], a[84:87], a[196:199], v[196:199]
    v_mfma_f32_16x16x32_bf16 v[196:199], a[88:91], a[200:203], v[196:199]
    v_exp_f32 v187, v187
    v_mfma_f32_16x16x32_bf16 v[196:199], a[92:95], a[204:207], v[196:199]
    v_cvt_pk_bf16_f32 v185, v186, v187
    v_mfma_f32_16x16x32_bf16 v[64:67], a[96:99], v[176:179], v[64:67]
    v_exp_f32 v188, v188
    v_mfma_f32_16x16x32_bf16 v[68:71], a[100:103], v[176:179], v[68:71]
    buffer_load_dwordx4 v244, s[16:19], s75 offen offset:2048 nt lds
    v_mfma_f32_16x16x32_bf16 v[72:75], a[104:107], v[176:179], v[72:75]
    v_exp_f32 v189, v189
    v_mfma_f32_16x16x32_bf16 v[76:79], a[108:111], v[176:179], v[76:79]
    v_cvt_pk_bf16_f32 v186, v188, v189
    v_mfma_f32_16x16x32_bf16 v[80:83], a[112:115], v[176:179], v[80:83]
    v_exp_f32 v190, v190
    v_mfma_f32_16x16x32_bf16 v[84:87], a[116:119], v[176:179], v[84:87]
    v_mfma_f32_16x16x32_bf16 v[88:91], a[120:123], v[176:179], v[88:91]
    v_exp_f32 v191, v191
    v_mfma_f32_16x16x32_bf16 v[92:95], a[124:127], v[176:179], v[92:95]
    v_cvt_pk_bf16_f32 v187, v190, v191
    v_mfma_f32_16x16x32_bf16 a[216:219], a[228:231], v[176:179], a[216:219]
    s_waitcnt vmcnt(15) lgkmcnt(0)
    s_barrier
    v_mfma_f32_16x16x32_bf16 v[160:163], a[0:3], a[128:131], v[200:203]
    v_exp_f32 v192, v192
    v_mfma_f32_16x16x32_bf16 v[160:163], a[4:7], a[132:135], v[160:163]
    ds_read_b64_tr_b16 a[32:33], v229 offset:32768
    ds_read_b64_tr_b16 a[34:35], v229 offset:36864
    v_mfma_f32_16x16x32_bf16 v[160:163], a[8:11], a[136:139], v[160:163]
    v_exp_f32 v193, v193
    v_mfma_f32_16x16x32_bf16 v[160:163], a[12:15], a[140:143], v[160:163]
    v_cvt_pk_bf16_f32 v192, v192, v193
    ds_read_b64_tr_b16 a[36:37], v230 offset:32768
    v_mfma_f32_16x16x32_bf16 v[164:167], a[16:19], a[128:131], v[200:203]
    v_exp_f32 v194, v194
    v_mfma_f32_16x16x32_bf16 v[164:167], a[20:23], a[132:135], v[164:167]
    buffer_load_dwordx4 v253, s[16:19], s75 offen offset:3072 nt lds
    s_add_u32 s75, s75, 8192
    s_and_b32 s75, s75, 0x1e000
    s_or_b32 s75, s75, s60
    ds_read_b64_tr_b16 a[38:39], v230 offset:36864
    v_mfma_f32_16x16x32_bf16 v[164:167], a[24:27], a[136:139], v[164:167]
    v_exp_f32 v195, v195
    v_mfma_f32_16x16x32_bf16 v[164:167], a[28:31], a[140:143], v[164:167]
    v_cvt_pk_bf16_f32 v193, v194, v195
    v_mfma_f32_16x16x32_bf16 v[96:99], a[96:99], v[184:187], v[96:99]
    v_exp_f32 v196, v196
    v_mfma_f32_16x16x32_bf16 v[100:103], a[100:103], v[184:187], v[100:103]
    ds_read_b64_tr_b16 a[40:41], v231 offset:32768
    ds_read_b64_tr_b16 a[42:43], v231 offset:36864
    v_mfma_f32_16x16x32_bf16 v[104:107], a[104:107], v[184:187], v[104:107]
    v_exp_f32 v197, v197
    v_mfma_f32_16x16x32_bf16 v[108:111], a[108:111], v[184:187], v[108:111]
    v_cvt_pk_bf16_f32 v194, v196, v197
    v_mfma_f32_16x16x32_bf16 v[112:115], a[112:115], v[184:187], v[112:115]
    v_exp_f32 v198, v198
    v_mfma_f32_16x16x32_bf16 v[116:119], a[116:119], v[184:187], v[116:119]
    ds_read_b64_tr_b16 a[44:45], v232 offset:32768
    s_add_u32 m0, s61, 16384
    s_nop 0
    buffer_load_dwordx4 v237, s[24:27], s75 offen offset:0 nt lds
    v_mfma_f32_16x16x32_bf16 v[120:123], a[120:123], v[184:187], v[120:123]
    v_exp_f32 v199, v199
    v_mfma_f32_16x16x32_bf16 v[124:127], a[124:127], v[184:187], v[124:127]
    v_cvt_pk_bf16_f32 v195, v198, v199
    v_mfma_f32_16x16x32_bf16 a[220:223], a[228:231], v[184:187], a[220:223]
    ds_read_b64_tr_b16 a[46:47], v232 offset:36864
    ds_read_b64_tr_b16 a[48:49], v233 offset:32768
    v_mfma_f32_16x16x32_bf16 v[168:171], a[0:3], a[144:147], v[204:207]
    v_exp_f32 v160, v160
    v_mfma_f32_16x16x32_bf16 v[168:171], a[4:7], a[148:151], v[168:171]
    ds_read_b64_tr_b16 a[50:51], v233 offset:36864
    ds_read_b64_tr_b16 a[52:53], v234 offset:32768
    v_mfma_f32_16x16x32_bf16 v[168:171], a[8:11], a[152:155], v[168:171]
    v_exp_f32 v161, v161
    v_mfma_f32_16x16x32_bf16 v[168:171], a[12:15], a[156:159], v[168:171]
    v_cvt_pk_bf16_f32 v160, v160, v161
    v_mfma_f32_16x16x32_bf16 v[172:175], a[16:19], a[144:147], v[204:207]
    v_exp_f32 v162, v162
    v_mfma_f32_16x16x32_bf16 v[172:175], a[20:23], a[148:151], v[172:175]
    ds_read_b64_tr_b16 a[54:55], v234 offset:36864
    ds_read_b64_tr_b16 a[56:57], v235 offset:32768
    v_mfma_f32_16x16x32_bf16 v[172:175], a[24:27], a[152:155], v[172:175]
    v_exp_f32 v163, v163
    v_mfma_f32_16x16x32_bf16 v[172:175], a[28:31], a[156:159], v[172:175]
    v_cvt_pk_bf16_f32 v161, v162, v163
    v_mfma_f32_16x16x32_bf16 v[128:131], a[96:99], v[192:195], v[128:131]
    v_exp_f32 v164, v164
    v_mfma_f32_16x16x32_bf16 v[132:135], a[100:103], v[192:195], v[132:135]
    buffer_load_dwordx4 v238, s[24:27], s75 offen offset:1024 nt lds
    ds_read_b64_tr_b16 a[58:59], v235 offset:36864
    v_mfma_f32_16x16x32_bf16 v[136:139], a[104:107], v[192:195], v[136:139]
    v_exp_f32 v165, v165
    v_mfma_f32_16x16x32_bf16 v[140:143], a[108:111], v[192:195], v[140:143]
    v_cvt_pk_bf16_f32 v162, v164, v165
    v_mfma_f32_16x16x32_bf16 v[144:147], a[112:115], v[192:195], v[144:147]
    v_exp_f32 v166, v166
    v_mfma_f32_16x16x32_bf16 v[148:151], a[116:119], v[192:195], v[148:151]
    ds_read_b64_tr_b16 a[60:61], v236 offset:32768
    v_mfma_f32_16x16x32_bf16 v[152:155], a[120:123], v[192:195], v[152:155]
    v_exp_f32 v167, v167
    v_mfma_f32_16x16x32_bf16 v[156:159], a[124:127], v[192:195], v[156:159]
    v_cvt_pk_bf16_f32 v163, v166, v167
    v_mfma_f32_16x16x32_bf16 a[224:227], a[228:231], v[192:195], a[224:227]
    ds_read_b64_tr_b16 a[62:63], v236 offset:36864
    v_mfma_f32_16x16x32_bf16 v[176:179], a[0:3], a[160:163], v[208:211]
    v_exp_f32 v168, v168
    v_mfma_f32_16x16x32_bf16 v[176:179], a[4:7], a[164:167], v[176:179]
    v_mfma_f32_16x16x32_bf16 v[176:179], a[8:11], a[168:171], v[176:179]
    v_exp_f32 v169, v169
    v_mfma_f32_16x16x32_bf16 v[176:179], a[12:15], a[172:175], v[176:179]
    v_cvt_pk_bf16_f32 v168, v168, v169
    v_mfma_f32_16x16x32_bf16 v[180:183], a[16:19], a[160:163], v[208:211]
    v_exp_f32 v170, v170
    v_mfma_f32_16x16x32_bf16 v[180:183], a[20:23], a[164:167], v[180:183]
    v_mfma_f32_16x16x32_bf16 v[180:183], a[24:27], a[168:171], v[180:183]
    v_exp_f32 v171, v171
    v_mfma_f32_16x16x32_bf16 v[180:183], a[28:31], a[172:175], v[180:183]
    v_cvt_pk_bf16_f32 v169, v170, v171
    s_waitcnt lgkmcnt(0)
    v_mfma_f32_16x16x32_bf16 v[0:3], a[32:35], v[160:163], v[0:3]
    v_exp_f32 v172, v172
    v_mfma_f32_16x16x32_bf16 v[4:7], a[36:39], v[160:163], v[4:7]
    v_mfma_f32_16x16x32_bf16 v[8:11], a[40:43], v[160:163], v[8:11]
    v_exp_f32 v173, v173
    v_mfma_f32_16x16x32_bf16 v[12:15], a[44:47], v[160:163], v[12:15]
    v_cvt_pk_bf16_f32 v170, v172, v173
    v_mfma_f32_16x16x32_bf16 v[16:19], a[48:51], v[160:163], v[16:19]
    v_exp_f32 v174, v174
    v_mfma_f32_16x16x32_bf16 v[20:23], a[52:55], v[160:163], v[20:23]
    v_mfma_f32_16x16x32_bf16 v[24:27], a[56:59], v[160:163], v[24:27]
    v_exp_f32 v175, v175
    v_mfma_f32_16x16x32_bf16 v[28:31], a[60:63], v[160:163], v[28:31]
    v_cvt_pk_bf16_f32 v171, v174, v175
    v_mfma_f32_16x16x32_bf16 a[208:211], a[228:231], v[160:163], a[208:211]
    s_waitcnt vmcnt(14)
    s_barrier
    v_mfma_f32_16x16x32_bf16 v[184:187], a[0:3], a[176:179], v[212:215]
    v_exp_f32 v176, v176
    v_mfma_f32_16x16x32_bf16 v[184:187], a[4:7], a[180:183], v[184:187]
    ds_read_b128 a[64:67], v225 offset:49152
    ds_read_b128 a[68:71], v226 offset:49152
    v_mfma_f32_16x16x32_bf16 v[184:187], a[8:11], a[184:187], v[184:187]
    v_exp_f32 v177, v177
    v_mfma_f32_16x16x32_bf16 v[184:187], a[12:15], a[188:191], v[184:187]
    v_cvt_pk_bf16_f32 v176, v176, v177
    v_mfma_f32_16x16x32_bf16 v[188:191], a[16:19], a[176:179], v[212:215]
    v_exp_f32 v178, v178
    v_mfma_f32_16x16x32_bf16 v[188:191], a[20:23], a[180:183], v[188:191]
    buffer_load_dwordx4 v239, s[24:27], s75 offen offset:2048 nt lds
    ds_read_b128 a[72:75], v227 offset:49152
    v_mfma_f32_16x16x32_bf16 v[188:191], a[24:27], a[184:187], v[188:191]
    v_exp_f32 v179, v179
    v_mfma_f32_16x16x32_bf16 v[188:191], a[28:31], a[188:191], v[188:191]
    v_cvt_pk_bf16_f32 v177, v178, v179
    v_mfma_f32_16x16x32_bf16 v[32:35], a[32:35], v[168:171], v[32:35]
    v_exp_f32 v180, v180
    v_mfma_f32_16x16x32_bf16 v[36:39], a[36:39], v[168:171], v[36:39]
    ds_read_b128 a[76:79], v228 offset:49152
    ds_read_b128 a[80:83], v225 offset:53248
    v_mfma_f32_16x16x32_bf16 v[40:43], a[40:43], v[168:171], v[40:43]
    v_exp_f32 v181, v181
    v_mfma_f32_16x16x32_bf16 v[44:47], a[44:47], v[168:171], v[44:47]
    v_cvt_pk_bf16_f32 v178, v180, v181
    v_mfma_f32_16x16x32_bf16 v[48:51], a[48:51], v[168:171], v[48:51]
    v_exp_f32 v182, v182
    v_mfma_f32_16x16x32_bf16 v[52:55], a[52:55], v[168:171], v[52:55]
    ds_read_b128 a[84:87], v226 offset:53248
    buffer_load_dwordx4 v240, s[24:27], s75 offen offset:3072 nt lds
    v_mfma_f32_16x16x32_bf16 v[56:59], a[56:59], v[168:171], v[56:59]
    v_exp_f32 v183, v183
    v_mfma_f32_16x16x32_bf16 v[60:63], a[60:63], v[168:171], v[60:63]
    v_cvt_pk_bf16_f32 v179, v182, v183
    v_mfma_f32_16x16x32_bf16 a[212:215], a[228:231], v[168:171], a[212:215]
    ds_read_b128 a[88:91], v227 offset:53248
    ds_read_b128 a[92:95], v228 offset:53248
    v_mfma_f32_16x16x32_bf16 v[192:195], a[0:3], a[192:195], v[216:219]
    v_exp_f32 v184, v184
    v_mfma_f32_16x16x32_bf16 v[192:195], a[4:7], a[196:199], v[192:195]
    s_add_u32 m0, s61, 24576
    s_nop 0
    buffer_load_dwordx4 v244, s[16:19], s75 offen offset:0 nt lds
    v_mfma_f32_16x16x32_bf16 v[192:195], a[8:11], a[200:203], v[192:195]
    v_exp_f32 v185, v185
    v_mfma_f32_16x16x32_bf16 v[192:195], a[12:15], a[204:207], v[192:195]
    v_cvt_pk_bf16_f32 v184, v184, v185
    v_mfma_f32_16x16x32_bf16 v[196:199], a[16:19], a[192:195], v[216:219]
    v_exp_f32 v186, v186
    v_mfma_f32_16x16x32_bf16 v[196:199], a[20:23], a[196:199], v[196:199]
    v_mfma_f32_16x16x32_bf16 v[196:199], a[24:27], a[200:203], v[196:199]
    v_exp_f32 v187, v187
    v_mfma_f32_16x16x32_bf16 v[196:199], a[28:31], a[204:207], v[196:199]
    v_cvt_pk_bf16_f32 v185, v186, v187
    v_mfma_f32_16x16x32_bf16 v[64:67], a[32:35], v[176:179], v[64:67]
    v_exp_f32 v188, v188
    v_mfma_f32_16x16x32_bf16 v[68:71], a[36:39], v[176:179], v[68:71]
    buffer_load_dwordx4 v253, s[16:19], s75 offen offset:1024 nt lds
    v_mfma_f32_16x16x32_bf16 v[72:75], a[40:43], v[176:179], v[72:75]
    v_exp_f32 v189, v189
    v_mfma_f32_16x16x32_bf16 v[76:79], a[44:47], v[176:179], v[76:79]
    v_cvt_pk_bf16_f32 v186, v188, v189
    v_mfma_f32_16x16x32_bf16 v[80:83], a[48:51], v[176:179], v[80:83]
    v_exp_f32 v190, v190
    v_mfma_f32_16x16x32_bf16 v[84:87], a[52:55], v[176:179], v[84:87]
    v_mfma_f32_16x16x32_bf16 v[88:91], a[56:59], v[176:179], v[88:91]
    v_exp_f32 v191, v191
    v_mfma_f32_16x16x32_bf16 v[92:95], a[60:63], v[176:179], v[92:95]
    v_cvt_pk_bf16_f32 v187, v190, v191
    v_mfma_f32_16x16x32_bf16 a[216:219], a[228:231], v[176:179], a[216:219]
    s_waitcnt vmcnt(14) lgkmcnt(0)
    s_barrier
    v_mfma_f32_16x16x32_bf16 v[160:163], a[64:67], a[128:131], v[200:203]
    v_exp_f32 v192, v192
    v_mfma_f32_16x16x32_bf16 v[160:163], a[68:71], a[132:135], v[160:163]
    ds_read_b64_tr_b16 a[96:97], v229 offset:49152
    buffer_load_dwordx4 v244, s[16:19], s75 offen offset:2048 nt lds
    v_mfma_f32_16x16x32_bf16 v[160:163], a[72:75], a[136:139], v[160:163]
    v_exp_f32 v193, v193
    v_mfma_f32_16x16x32_bf16 v[160:163], a[76:79], a[140:143], v[160:163]
    v_cvt_pk_bf16_f32 v192, v192, v193
    ds_read_b64_tr_b16 a[98:99], v229 offset:53248
    v_mfma_f32_16x16x32_bf16 v[164:167], a[80:83], a[128:131], v[200:203]
    v_exp_f32 v194, v194
    v_mfma_f32_16x16x32_bf16 v[164:167], a[84:87], a[132:135], v[164:167]
    ds_read_b64_tr_b16 a[100:101], v230 offset:49152
    ds_read_b64_tr_b16 a[102:103], v230 offset:53248
    v_mfma_f32_16x16x32_bf16 v[164:167], a[88:91], a[136:139], v[164:167]
    v_exp_f32 v195, v195
    v_mfma_f32_16x16x32_bf16 v[164:167], a[92:95], a[140:143], v[164:167]
    v_cvt_pk_bf16_f32 v193, v194, v195
    v_mfma_f32_16x16x32_bf16 v[96:99], a[32:35], v[184:187], v[96:99]
    v_exp_f32 v196, v196
    v_mfma_f32_16x16x32_bf16 v[100:103], a[36:39], v[184:187], v[100:103]
    ds_read_b64_tr_b16 a[104:105], v231 offset:49152
    buffer_load_dwordx4 v253, s[16:19], s75 offen offset:3072 nt lds
    s_add_u32 s75, s75, 8192
    s_and_b32 s75, s75, 0x1e000
    s_or_b32 s75, s75, s60
    v_mfma_f32_16x16x32_bf16 v[104:107], a[40:43], v[184:187], v[104:107]
    v_exp_f32 v197, v197
    v_mfma_f32_16x16x32_bf16 v[108:111], a[44:47], v[184:187], v[108:111]
    v_cvt_pk_bf16_f32 v194, v196, v197
    v_mfma_f32_16x16x32_bf16 v[112:115], a[48:51], v[184:187], v[112:115]
    v_exp_f32 v198, v198
    v_mfma_f32_16x16x32_bf16 v[116:119], a[52:55], v[184:187], v[116:119]
    ds_read_b64_tr_b16 a[106:107], v231 offset:53248
    ds_read_b64_tr_b16 a[108:109], v232 offset:49152
    v_mfma_f32_16x16x32_bf16 v[120:123], a[56:59], v[184:187], v[120:123]
    v_exp_f32 v199, v199
    v_mfma_f32_16x16x32_bf16 v[124:127], a[60:63], v[184:187], v[124:127]
    v_cvt_pk_bf16_f32 v195, v198, v199
    v_mfma_f32_16x16x32_bf16 a[220:223], a[228:231], v[184:187], a[220:223]
    ds_read_b64_tr_b16 a[110:111], v232 offset:53248
    ds_read_b64_tr_b16 a[112:113], v233 offset:49152
    v_mfma_f32_16x16x32_bf16 v[168:171], a[64:67], a[144:147], v[204:207]
    v_exp_f32 v160, v160
    v_mfma_f32_16x16x32_bf16 v[168:171], a[68:71], a[148:151], v[168:171]
    ds_read_b64_tr_b16 a[114:115], v233 offset:53248
    ds_read_b64_tr_b16 a[116:117], v234 offset:49152
    v_mfma_f32_16x16x32_bf16 v[168:171], a[72:75], a[152:155], v[168:171]
    v_exp_f32 v161, v161
    v_mfma_f32_16x16x32_bf16 v[168:171], a[76:79], a[156:159], v[168:171]
    v_cvt_pk_bf16_f32 v160, v160, v161
    v_mfma_f32_16x16x32_bf16 v[172:175], a[80:83], a[144:147], v[204:207]
    v_exp_f32 v162, v162
    v_mfma_f32_16x16x32_bf16 v[172:175], a[84:87], a[148:151], v[172:175]
    ds_read_b64_tr_b16 a[118:119], v234 offset:53248
    s_add_u32 m0, s61, 32768
    s_nop 0
    buffer_load_dwordx4 v237, s[24:27], s75 offen offset:0 nt lds
    v_mfma_f32_16x16x32_bf16 v[172:175], a[88:91], a[152:155], v[172:175]
    v_exp_f32 v163, v163
    v_mfma_f32_16x16x32_bf16 v[172:175], a[92:95], a[156:159], v[172:175]
    v_cvt_pk_bf16_f32 v161, v162, v163
    v_mfma_f32_16x16x32_bf16 v[128:131], a[32:35], v[192:195], v[128:131]
    v_exp_f32 v164, v164
    v_mfma_f32_16x16x32_bf16 v[132:135], a[36:39], v[192:195], v[132:135]
    ds_read_b64_tr_b16 a[120:121], v235 offset:49152
    ds_read_b64_tr_b16 a[122:123], v235 offset:53248
    v_mfma_f32_16x16x32_bf16 v[136:139], a[40:43], v[192:195], v[136:139]
    v_exp_f32 v165, v165
    v_mfma_f32_16x16x32_bf16 v[140:143], a[44:47], v[192:195], v[140:143]
    v_cvt_pk_bf16_f32 v162, v164, v165
    v_mfma_f32_16x16x32_bf16 v[144:147], a[48:51], v[192:195], v[144:147]
    v_exp_f32 v166, v166
    v_mfma_f32_16x16x32_bf16 v[148:151], a[52:55], v[192:195], v[148:151]
    ds_read_b64_tr_b16 a[124:125], v236 offset:49152
    buffer_load_dwordx4 v238, s[24:27], s75 offen offset:1024 nt lds
    v_mfma_f32_16x16x32_bf16 v[152:155], a[56:59], v[192:195], v[152:155]
    v_exp_f32 v167, v167
    v_mfma_f32_16x16x32_bf16 v[156:159], a[60:63], v[192:195], v[156:159]
    v_cvt_pk_bf16_f32 v163, v166, v167
    v_mfma_f32_16x16x32_bf16 a[224:227], a[228:231], v[192:195], a[224:227]
    ds_read_b64_tr_b16 a[126:127], v236 offset:53248
    v_mfma_f32_16x16x32_bf16 v[176:179], a[64:67], a[160:163], v[208:211]
    v_exp_f32 v168, v168
    v_mfma_f32_16x16x32_bf16 v[176:179], a[68:71], a[164:167], v[176:179]
    v_mfma_f32_16x16x32_bf16 v[176:179], a[72:75], a[168:171], v[176:179]
    v_exp_f32 v169, v169
    v_mfma_f32_16x16x32_bf16 v[176:179], a[76:79], a[172:175], v[176:179]
    v_cvt_pk_bf16_f32 v168, v168, v169
    v_mfma_f32_16x16x32_bf16 v[180:183], a[80:83], a[160:163], v[208:211]
    v_exp_f32 v170, v170
    v_mfma_f32_16x16x32_bf16 v[180:183], a[84:87], a[164:167], v[180:183]
    v_mfma_f32_16x16x32_bf16 v[180:183], a[88:91], a[168:171], v[180:183]
    v_exp_f32 v171, v171
    v_mfma_f32_16x16x32_bf16 v[180:183], a[92:95], a[172:175], v[180:183]
    v_cvt_pk_bf16_f32 v169, v170, v171
    s_waitcnt lgkmcnt(0)
    v_mfma_f32_16x16x32_bf16 v[0:3], a[96:99], v[160:163], v[0:3]
    v_exp_f32 v172, v172
    v_mfma_f32_16x16x32_bf16 v[4:7], a[100:103], v[160:163], v[4:7]
    v_mfma_f32_16x16x32_bf16 v[8:11], a[104:107], v[160:163], v[8:11]
    v_exp_f32 v173, v173
    v_mfma_f32_16x16x32_bf16 v[12:15], a[108:111], v[160:163], v[12:15]
    v_cvt_pk_bf16_f32 v170, v172, v173
    v_mfma_f32_16x16x32_bf16 v[16:19], a[112:115], v[160:163], v[16:19]
    v_exp_f32 v174, v174
    v_mfma_f32_16x16x32_bf16 v[20:23], a[116:119], v[160:163], v[20:23]
    v_mfma_f32_16x16x32_bf16 v[24:27], a[120:123], v[160:163], v[24:27]
    v_exp_f32 v175, v175
    v_mfma_f32_16x16x32_bf16 v[28:31], a[124:127], v[160:163], v[28:31]
    v_cvt_pk_bf16_f32 v171, v174, v175
    v_mfma_f32_16x16x32_bf16 a[208:211], a[228:231], v[160:163], a[208:211]
    s_waitcnt vmcnt(14)
    s_barrier
    v_mfma_f32_16x16x32_bf16 v[184:187], a[64:67], a[176:179], v[212:215]
    v_exp_f32 v176, v176
    v_mfma_f32_16x16x32_bf16 v[184:187], a[68:71], a[180:183], v[184:187]
    ds_read_b128 a[0:3], v225 offset:0
    ds_read_b128 a[4:7], v226 offset:0
    v_mfma_f32_16x16x32_bf16 v[184:187], a[72:75], a[184:187], v[184:187]
    v_exp_f32 v177, v177
    v_mfma_f32_16x16x32_bf16 v[184:187], a[76:79], a[188:191], v[184:187]
    v_cvt_pk_bf16_f32 v176, v176, v177
    v_mfma_f32_16x16x32_bf16 v[188:191], a[80:83], a[176:179], v[212:215]
    v_exp_f32 v178, v178
    v_mfma_f32_16x16x32_bf16 v[188:191], a[84:87], a[180:183], v[188:191]
    buffer_load_dwordx4 v239, s[24:27], s75 offen offset:2048 nt lds
    ds_read_b128 a[8:11], v227 offset:0
    v_mfma_f32_16x16x32_bf16 v[188:191], a[88:91], a[184:187], v[188:191]
    v_exp_f32 v179, v179
    v_mfma_f32_16x16x32_bf16 v[188:191], a[92:95], a[188:191], v[188:191]
    v_cvt_pk_bf16_f32 v177, v178, v179
    v_mfma_f32_16x16x32_bf16 v[32:35], a[96:99], v[168:171], v[32:35]
    v_exp_f32 v180, v180
    v_mfma_f32_16x16x32_bf16 v[36:39], a[100:103], v[168:171], v[36:39]
    ds_read_b128 a[12:15], v228 offset:0
    ds_read_b128 a[16:19], v225 offset:4096
    v_mfma_f32_16x16x32_bf16 v[40:43], a[104:107], v[168:171], v[40:43]
    v_exp_f32 v181, v181
    v_mfma_f32_16x16x32_bf16 v[44:47], a[108:111], v[168:171], v[44:47]
    v_cvt_pk_bf16_f32 v178, v180, v181
    v_mfma_f32_16x16x32_bf16 v[48:51], a[112:115], v[168:171], v[48:51]
    v_exp_f32 v182, v182
    v_mfma_f32_16x16x32_bf16 v[52:55], a[116:119], v[168:171], v[52:55]
    ds_read_b128 a[20:23], v226 offset:4096
    buffer_load_dwordx4 v240, s[24:27], s75 offen offset:3072 nt lds
    v_mfma_f32_16x16x32_bf16 v[56:59], a[120:123], v[168:171], v[56:59]
    v_exp_f32 v183, v183
    v_mfma_f32_16x16x32_bf16 v[60:63], a[124:127], v[168:171], v[60:63]
    v_cvt_pk_bf16_f32 v179, v182, v183
    v_mfma_f32_16x16x32_bf16 a[212:215], a[228:231], v[168:171], a[212:215]
    ds_read_b128 a[24:27], v227 offset:4096
    ds_read_b128 a[28:31], v228 offset:4096
    v_mfma_f32_16x16x32_bf16 v[192:195], a[64:67], a[192:195], v[216:219]
    v_exp_f32 v184, v184
    v_mfma_f32_16x16x32_bf16 v[192:195], a[68:71], a[196:199], v[192:195]
    s_add_u32 m0, s61, 40960
    s_nop 0
    buffer_load_dwordx4 v244, s[16:19], s75 offen offset:0 nt lds
    v_mfma_f32_16x16x32_bf16 v[192:195], a[72:75], a[200:203], v[192:195]
    v_exp_f32 v185, v185
    v_mfma_f32_16x16x32_bf16 v[192:195], a[76:79], a[204:207], v[192:195]
    v_cvt_pk_bf16_f32 v184, v184, v185
    v_mfma_f32_16x16x32_bf16 v[196:199], a[80:83], a[192:195], v[216:219]
    v_exp_f32 v186, v186
    v_mfma_f32_16x16x32_bf16 v[196:199], a[84:87], a[196:199], v[196:199]
    v_mfma_f32_16x16x32_bf16 v[196:199], a[88:91], a[200:203], v[196:199]
    v_exp_f32 v187, v187
    v_mfma_f32_16x16x32_bf16 v[196:199], a[92:95], a[204:207], v[196:199]
    v_cvt_pk_bf16_f32 v185, v186, v187
    v_mfma_f32_16x16x32_bf16 v[64:67], a[96:99], v[176:179], v[64:67]
    v_exp_f32 v188, v188
    v_mfma_f32_16x16x32_bf16 v[68:71], a[100:103], v[176:179], v[68:71]
    v_mfma_f32_16x16x32_bf16 v[72:75], a[104:107], v[176:179], v[72:75]
    v_exp_f32 v189, v189
    v_mfma_f32_16x16x32_bf16 v[76:79], a[108:111], v[176:179], v[76:79]
    v_cvt_pk_bf16_f32 v186, v188, v189
    v_mfma_f32_16x16x32_bf16 v[80:83], a[112:115], v[176:179], v[80:83]
    v_exp_f32 v190, v190
    v_mfma_f32_16x16x32_bf16 v[84:87], a[116:119], v[176:179], v[84:87]
    v_mfma_f32_16x16x32_bf16 v[88:91], a[120:123], v[176:179], v[88:91]
    v_exp_f32 v191, v191
    v_mfma_f32_16x16x32_bf16 v[92:95], a[124:127], v[176:179], v[92:95]
    v_cvt_pk_bf16_f32 v187, v190, v191
    v_mfma_f32_16x16x32_bf16 a[216:219], a[228:231], v[176:179], a[216:219]
    s_waitcnt vmcnt(13) lgkmcnt(0)
    s_barrier
    v_mfma_f32_16x16x32_bf16 v[160:163], a[0:3], a[128:131], v[200:203]
    v_exp_f32 v192, v192
    v_mfma_f32_16x16x32_bf16 v[160:163], a[4:7], a[132:135], v[160:163]
    ds_read_b64_tr_b16 a[32:33], v229 offset:0
    ds_read_b64_tr_b16 a[34:35], v229 offset:4096
    v_mfma_f32_16x16x32_bf16 v[160:163], a[8:11], a[136:139], v[160:163]
    v_exp_f32 v193, v193
    v_mfma_f32_16x16x32_bf16 v[160:163], a[12:15], a[140:143], v[160:163]
    v_cvt_pk_bf16_f32 v192, v192, v193
    buffer_load_dwordx4 v253, s[16:19], s75 offen offset:1024 nt lds
    v_mfma_f32_16x16x32_bf16 v[164:167], a[16:19], a[128:131], v[200:203]
    v_exp_f32 v194, v194
    v_mfma_f32_16x16x32_bf16 v[164:167], a[20:23], a[132:135], v[164:167]
    ds_read_b64_tr_b16 a[36:37], v230 offset:0
    ds_read_b64_tr_b16 a[38:39], v230 offset:4096
    v_mfma_f32_16x16x32_bf16 v[164:167], a[24:27], a[136:139], v[164:167]
    v_exp_f32 v195, v195
    v_mfma_f32_16x16x32_bf16 v[164:167], a[28:31], a[140:143], v[164:167]
    v_cvt_pk_bf16_f32 v193, v194, v195
    v_mfma_f32_16x16x32_bf16 v[96:99], a[96:99], v[184:187], v[96:99]
    v_exp_f32 v196, v196
    v_mfma_f32_16x16x32_bf16 v[100:103], a[100:103], v[184:187], v[100:103]
    ds_read_b64_tr_b16 a[40:41], v231 offset:0
    ds_read_b64_tr_b16 a[42:43], v231 offset:4096
    v_mfma_f32_16x16x32_bf16 v[104:107], a[104:107], v[184:187], v[104:107]
    v_exp_f32 v197, v197
    v_mfma_f32_16x16x32_bf16 v[108:111], a[108:111], v[184:187], v[108:111]
    v_cvt_pk_bf16_f32 v194, v196, v197
    v_mfma_f32_16x16x32_bf16 v[112:115], a[112:115], v[184:187], v[112:115]
    v_exp_f32 v198, v198
    v_mfma_f32_16x16x32_bf16 v[116:119], a[116:119], v[184:187], v[116:119]
    ds_read_b64_tr_b16 a[44:45], v232 offset:0
    buffer_load_dwordx4 v244, s[16:19], s75 offen offset:2048 nt lds
    v_mfma_f32_16x16x32_bf16 v[120:123], a[120:123], v[184:187], v[120:123]
    v_exp_f32 v199, v199
    v_mfma_f32_16x16x32_bf16 v[124:127], a[124:127], v[184:187], v[124:127]
    v_cvt_pk_bf16_f32 v195, v198, v199
    v_mfma_f32_16x16x32_bf16 a[220:223], a[228:231], v[184:187], a[220:223]
    ds_read_b64_tr_b16 a[46:47], v232 offset:4096
    ds_read_b64_tr_b16 a[48:49], v233 offset:0
    v_mfma_f32_16x16x32_bf16 v[168:171], a[0:3], a[144:147], v[204:207]
    v_exp_f32 v160, v160
    v_mfma_f32_16x16x32_bf16 v[168:171], a[4:7], a[148:151], v[168:171]
    ds_read_b64_tr_b16 a[50:51], v233 offset:4096
    ds_read_b64_tr_b16 a[52:53], v234 offset:0
    v_mfma_f32_16x16x32_bf16 v[168:171], a[8:11], a[152:155], v[168:171]
    v_exp_f32 v161, v161
    v_mfma_f32_16x16x32_bf16 v[168:171], a[12:15], a[156:159], v[168:171]
    v_cvt_pk_bf16_f32 v160, v160, v161
    v_mfma_f32_16x16x32_bf16 v[172:175], a[16:19], a[144:147], v[204:207]
    v_exp_f32 v162, v162
    v_mfma_f32_16x16x32_bf16 v[172:175], a[20:23], a[148:151], v[172:175]
    buffer_load_dwordx4 v253, s[16:19], s75 offen offset:3072 nt lds
    s_add_u32 s75, s75, 8192
    s_and_b32 s75, s75, 0x1e000
    s_or_b32 s75, s75, s60
    ds_read_b64_tr_b16 a[54:55], v234 offset:4096
    v_mfma_f32_16x16x32_bf16 v[172:175], a[24:27], a[152:155], v[172:175]
    v_exp_f32 v163, v163
    v_mfma_f32_16x16x32_bf16 v[172:175], a[28:31], a[156:159], v[172:175]
    v_cvt_pk_bf16_f32 v161, v162, v163
    v_mfma_f32_16x16x32_bf16 v[128:131], a[96:99], v[192:195], v[128:131]
    v_exp_f32 v164, v164
    v_mfma_f32_16x16x32_bf16 v[132:135], a[100:103], v[192:195], v[132:135]
    ds_read_b64_tr_b16 a[56:57], v235 offset:0
    ds_read_b64_tr_b16 a[58:59], v235 offset:4096
    v_mfma_f32_16x16x32_bf16 v[136:139], a[104:107], v[192:195], v[136:139]
    v_exp_f32 v165, v165
    v_mfma_f32_16x16x32_bf16 v[140:143], a[108:111], v[192:195], v[140:143]
    v_cvt_pk_bf16_f32 v162, v164, v165
    v_mfma_f32_16x16x32_bf16 v[144:147], a[112:115], v[192:195], v[144:147]
    v_exp_f32 v166, v166
    v_mfma_f32_16x16x32_bf16 v[148:151], a[116:119], v[192:195], v[148:151]
    ds_read_b64_tr_b16 a[60:61], v236 offset:0
    s_add_u32 m0, s61, 49152
    s_nop 0
    buffer_load_dwordx4 v237, s[24:27], s75 offen offset:0 nt lds
    v_mfma_f32_16x16x32_bf16 v[152:155], a[120:123], v[192:195], v[152:155]
    v_exp_f32 v167, v167
    v_mfma_f32_16x16x32_bf16 v[156:159], a[124:127], v[192:195], v[156:159]
    v_cvt_pk_bf16_f32 v163, v166, v167
    v_mfma_f32_16x16x32_bf16 a[224:227], a[228:231], v[192:195], a[224:227]
    ds_read_b64_tr_b16 a[62:63], v236 offset:4096
    v_mfma_f32_16x16x32_bf16 v[176:179], a[0:3], a[160:163], v[208:211]
    v_exp_f32 v168, v168
    v_mfma_f32_16x16x32_bf16 v[176:179], a[4:7], a[164:167], v[176:179]
    v_mfma_f32_16x16x32_bf16 v[176:179], a[8:11], a[168:171], v[176:179]
    v_exp_f32 v169, v169
    v_mfma_f32_16x16x32_bf16 v[176:179], a[12:15], a[172:175], v[176:179]
    v_cvt_pk_bf16_f32 v168, v168, v169
    v_mfma_f32_16x16x32_bf16 v[180:183], a[16:19], a[160:163], v[208:211]
    v_exp_f32 v170, v170
    v_mfma_f32_16x16x32_bf16 v[180:183], a[20:23], a[164:167], v[180:183]
    v_mfma_f32_16x16x32_bf16 v[180:183], a[24:27], a[168:171], v[180:183]
    v_exp_f32 v171, v171
    v_mfma_f32_16x16x32_bf16 v[180:183], a[28:31], a[172:175], v[180:183]
    v_cvt_pk_bf16_f32 v169, v170, v171
    s_waitcnt lgkmcnt(0)
    v_mfma_f32_16x16x32_bf16 v[0:3], a[32:35], v[160:163], v[0:3]
    v_exp_f32 v172, v172
    v_mfma_f32_16x16x32_bf16 v[4:7], a[36:39], v[160:163], v[4:7]
    v_mfma_f32_16x16x32_bf16 v[8:11], a[40:43], v[160:163], v[8:11]
    v_exp_f32 v173, v173
    v_mfma_f32_16x16x32_bf16 v[12:15], a[44:47], v[160:163], v[12:15]
    v_cvt_pk_bf16_f32 v170, v172, v173
    v_mfma_f32_16x16x32_bf16 v[16:19], a[48:51], v[160:163], v[16:19]
    v_exp_f32 v174, v174
    v_mfma_f32_16x16x32_bf16 v[20:23], a[52:55], v[160:163], v[20:23]
    v_mfma_f32_16x16x32_bf16 v[24:27], a[56:59], v[160:163], v[24:27]
    v_exp_f32 v175, v175
    v_mfma_f32_16x16x32_bf16 v[28:31], a[60:63], v[160:163], v[28:31]
    v_cvt_pk_bf16_f32 v171, v174, v175
    v_mfma_f32_16x16x32_bf16 a[208:211], a[228:231], v[160:163], a[208:211]
    s_waitcnt vmcnt(13)
    s_barrier
    v_mfma_f32_16x16x32_bf16 v[184:187], a[0:3], a[176:179], v[212:215]
    v_exp_f32 v176, v176
    v_mfma_f32_16x16x32_bf16 v[184:187], a[4:7], a[180:183], v[184:187]
    ds_read_b128 a[64:67], v225 offset:16384
    ds_read_b128 a[68:71], v226 offset:16384
    v_mfma_f32_16x16x32_bf16 v[184:187], a[8:11], a[184:187], v[184:187]
    v_exp_f32 v177, v177
    v_mfma_f32_16x16x32_bf16 v[184:187], a[12:15], a[188:191], v[184:187]
    v_cvt_pk_bf16_f32 v176, v176, v177
    v_mfma_f32_16x16x32_bf16 v[188:191], a[16:19], a[176:179], v[212:215]
    v_exp_f32 v178, v178
    v_mfma_f32_16x16x32_bf16 v[188:191], a[20:23], a[180:183], v[188:191]
    buffer_load_dwordx4 v238, s[24:27], s75 offen offset:1024 nt lds
    ds_read_b128 a[72:75], v227 offset:16384
    v_mfma_f32_16x16x32_bf16 v[188:191], a[24:27], a[184:187], v[188:191]
    v_exp_f32 v179, v179
    v_mfma_f32_16x16x32_bf16 v[188:191], a[28:31], a[188:191], v[188:191]
    v_cvt_pk_bf16_f32 v177, v178, v179
    v_mfma_f32_16x16x32_bf16 v[32:35], a[32:35], v[168:171], v[32:35]
    v_exp_f32 v180, v180
    v_mfma_f32_16x16x32_bf16 v[36:39], a[36:39], v[168:171], v[36:39]
    ds_read_b128 a[76:79], v228 offset:16384
    ds_read_b128 a[80:83], v225 offset:20480
    v_mfma_f32_16x16x32_bf16 v[40:43], a[40:43], v[168:171], v[40:43]
    v_exp_f32 v181, v181
    v_mfma_f32_16x16x32_bf16 v[44:47], a[44:47], v[168:171], v[44:47]
    v_cvt_pk_bf16_f32 v178, v180, v181
    v_mfma_f32_16x16x32_bf16 v[48:51], a[48:51], v[168:171], v[48:51]
    v_exp_f32 v182, v182
    v_mfma_f32_16x16x32_bf16 v[52:55], a[52:55], v[168:171], v[52:55]
    ds_read_b128 a[84:87], v226 offset:20480
    buffer_load_dwordx4 v239, s[24:27], s75 offen offset:2048 nt lds
    v_mfma_f32_16x16x32_bf16 v[56:59], a[56:59], v[168:171], v[56:59]
    v_exp_f32 v183, v183
    v_mfma_f32_16x16x32_bf16 v[60:63], a[60:63], v[168:171], v[60:63]
    v_cvt_pk_bf16_f32 v179, v182, v183
    v_mfma_f32_16x16x32_bf16 a[212:215], a[228:231], v[168:171], a[212:215]
    ds_read_b128 a[88:91], v227 offset:20480
    ds_read_b128 a[92:95], v228 offset:20480
    v_mfma_f32_16x16x32_bf16 v[192:195], a[0:3], a[192:195], v[216:219]
    v_exp_f32 v184, v184
    v_mfma_f32_16x16x32_bf16 v[192:195], a[4:7], a[196:199], v[192:195]
    buffer_load_dwordx4 v240, s[24:27], s75 offen offset:3072 nt lds
    v_mfma_f32_16x16x32_bf16 v[192:195], a[8:11], a[200:203], v[192:195]
    v_exp_f32 v185, v185
    v_mfma_f32_16x16x32_bf16 v[192:195], a[12:15], a[204:207], v[192:195]
    v_cvt_pk_bf16_f32 v184, v184, v185
    v_mfma_f32_16x16x32_bf16 v[196:199], a[16:19], a[192:195], v[216:219]
    v_exp_f32 v186, v186
    v_mfma_f32_16x16x32_bf16 v[196:199], a[20:23], a[196:199], v[196:199]
    v_mfma_f32_16x16x32_bf16 v[196:199], a[24:27], a[200:203], v[196:199]
    v_exp_f32 v187, v187
    v_mfma_f32_16x16x32_bf16 v[196:199], a[28:31], a[204:207], v[196:199]
    v_cvt_pk_bf16_f32 v185, v186, v187
    v_mfma_f32_16x16x32_bf16 v[64:67], a[32:35], v[176:179], v[64:67]
    v_exp_f32 v188, v188
    v_mfma_f32_16x16x32_bf16 v[68:71], a[36:39], v[176:179], v[68:71]
    s_add_u32 m0, s61, 57344
    s_nop 0
    buffer_load_dwordx4 v244, s[16:19], s75 offen offset:0 nt lds
    v_mfma_f32_16x16x32_bf16 v[72:75], a[40:43], v[176:179], v[72:75]
    v_exp_f32 v189, v189
    v_mfma_f32_16x16x32_bf16 v[76:79], a[44:47], v[176:179], v[76:79]
    v_cvt_pk_bf16_f32 v186, v188, v189
    v_mfma_f32_16x16x32_bf16 v[80:83], a[48:51], v[176:179], v[80:83]
    v_exp_f32 v190, v190
    v_mfma_f32_16x16x32_bf16 v[84:87], a[52:55], v[176:179], v[84:87]
    v_mfma_f32_16x16x32_bf16 v[88:91], a[56:59], v[176:179], v[88:91]
    v_exp_f32 v191, v191
    v_mfma_f32_16x16x32_bf16 v[92:95], a[60:63], v[176:179], v[92:95]
    v_cvt_pk_bf16_f32 v187, v190, v191
    v_mfma_f32_16x16x32_bf16 a[216:219], a[228:231], v[176:179], a[216:219]
    s_waitcnt vmcnt(13) lgkmcnt(0)
    s_barrier
    v_mfma_f32_16x16x32_bf16 v[160:163], a[64:67], a[128:131], v[200:203]
    v_exp_f32 v192, v192
    v_mfma_f32_16x16x32_bf16 v[160:163], a[68:71], a[132:135], v[160:163]
    ds_read_b64_tr_b16 a[96:97], v229 offset:16384
    ds_read_b64_tr_b16 a[98:99], v229 offset:20480
    v_mfma_f32_16x16x32_bf16 v[160:163], a[72:75], a[136:139], v[160:163]
    v_exp_f32 v193, v193
    v_mfma_f32_16x16x32_bf16 v[160:163], a[76:79], a[140:143], v[160:163]
    v_cvt_pk_bf16_f32 v192, v192, v193
    buffer_load_dwordx4 v253, s[16:19], s75 offen offset:1024 nt lds
    v_mfma_f32_16x16x32_bf16 v[164:167], a[80:83], a[128:131], v[200:203]
    v_exp_f32 v194, v194
    v_mfma_f32_16x16x32_bf16 v[164:167], a[84:87], a[132:135], v[164:167]
    ds_read_b64_tr_b16 a[100:101], v230 offset:16384
    ds_read_b64_tr_b16 a[102:103], v230 offset:20480
    v_mfma_f32_16x16x32_bf16 v[164:167], a[88:91], a[136:139], v[164:167]
    v_exp_f32 v195, v195
    v_mfma_f32_16x16x32_bf16 v[164:167], a[92:95], a[140:143], v[164:167]
    v_cvt_pk_bf16_f32 v193, v194, v195
    v_mfma_f32_16x16x32_bf16 v[96:99], a[32:35], v[184:187], v[96:99]
    v_exp_f32 v196, v196
    v_mfma_f32_16x16x32_bf16 v[100:103], a[36:39], v[184:187], v[100:103]
    ds_read_b64_tr_b16 a[104:105], v231 offset:16384
    ds_read_b64_tr_b16 a[106:107], v231 offset:20480
    v_mfma_f32_16x16x32_bf16 v[104:107], a[40:43], v[184:187], v[104:107]
    v_exp_f32 v197, v197
    v_mfma_f32_16x16x32_bf16 v[108:111], a[44:47], v[184:187], v[108:111]
    v_cvt_pk_bf16_f32 v194, v196, v197
    v_mfma_f32_16x16x32_bf16 v[112:115], a[48:51], v[184:187], v[112:115]
    v_exp_f32 v198, v198
    v_mfma_f32_16x16x32_bf16 v[116:119], a[52:55], v[184:187], v[116:119]
    ds_read_b64_tr_b16 a[108:109], v232 offset:16384
    buffer_load_dwordx4 v244, s[16:19], s75 offen offset:2048 nt lds
    v_mfma_f32_16x16x32_bf16 v[120:123], a[56:59], v[184:187], v[120:123]
    v_exp_f32 v199, v199
    v_mfma_f32_16x16x32_bf16 v[124:127], a[60:63], v[184:187], v[124:127]
    v_cvt_pk_bf16_f32 v195, v198, v199
    v_mfma_f32_16x16x32_bf16 a[220:223], a[228:231], v[184:187], a[220:223]
    ds_read_b64_tr_b16 a[110:111], v232 offset:20480
    ds_read_b64_tr_b16 a[112:113], v233 offset:16384
    v_mfma_f32_16x16x32_bf16 v[168:171], a[64:67], a[144:147], v[204:207]
    v_exp_f32 v160, v160
    v_mfma_f32_16x16x32_bf16 v[168:171], a[68:71], a[148:151], v[168:171]
    ds_read_b64_tr_b16 a[114:115], v233 offset:20480
    ds_read_b64_tr_b16 a[116:117], v234 offset:16384
    v_mfma_f32_16x16x32_bf16 v[168:171], a[72:75], a[152:155], v[168:171]
    v_exp_f32 v161, v161
    v_mfma_f32_16x16x32_bf16 v[168:171], a[76:79], a[156:159], v[168:171]
    v_cvt_pk_bf16_f32 v160, v160, v161
    v_mfma_f32_16x16x32_bf16 v[172:175], a[80:83], a[144:147], v[204:207]
    v_exp_f32 v162, v162
    v_mfma_f32_16x16x32_bf16 v[172:175], a[84:87], a[148:151], v[172:175]
    ds_read_b64_tr_b16 a[118:119], v234 offset:20480
    ds_read_b64_tr_b16 a[120:121], v235 offset:16384
    v_mfma_f32_16x16x32_bf16 v[172:175], a[88:91], a[152:155], v[172:175]
    v_exp_f32 v163, v163
    v_mfma_f32_16x16x32_bf16 v[172:175], a[92:95], a[156:159], v[172:175]
    v_cvt_pk_bf16_f32 v161, v162, v163
    v_mfma_f32_16x16x32_bf16 v[128:131], a[32:35], v[192:195], v[128:131]
    v_exp_f32 v164, v164
    v_mfma_f32_16x16x32_bf16 v[132:135], a[36:39], v[192:195], v[132:135]
    buffer_load_dwordx4 v253, s[16:19], s75 offen offset:3072 nt lds
    s_add_u32 s75, s75, 8192
    s_and_b32 s75, s75, 0x1e000
    s_or_b32 s75, s75, s60
    ds_read_b64_tr_b16 a[122:123], v235 offset:20480
    v_mfma_f32_16x16x32_bf16 v[136:139], a[40:43], v[192:195], v[136:139]
    v_exp_f32 v165, v165
    v_mfma_f32_16x16x32_bf16 v[140:143], a[44:47], v[192:195], v[140:143]
    v_cvt_pk_bf16_f32 v162, v164, v165
    v_mfma_f32_16x16x32_bf16 v[144:147], a[48:51], v[192:195], v[144:147]
    v_exp_f32 v166, v166
    v_mfma_f32_16x16x32_bf16 v[148:151], a[52:55], v[192:195], v[148:151]
    ds_read_b64_tr_b16 a[124:125], v236 offset:16384
    v_mfma_f32_16x16x32_bf16 v[152:155], a[56:59], v[192:195], v[152:155]
    v_exp_f32 v167, v167
    v_mfma_f32_16x16x32_bf16 v[156:159], a[60:63], v[192:195], v[156:159]
    v_cvt_pk_bf16_f32 v163, v166, v167
    v_mfma_f32_16x16x32_bf16 a[224:227], a[228:231], v[192:195], a[224:227]
    ds_read_b64_tr_b16 a[126:127], v236 offset:20480
    v_mfma_f32_16x16x32_bf16 v[176:179], a[64:67], a[160:163], v[208:211]
    v_exp_f32 v168, v168
    v_mfma_f32_16x16x32_bf16 v[176:179], a[68:71], a[164:167], v[176:179]
    v_mfma_f32_16x16x32_bf16 v[176:179], a[72:75], a[168:171], v[176:179]
    v_exp_f32 v169, v169
    v_mfma_f32_16x16x32_bf16 v[176:179], a[76:79], a[172:175], v[176:179]
    v_cvt_pk_bf16_f32 v168, v168, v169
    v_mfma_f32_16x16x32_bf16 v[180:183], a[80:83], a[160:163], v[208:211]
    v_exp_f32 v170, v170
    v_mfma_f32_16x16x32_bf16 v[180:183], a[84:87], a[164:167], v[180:183]
    v_mfma_f32_16x16x32_bf16 v[180:183], a[88:91], a[168:171], v[180:183]
    v_exp_f32 v171, v171
    v_mfma_f32_16x16x32_bf16 v[180:183], a[92:95], a[172:175], v[180:183]
    v_cvt_pk_bf16_f32 v169, v170, v171
    s_waitcnt lgkmcnt(0)
    v_mfma_f32_16x16x32_bf16 v[0:3], a[96:99], v[160:163], v[0:3]
    v_exp_f32 v172, v172
    v_mfma_f32_16x16x32_bf16 v[4:7], a[100:103], v[160:163], v[4:7]
    v_mfma_f32_16x16x32_bf16 v[8:11], a[104:107], v[160:163], v[8:11]
    v_exp_f32 v173, v173
    v_mfma_f32_16x16x32_bf16 v[12:15], a[108:111], v[160:163], v[12:15]
    v_cvt_pk_bf16_f32 v170, v172, v173
    v_mfma_f32_16x16x32_bf16 v[16:19], a[112:115], v[160:163], v[16:19]
    v_exp_f32 v174, v174
    v_mfma_f32_16x16x32_bf16 v[20:23], a[116:119], v[160:163], v[20:23]
    v_mfma_f32_16x16x32_bf16 v[24:27], a[120:123], v[160:163], v[24:27]
    v_exp_f32 v175, v175
    v_mfma_f32_16x16x32_bf16 v[28:31], a[124:127], v[160:163], v[28:31]
    v_cvt_pk_bf16_f32 v171, v174, v175
    v_mfma_f32_16x16x32_bf16 a[208:211], a[228:231], v[160:163], a[208:211]
    s_waitcnt vmcnt(12)
    s_barrier
    v_mfma_f32_16x16x32_bf16 v[184:187], a[64:67], a[176:179], v[212:215]
    v_exp_f32 v176, v176
    v_mfma_f32_16x16x32_bf16 v[184:187], a[68:71], a[180:183], v[184:187]
    ds_read_b128 a[0:3], v225 offset:32768
    ds_read_b128 a[4:7], v226 offset:32768
    v_mfma_f32_16x16x32_bf16 v[184:187], a[72:75], a[184:187], v[184:187]
    v_exp_f32 v177, v177
    v_mfma_f32_16x16x32_bf16 v[184:187], a[76:79], a[188:191], v[184:187]
    v_cvt_pk_bf16_f32 v176, v176, v177
    s_add_u32 m0, s72, 0
    s_add_u32 s54, s70, 0
    buffer_load_dwordx4 v220, s[32:35], s54 offen offset:0 lds
    buffer_load_dwordx4 v221, s[32:35], s54 offen offset:1024 lds
    v_mfma_f32_16x16x32_bf16 v[188:191], a[80:83], a[176:179], v[212:215]
    v_exp_f32 v178, v178
    v_mfma_f32_16x16x32_bf16 v[188:191], a[84:87], a[180:183], v[188:191]
    ds_read_b128 a[8:11], v227 offset:32768
    ds_read_b128 a[12:15], v228 offset:32768
    v_mfma_f32_16x16x32_bf16 v[188:191], a[88:91], a[184:187], v[188:191]
    v_exp_f32 v179, v179
    v_mfma_f32_16x16x32_bf16 v[188:191], a[92:95], a[188:191], v[188:191]
    v_cvt_pk_bf16_f32 v177, v178, v179
    buffer_load_dwordx4 v222, s[32:35], s54 offen offset:2048 lds
    v_mfma_f32_16x16x32_bf16 v[32:35], a[96:99], v[168:171], v[32:35]
    v_exp_f32 v180, v180
    v_mfma_f32_16x16x32_bf16 v[36:39], a[100:103], v[168:171], v[36:39]
    ds_read_b128 a[16:19], v225 offset:36864
    buffer_load_dwordx4 v223, s[32:35], s54 offen offset:3072 lds
    v_mfma_f32_16x16x32_bf16 v[40:43], a[104:107], v[168:171], v[40:43]
    v_exp_f32 v181, v181
    v_mfma_f32_16x16x32_bf16 v[44:47], a[108:111], v[168:171], v[44:47]
    v_cvt_pk_bf16_f32 v178, v180, v181
    v_mfma_f32_16x16x32_bf16 v[48:51], a[112:115], v[168:171], v[48:51]
    v_exp_f32 v182, v182
    v_mfma_f32_16x16x32_bf16 v[52:55], a[116:119], v[168:171], v[52:55]
    ds_read_b128 a[20:23], v226 offset:36864
    ds_read_b128 a[24:27], v227 offset:36864
    v_mfma_f32_16x16x32_bf16 v[56:59], a[120:123], v[168:171], v[56:59]
    v_exp_f32 v183, v183
    v_mfma_f32_16x16x32_bf16 v[60:63], a[124:127], v[168:171], v[60:63]
    v_cvt_pk_bf16_f32 v179, v182, v183
    v_mfma_f32_16x16x32_bf16 a[212:215], a[228:231], v[168:171], a[212:215]
    s_add_u32 m0, s72, 4096
    s_nop 0
    buffer_load_dwordx4 v224, s[32:35], s54 offen offset:0 lds
    ds_read_b128 a[28:31], v228 offset:36864
    v_mfma_f32_16x16x32_bf16 v[192:195], a[64:67], a[192:195], v[216:219]
    v_exp_f32 v184, v184
    v_mfma_f32_16x16x32_bf16 v[192:195], a[68:71], a[196:199], v[192:195]
    s_add_u32 m0, s73, 0
    s_add_u32 s54, s70, 40960
    buffer_load_dwordx4 v220, s[32:35], s54 offen offset:0 lds
    buffer_load_dwordx4 v221, s[32:35], s54 offen offset:1024 lds
    v_mfma_f32_16x16x32_bf16 v[192:195], a[72:75], a[200:203], v[192:195]
    v_exp_f32 v185, v185
    v_mfma_f32_16x16x32_bf16 v[192:195], a[76:79], a[204:207], v[192:195]
    v_cvt_pk_bf16_f32 v184, v184, v185
    v_mfma_f32_16x16x32_bf16 v[196:199], a[80:83], a[192:195], v[216:219]
    v_exp_f32 v186, v186
    v_mfma_f32_16x16x32_bf16 v[196:199], a[84:87], a[196:199], v[196:199]
    buffer_load_dwordx4 v222, s[32:35], s54 offen offset:2048 lds
    v_mfma_f32_16x16x32_bf16 v[196:199], a[88:91], a[200:203], v[196:199]
    v_exp_f32 v187, v187
    v_mfma_f32_16x16x32_bf16 v[196:199], a[92:95], a[204:207], v[196:199]
    v_cvt_pk_bf16_f32 v185, v186, v187
    v_mfma_f32_16x16x32_bf16 v[64:67], a[96:99], v[176:179], v[64:67]
    v_exp_f32 v188, v188
    v_mfma_f32_16x16x32_bf16 v[68:71], a[100:103], v[176:179], v[68:71]
    buffer_load_dwordx4 v223, s[32:35], s54 offen offset:3072 lds
    v_mfma_f32_16x16x32_bf16 v[72:75], a[104:107], v[176:179], v[72:75]
    v_exp_f32 v189, v189
    v_mfma_f32_16x16x32_bf16 v[76:79], a[108:111], v[176:179], v[76:79]
    v_cvt_pk_bf16_f32 v186, v188, v189
    v_mfma_f32_16x16x32_bf16 v[80:83], a[112:115], v[176:179], v[80:83]
    v_exp_f32 v190, v190
    v_mfma_f32_16x16x32_bf16 v[84:87], a[116:119], v[176:179], v[84:87]
    s_add_u32 m0, s73, 4096
    s_nop 0
    buffer_load_dwordx4 v224, s[32:35], s54 offen offset:0 lds
    v_mfma_f32_16x16x32_bf16 v[88:91], a[120:123], v[176:179], v[88:91]
    v_exp_f32 v191, v191
    v_mfma_f32_16x16x32_bf16 v[92:95], a[124:127], v[176:179], v[92:95]
    v_cvt_pk_bf16_f32 v187, v190, v191
    v_mfma_f32_16x16x32_bf16 a[216:219], a[228:231], v[176:179], a[216:219]
    s_waitcnt vmcnt(14) lgkmcnt(0)
    s_barrier
    v_mfma_f32_16x16x32_bf16 v[160:163], a[0:3], a[128:131], v[200:203]
    v_exp_f32 v192, v192
    v_mfma_f32_16x16x32_bf16 v[160:163], a[4:7], a[132:135], v[160:163]
    ds_read_b128 a[64:67], v225 offset:49152
    ds_read_b128 a[68:71], v226 offset:49152
    v_mfma_f32_16x16x32_bf16 v[160:163], a[8:11], a[136:139], v[160:163]
    v_exp_f32 v193, v193
    v_mfma_f32_16x16x32_bf16 v[160:163], a[12:15], a[140:143], v[160:163]
    v_cvt_pk_bf16_f32 v192, v192, v193
    ds_read_b128 a[72:75], v227 offset:49152
    v_mfma_f32_16x16x32_bf16 v[164:167], a[16:19], a[128:131], v[200:203]
    v_exp_f32 v194, v194
    v_mfma_f32_16x16x32_bf16 v[164:167], a[20:23], a[132:135], v[164:167]
    ds_read_b128 a[76:79], v228 offset:49152
    ds_read_b128 a[80:83], v225 offset:53248
    v_mfma_f32_16x16x32_bf16 v[164:167], a[24:27], a[136:139], v[164:167]
    v_exp_f32 v195, v195
    v_mfma_f32_16x16x32_bf16 v[164:167], a[28:31], a[140:143], v[164:167]
    v_cvt_pk_bf16_f32 v193, v194, v195
    ds_read_b128 a[84:87], v226 offset:53248
    v_mfma_f32_16x16x32_bf16 v[96:99], a[96:99], v[184:187], v[96:99]
    v_exp_f32 v196, v196
    v_mfma_f32_16x16x32_bf16 v[100:103], a[100:103], v[184:187], v[100:103]
    ds_read_b128 a[88:91], v227 offset:53248
    ds_read_b128 a[92:95], v228 offset:53248
    v_mfma_f32_16x16x32_bf16 v[104:107], a[104:107], v[184:187], v[104:107]
    v_exp_f32 v197, v197
    v_mfma_f32_16x16x32_bf16 v[108:111], a[108:111], v[184:187], v[108:111]
    v_cvt_pk_bf16_f32 v194, v196, v197
    ds_read_b64_tr_b16 a[32:33], v229 offset:32768
    v_mfma_f32_16x16x32_bf16 v[112:115], a[112:115], v[184:187], v[112:115]
    v_exp_f32 v198, v198
    v_mfma_f32_16x16x32_bf16 v[116:119], a[116:119], v[184:187], v[116:119]
    ds_read_b64_tr_b16 a[34:35], v229 offset:36864
    ds_read_b64_tr_b16 a[36:37], v230 offset:32768
    v_mfma_f32_16x16x32_bf16 v[120:123], a[120:123], v[184:187], v[120:123]
    v_exp_f32 v199, v199
    v_mfma_f32_16x16x32_bf16 v[124:127], a[124:127], v[184:187], v[124:127]
    v_cvt_pk_bf16_f32 v195, v198, v199
    v_mfma_f32_16x16x32_bf16 a[220:223], a[228:231], v[184:187], a[220:223]
    ds_read_b64_tr_b16 a[38:39], v230 offset:36864
    ds_read_b64_tr_b16 a[40:41], v231 offset:32768
    s_waitcnt lgkmcnt(5)
    v_mfma_f32_16x16x32_bf16 v[168:171], a[64:67], a[128:131], v[200:203]
    v_exp_f32 v160, v160
    v_mfma_f32_16x16x32_bf16 v[168:171], a[68:71], a[132:135], v[168:171]
    ds_read_b64_tr_b16 a[42:43], v231 offset:36864
    ds_read_b64_tr_b16 a[44:45], v232 offset:32768
    v_mfma_f32_16x16x32_bf16 v[168:171], a[72:75], a[136:139], v[168:171]
    v_exp_f32 v161, v161
    v_mfma_f32_16x16x32_bf16 v[168:171], a[76:79], a[140:143], v[168:171]
    v_cvt_pk_bf16_f32 v160, v160, v161
    ds_read_b64_tr_b16 a[46:47], v232 offset:36864
    v_mfma_f32_16x16x32_bf16 v[172:175], a[80:83], a[128:131], v[200:203]
    v_exp_f32 v162, v162
    v_mfma_f32_16x16x32_bf16 v[172:175], a[84:87], a[132:135], v[172:175]
    ds_read_b64_tr_b16 a[48:49], v233 offset:32768
    ds_read_b64_tr_b16 a[50:51], v233 offset:36864
    v_mfma_f32_16x16x32_bf16 v[172:175], a[88:91], a[136:139], v[172:175]
    v_exp_f32 v163, v163
    v_mfma_f32_16x16x32_bf16 v[172:175], a[92:95], a[140:143], v[172:175]
    v_cvt_pk_bf16_f32 v161, v162, v163
    v_mfma_f32_16x16x32_bf16 v[128:131], a[96:99], v[192:195], v[128:131]
    v_exp_f32 v164, v164
    v_mfma_f32_16x16x32_bf16 v[132:135], a[100:103], v[192:195], v[132:135]
    ds_read_b64_tr_b16 a[52:53], v234 offset:32768
    ds_read_b64_tr_b16 a[54:55], v234 offset:36864
    v_mfma_f32_16x16x32_bf16 v[136:139], a[104:107], v[192:195], v[136:139]
    v_exp_f32 v165, v165
    v_mfma_f32_16x16x32_bf16 v[140:143], a[108:111], v[192:195], v[140:143]
    v_cvt_pk_bf16_f32 v162, v164, v165
    v_mfma_f32_16x16x32_bf16 v[144:147], a[112:115], v[192:195], v[144:147]
    v_exp_f32 v166, v166
    v_mfma_f32_16x16x32_bf16 v[148:151], a[116:119], v[192:195], v[148:151]
    ds_read_b64_tr_b16 a[56:57], v235 offset:32768
    ds_read_b64_tr_b16 a[58:59], v235 offset:36864
    v_mfma_f32_16x16x32_bf16 v[152:155], a[120:123], v[192:195], v[152:155]
    v_exp_f32 v167, v167
    v_mfma_f32_16x16x32_bf16 v[156:159], a[124:127], v[192:195], v[156:159]
    v_cvt_pk_bf16_f32 v163, v166, v167
    v_mfma_f32_16x16x32_bf16 a[224:227], a[228:231], v[192:195], a[224:227]
    ds_read_b64_tr_b16 a[60:61], v236 offset:32768
    ds_read_b64_tr_b16 a[62:63], v236 offset:36864
    s_waitcnt vmcnt(10)
    s_barrier
    v_mov_b32 v246, 0x4b800000
    s_mov_b64 s[66:67], 0
    v_mfma_f32_16x16x32_bf16 v[176:179], a[0:3], a[144:147], v[204:207]
    v_exp_f32 v168, v168
    v_mfma_f32_16x16x32_bf16 v[176:179], a[4:7], a[148:151], v[176:179]
    ds_read_b64_tr_b16 a[96:97], v229 offset:49152
    ds_read_b64_tr_b16 a[98:99], v229 offset:53248
    ds_read_b64_tr_b16 a[100:101], v230 offset:49152
    ds_read_b64_tr_b16 a[102:103], v230 offset:53248
    v_mfma_f32_16x16x32_bf16 v[176:179], a[8:11], a[152:155], v[176:179]
    v_exp_f32 v169, v169
    v_mfma_f32_16x16x32_bf16 v[176:179], a[12:15], a[156:159], v[176:179]
    v_cvt_pk_bf16_f32 v168, v168, v169
    v_mfma_f32_16x16x32_bf16 v[180:183], a[16:19], a[144:147], v[204:207]
    v_exp_f32 v170, v170
    v_mfma_f32_16x16x32_bf16 v[180:183], a[20:23], a[148:151], v[180:183]
    ds_read_b64_tr_b16 a[104:105], v231 offset:49152
    ds_read_b64_tr_b16 a[106:107], v231 offset:53248
    ds_read_b64_tr_b16 a[108:109], v232 offset:49152
    ds_read_b64_tr_b16 a[110:111], v232 offset:53248
    v_mfma_f32_16x16x32_bf16 v[180:183], a[24:27], a[152:155], v[180:183]
    v_exp_f32 v171, v171
    v_mfma_f32_16x16x32_bf16 v[180:183], a[28:31], a[156:159], v[180:183]
    v_cvt_pk_bf16_f32 v169, v170, v171
    s_waitcnt lgkmcnt(8)
    v_mfma_f32_16x16x32_bf16 v[0:3], a[32:35], v[160:163], v[0:3]
    v_exp_f32 v172, v172
    v_mfma_f32_16x16x32_bf16 v[4:7], a[36:39], v[160:163], v[4:7]
    ds_read_b64_tr_b16 a[112:113], v233 offset:49152
    ds_read_b64_tr_b16 a[114:115], v233 offset:53248
    ds_read_b64_tr_b16 a[116:117], v234 offset:49152
    ds_read_b64_tr_b16 a[118:119], v234 offset:53248
    v_mfma_f32_16x16x32_bf16 v[8:11], a[40:43], v[160:163], v[8:11]
    v_exp_f32 v173, v173
    v_mfma_f32_16x16x32_bf16 v[12:15], a[44:47], v[160:163], v[12:15]
    v_cvt_pk_bf16_f32 v170, v172, v173
    v_mfma_f32_16x16x32_bf16 v[16:19], a[48:51], v[160:163], v[16:19]
    v_exp_f32 v174, v174
    v_mfma_f32_16x16x32_bf16 v[20:23], a[52:55], v[160:163], v[20:23]
    ds_read_b64_tr_b16 a[120:121], v235 offset:49152
    ds_read_b64_tr_b16 a[122:123], v235 offset:53248
    v_mfma_f32_16x16x32_bf16 v[24:27], a[56:59], v[160:163], v[24:27]
    v_exp_f32 v175, v175
    v_mfma_f32_16x16x32_bf16 v[28:31], a[60:63], v[160:163], v[28:31]
    v_cvt_pk_bf16_f32 v171, v174, v175
    v_mfma_f32_16x16x32_bf16 a[208:211], a[228:231], v[160:163], a[208:211]
    ds_read_b64_tr_b16 a[124:125], v236 offset:49152
    ds_read_b64_tr_b16 a[126:127], v236 offset:53248
    v_mfma_f32_16x16x32_bf16 v[184:187], a[64:67], a[144:147], v[204:207]
    v_exp_f32 v176, v176
    v_mfma_f32_16x16x32_bf16 v[184:187], a[68:71], a[148:151], v[184:187]
    s_add_u32 m0, s74, 0
    s_add_u32 s54, s71, 0
    buffer_load_dwordx4 v220, s[32:35], s54 offen offset:0 lds
    buffer_load_dwordx4 v221, s[32:35], s54 offen offset:1024 lds
    buffer_load_dwordx4 v222, s[32:35], s54 offen offset:2048 lds
    v_mfma_f32_16x16x32_bf16 v[184:187], a[72:75], a[152:155], v[184:187]
    v_exp_f32 v177, v177
    v_mfma_f32_16x16x32_bf16 v[184:187], a[76:79], a[156:159], v[184:187]
    v_cvt_pk_bf16_f32 v176, v176, v177
    v_mfma_f32_16x16x32_bf16 v[188:191], a[80:83], a[144:147], v[204:207]
    v_exp_f32 v178, v178
    v_mfma_f32_16x16x32_bf16 v[188:191], a[84:87], a[148:151], v[188:191]
    buffer_load_dwordx4 v223, s[32:35], s54 offen offset:3072 lds
    s_add_u32 m0, s74, 4096
    s_nop 0
    buffer_load_dwordx4 v224, s[32:35], s54 offen offset:0 lds
    v_mfma_f32_16x16x32_bf16 v[188:191], a[88:91], a[152:155], v[188:191]
    v_exp_f32 v179, v179
    v_mfma_f32_16x16x32_bf16 v[188:191], a[92:95], a[156:159], v[188:191]
    v_cvt_pk_bf16_f32 v177, v178, v179
    s_waitcnt lgkmcnt(0)
    v_mfma_f32_16x16x32_bf16 v[0:3], a[96:99], v[168:171], v[0:3]
    v_exp_f32 v180, v180
    v_mfma_f32_16x16x32_bf16 v[4:7], a[100:103], v[168:171], v[4:7]
    s_add_u32 m0, s74, 5120
    s_add_u32 s54, s71, 40960
    buffer_load_dwordx4 v220, s[32:35], s54 offen offset:0 lds
    buffer_load_dwordx4 v221, s[32:35], s54 offen offset:1024 lds
    buffer_load_dwordx4 v222, s[32:35], s54 offen offset:2048 lds
    v_mfma_f32_16x16x32_bf16 v[8:11], a[104:107], v[168:171], v[8:11]
    v_exp_f32 v181, v181
    v_mfma_f32_16x16x32_bf16 v[12:15], a[108:111], v[168:171], v[12:15]
    v_cvt_pk_bf16_f32 v178, v180, v181
    v_mfma_f32_16x16x32_bf16 v[16:19], a[112:115], v[168:171], v[16:19]
    v_exp_f32 v182, v182
    v_mfma_f32_16x16x32_bf16 v[20:23], a[116:119], v[168:171], v[20:23]
    buffer_load_dwordx4 v223, s[32:35], s54 offen offset:3072 lds
    v_mfma_f32_16x16x32_bf16 v[24:27], a[120:123], v[168:171], v[24:27]
    v_exp_f32 v183, v183
    v_mfma_f32_16x16x32_bf16 v[28:31], a[124:127], v[168:171], v[28:31]
    v_cvt_pk_bf16_f32 v179, v182, v183
    v_mfma_f32_16x16x32_bf16 a[208:211], a[228:231], v[168:171], a[208:211]
    s_add_u32 m0, s74, 9216
    s_nop 0
    buffer_load_dwordx4 v224, s[32:35], s54 offen offset:0 lds
    s_barrier
    v_mfma_f32_16x16x32_bf16 v[192:195], a[0:3], a[160:163], v[208:211]
    v_exp_f32 v184, v184
    v_exp_f32 v185, v185
    v_mfma_f32_16x16x32_bf16 v[192:195], a[4:7], a[164:167], v[192:195]
    v_exp_f32 v186, v186
    v_mfma_f32_16x16x32_bf16 v[192:195], a[8:11], a[168:171], v[192:195]
    v_cvt_pk_bf16_f32 v184, v184, v185
    v_accvgpr_read_b32 v201, a208
    v_cmp_nlt_f32 vcc, v201, v246
    v_mfma_f32_16x16x32_bf16 v[192:195], a[12:15], a[172:175], v[192:195]
    v_exp_f32 v187, v187
    v_rcp_f32 v200, v201
    v_mfma_f32_16x16x32_bf16 v[196:199], a[16:19], a[160:163], v[208:211]
    s_or_b64 s[66:67], s[66:67], vcc
    v_pk_mul_f32 v[0:1], v[0:1], v[200:201] op_sel_hi:[1,0]
    v_mfma_f32_16x16x32_bf16 v[196:199], a[20:23], a[164:167], v[196:199]
    v_pk_mul_f32 v[2:3], v[2:3], v[200:201] op_sel_hi:[1,0]
    v_exp_f32 v188, v188
    v_mfma_f32_16x16x32_bf16 v[196:199], a[24:27], a[168:171], v[196:199]
    v_pk_mul_f32 v[4:5], v[4:5], v[200:201] op_sel_hi:[1,0]
    v_pk_mul_f32 v[6:7], v[6:7], v[200:201] op_sel_hi:[1,0]
    v_cvt_pk_bf16_f32 v0, v0, v1
    v_mfma_f32_16x16x32_bf16 v[196:199], a[28:31], a[172:175], v[196:199]
    v_cvt_pk_bf16_f32 v1, v2, v3
    v_cvt_pk_bf16_f32 v185, v186, v187
    v_cvt_pk_bf16_f32 v2, v4, v5
    v_mfma_f32_16x16x32_bf16 v[32:35], a[32:35], v[176:179], v[32:35]
    v_cvt_pk_bf16_f32 v3, v6, v7
    buffer_store_dwordx4 v[0:3], v241, s[28:31], s48 offen offset:0 sc1
    v_exp_f32 v189, v189
    v_mfma_f32_16x16x32_bf16 v[36:39], a[36:39], v[176:179], v[36:39]
    ds_write_b128 v251, v[0:3] offset:0
    v_pk_mul_f32 v[8:9], v[8:9], v[200:201] op_sel_hi:[1,0]
    v_mfma_f32_16x16x32_bf16 v[40:43], a[40:43], v[176:179], v[40:43]
    v_pk_mul_f32 v[10:11], v[10:11], v[200:201] op_sel_hi:[1,0]
    v_pk_mul_f32 v[12:13], v[12:13], v[200:201] op_sel_hi:[1,0]
    v_pk_mul_f32 v[14:15], v[14:15], v[200:201] op_sel_hi:[1,0]
    v_mfma_f32_16x16x32_bf16 v[44:47], a[44:47], v[176:179], v[44:47]
    v_exp_f32 v190, v190
    v_cvt_pk_bf16_f32 v8, v8, v9
    v_mfma_f32_16x16x32_bf16 v[48:51], a[48:51], v[176:179], v[48:51]
    v_cvt_pk_bf16_f32 v9, v10, v11
    v_cvt_pk_bf16_f32 v10, v12, v13
    v_cvt_pk_bf16_f32 v11, v14, v15
    v_mfma_f32_16x16x32_bf16 v[52:55], a[52:55], v[176:179], v[52:55]
    v_cvt_pk_bf16_f32 v186, v188, v189
    buffer_store_dwordx4 v[8:11], v241, s[28:31], s49 offen offset:0 sc1
    ds_write_b128 v251, v[8:11] offset:1024
    v_mfma_f32_16x16x32_bf16 v[56:59], a[56:59], v[176:179], v[56:59]
    v_pk_mul_f32 v[16:17], v[16:17], v[200:201] op_sel_hi:[1,0]
    v_exp_f32 v191, v191
    v_mfma_f32_16x16x32_bf16 v[60:63], a[60:63], v[176:179], v[60:63]
    v_pk_mul_f32 v[18:19], v[18:19], v[200:201] op_sel_hi:[1,0]
    v_pk_mul_f32 v[20:21], v[20:21], v[200:201] op_sel_hi:[1,0]
    v_pk_mul_f32 v[22:23], v[22:23], v[200:201] op_sel_hi:[1,0]
    v_mfma_f32_16x16x32_bf16 a[212:215], a[228:231], v[176:179], a[212:215]
    v_cvt_pk_bf16_f32 v16, v16, v17
    v_cvt_pk_bf16_f32 v187, v190, v191
    v_cvt_pk_bf16_f32 v17, v18, v19
    v_mfma_f32_16x16x32_bf16 v[160:163], a[64:67], a[160:163], v[208:211]
    v_exp_f32 v192, v192
    v_mfma_f32_16x16x32_bf16 v[160:163], a[68:71], a[164:167], v[160:163]
    v_exp_f32 v193, v193
    v_mfma_f32_16x16x32_bf16 v[160:163], a[72:75], a[168:171], v[160:163]
    v_exp_f32 v194, v194
    v_mfma_f32_16x16x32_bf16 v[160:163], a[76:79], a[172:175], v[160:163]
    v_cvt_pk_bf16_f32 v192, v192, v193
    v_cvt_pk_bf16_f32 v18, v20, v21
    v_mfma_f32_16x16x32_bf16 v[164:167], a[80:83], a[160:163], v[208:211]
    v_exp_f32 v195, v195
    v_mfma_f32_16x16x32_bf16 v[164:167], a[84:87], a[164:167], v[164:167]
    v_cvt_pk_bf16_f32 v19, v22, v23
    buffer_store_dwordx4 v[16:19], v241, s[28:31], s50 offen offset:0 sc1
    v_mfma_f32_16x16x32_bf16 v[164:167], a[88:91], a[168:171], v[164:167]
    v_exp_f32 v196, v196
    v_mfma_f32_16x16x32_bf16 v[164:167], a[92:95], a[172:175], v[164:167]
    ds_write_b128 v251, v[16:19] offset:2048
    v_pk_mul_f32 v[24:25], v[24:25], v[200:201] op_sel_hi:[1,0]
    v_mfma_f32_16x16x32_bf16 v[32:35], a[96:99], v[184:187], v[32:35]
    v_cvt_pk_bf16_f32 v193, v194, v195
    v_pk_mul_f32 v[26:27], v[26:27], v[200:201] op_sel_hi:[1,0]
    v_mfma_f32_16x16x32_bf16 v[36:39], a[100:103], v[184:187], v[36:39]
    v_exp_f32 v197, v197
    v_mfma_f32_16x16x32_bf16 v[40:43], a[104:107], v[184:187], v[40:43]
    v_pk_mul_f32 v[28:29], v[28:29], v[200:201] op_sel_hi:[1,0]
    v_pk_mul_f32 v[30:31], v[30:31], v[200:201] op_sel_hi:[1,0]
    v_mfma_f32_16x16x32_bf16 v[44:47], a[108:111], v[184:187], v[44:47]
    v_cvt_pk_bf16_f32 v24, v24, v25
    v_exp_f32 v198, v198
    v_mfma_f32_16x16x32_bf16 v[48:51], a[112:115], v[184:187], v[48:51]
    v_cvt_pk_bf16_f32 v25, v26, v27
    v_mfma_f32_16x16x32_bf16 v[52:55], a[116:119], v[184:187], v[52:55]
    v_cvt_pk_bf16_f32 v194, v196, v197
    v_cvt_pk_bf16_f32 v26, v28, v29
    v_mfma_f32_16x16x32_bf16 v[56:59], a[120:123], v[184:187], v[56:59]
    v_cvt_pk_bf16_f32 v27, v30, v31
    v_exp_f32 v199, v199
    v_mfma_f32_16x16x32_bf16 v[60:63], a[124:127], v[184:187], v[60:63]
    buffer_store_dwordx4 v[24:27], v241, s[28:31], s51 offen offset:0 sc1
    v_mfma_f32_16x16x32_bf16 a[212:215], a[228:231], v[184:187], a[212:215]
    v_cvt_pk_bf16_f32 v195, v198, v199
    ds_write_b128 v251, v[24:27] offset:3072
    v_mfma_f32_16x16x32_bf16 v[168:171], a[0:3], a[176:179], v[212:215]
    v_exp_f32 v160, v160
    v_exp_f32 v161, v161
    v_mfma_f32_16x16x32_bf16 v[168:171], a[4:7], a[180:183], v[168:171]
    v_exp_f32 v162, v162
    v_mfma_f32_16x16x32_bf16 v[168:171], a[8:11], a[184:187], v[168:171]
    v_cvt_pk_bf16_f32 v160, v160, v161
    v_accvgpr_read_b32 v205, a212
    v_cmp_nlt_f32 vcc, v205, v246
    v_mfma_f32_16x16x32_bf16 v[168:171], a[12:15], a[188:191], v[168:171]
    v_exp_f32 v163, v163
    v_rcp_f32 v204, v205
    v_mfma_f32_16x16x32_bf16 v[172:175], a[16:19], a[176:179], v[212:215]
    s_or_b64 s[66:67], s[66:67], vcc
    v_pk_mul_f32 v[32:33], v[32:33], v[204:205] op_sel_hi:[1,0]
    v_mfma_f32_16x16x32_bf16 v[172:175], a[20:23], a[180:183], v[172:175]
    v_pk_mul_f32 v[34:35], v[34:35], v[204:205] op_sel_hi:[1,0]
    v_exp_f32 v164, v164
    v_mfma_f32_16x16x32_bf16 v[172:175], a[24:27], a[184:187], v[172:175]
    v_pk_mul_f32 v[36:37], v[36:37], v[204:205] op_sel_hi:[1,0]
    v_pk_mul_f32 v[38:39], v[38:39], v[204:205] op_sel_hi:[1,0]
    v_cvt_pk_bf16_f32 v32, v32, v33
    v_mfma_f32_16x16x32_bf16 v[172:175], a[28:31], a[188:191], v[172:175]
    v_cvt_pk_bf16_f32 v33, v34, v35
    v_cvt_pk_bf16_f32 v161, v162, v163
    v_cvt_pk_bf16_f32 v34, v36, v37
    v_mfma_f32_16x16x32_bf16 v[64:67], a[32:35], v[192:195], v[64:67]
    v_cvt_pk_bf16_f32 v35, v38, v39
    buffer_store_dwordx4 v[32:35], v241, s[28:31], s48 offen offset:1024 sc1
    v_exp_f32 v165, v165
    v_mfma_f32_16x16x32_bf16 v[68:71], a[36:39], v[192:195], v[68:71]
    ds_write_b128 v251, v[32:35] offset:4096
    v_pk_mul_f32 v[40:41], v[40:41], v[204:205] op_sel_hi:[1,0]
    v_mfma_f32_16x16x32_bf16 v[72:75], a[40:43], v[192:195], v[72:75]
    v_pk_mul_f32 v[42:43], v[42:43], v[204:205] op_sel_hi:[1,0]
    v_pk_mul_f32 v[44:45], v[44:45], v[204:205] op_sel_hi:[1,0]
    v_pk_mul_f32 v[46:47], v[46:47], v[204:205] op_sel_hi:[1,0]
    v_mfma_f32_16x16x32_bf16 v[76:79], a[44:47], v[192:195], v[76:79]
    v_exp_f32 v166, v166
    v_cvt_pk_bf16_f32 v40, v40, v41
    v_mfma_f32_16x16x32_bf16 v[80:83], a[48:51], v[192:195], v[80:83]
    v_cvt_pk_bf16_f32 v41, v42, v43
    v_cvt_pk_bf16_f32 v42, v44, v45
    v_cvt_pk_bf16_f32 v43, v46, v47
    v_mfma_f32_16x16x32_bf16 v[84:87], a[52:55], v[192:195], v[84:87]
    v_cvt_pk_bf16_f32 v162, v164, v165
    buffer_store_dwordx4 v[40:43], v241, s[28:31], s49 offen offset:1024 sc1
    ds_write_b128 v251, v[40:43] offset:5120
    v_mfma_f32_16x16x32_bf16 v[88:91], a[56:59], v[192:195], v[88:91]
    v_pk_mul_f32 v[48:49], v[48:49], v[204:205] op_sel_hi:[1,0]
    v_exp_f32 v167, v167
    v_mfma_f32_16x16x32_bf16 v[92:95], a[60:63], v[192:195], v[92:95]
    v_pk_mul_f32 v[50:51], v[50:51], v[204:205] op_sel_hi:[1,0]
    v_pk_mul_f32 v[52:53], v[52:53], v[204:205] op_sel_hi:[1,0]
    v_pk_mul_f32 v[54:55], v[54:55], v[204:205] op_sel_hi:[1,0]
    v_mfma_f32_16x16x32_bf16 a[216:219], a[228:231], v[192:195], a[216:219]
    v_cvt_pk_bf16_f32 v48, v48, v49
    v_cvt_pk_bf16_f32 v163, v166, v167
    v_cvt_pk_bf16_f32 v49, v50, v51
    v_mfma_f32_16x16x32_bf16 v[176:179], a[64:67], a[176:179], v[212:215]
    v_exp_f32 v168, v168
    v_mfma_f32_16x16x32_bf16 v[176:179], a[68:71], a[180:183], v[176:179]
    v_exp_f32 v169, v169
    v_mfma_f32_16x16x32_bf16 v[176:179], a[72:75], a[184:187], v[176:179]
    v_exp_f32 v170, v170
    v_mfma_f32_16x16x32_bf16 v[176:179], a[76:79], a[188:191], v[176:179]
    v_cvt_pk_bf16_f32 v168, v168, v169
    v_cvt_pk_bf16_f32 v50, v52, v53
    v_mfma_f32_16x16x32_bf16 v[180:183], a[80:83], a[176:179], v[212:215]
    v_exp_f32 v171, v171
    v_mfma_f32_16x16x32_bf16 v[180:183], a[84:87], a[180:183], v[180:183]
    v_cvt_pk_bf16_f32 v51, v54, v55
    buffer_store_dwordx4 v[48:51], v241, s[28:31], s50 offen offset:1024 sc1
    v_mfma_f32_16x16x32_bf16 v[180:183], a[88:91], a[184:187], v[180:183]
    v_exp_f32 v172, v172
    v_mfma_f32_16x16x32_bf16 v[180:183], a[92:95], a[188:191], v[180:183]
    ds_write_b128 v251, v[48:51] offset:6144
    v_pk_mul_f32 v[56:57], v[56:57], v[204:205] op_sel_hi:[1,0]
    v_mfma_f32_16x16x32_bf16 v[64:67], a[96:99], v[160:163], v[64:67]
    v_cvt_pk_bf16_f32 v169, v170, v171
    v_pk_mul_f32 v[58:59], v[58:59], v[204:205] op_sel_hi:[1,0]
    v_mfma_f32_16x16x32_bf16 v[68:71], a[100:103], v[160:163], v[68:71]
    v_exp_f32 v173, v173
    v_mfma_f32_16x16x32_bf16 v[72:75], a[104:107], v[160:163], v[72:75]
    v_pk_mul_f32 v[60:61], v[60:61], v[204:205] op_sel_hi:[1,0]
    v_pk_mul_f32 v[62:63], v[62:63], v[204:205] op_sel_hi:[1,0]
    v_mfma_f32_16x16x32_bf16 v[76:79], a[108:111], v[160:163], v[76:79]
    v_cvt_pk_bf16_f32 v56, v56, v57
    v_exp_f32 v174, v174
    v_mfma_f32_16x16x32_bf16 v[80:83], a[112:115], v[160:163], v[80:83]
    v_cvt_pk_bf16_f32 v57, v58, v59
    v_mfma_f32_16x16x32_bf16 v[84:87], a[116:119], v[160:163], v[84:87]
    v_cvt_pk_bf16_f32 v170, v172, v173
    v_cvt_pk_bf16_f32 v58, v60, v61
    v_mfma_f32_16x16x32_bf16 v[88:91], a[120:123], v[160:163], v[88:91]
    v_cvt_pk_bf16_f32 v59, v62, v63
    v_exp_f32 v175, v175
    v_mfma_f32_16x16x32_bf16 v[92:95], a[124:127], v[160:163], v[92:95]
    buffer_store_dwordx4 v[56:59], v241, s[28:31], s51 offen offset:1024 sc1
    v_mfma_f32_16x16x32_bf16 a[216:219], a[228:231], v[160:163], a[216:219]
    v_cvt_pk_bf16_f32 v171, v174, v175
    ds_write_b128 v251, v[56:59] offset:7168
    v_mfma_f32_16x16x32_bf16 v[184:187], a[0:3], a[192:195], v[216:219]
    v_exp_f32 v176, v176
    v_exp_f32 v177, v177
    v_mfma_f32_16x16x32_bf16 v[184:187], a[4:7], a[196:199], v[184:187]
    v_exp_f32 v178, v178
    v_mfma_f32_16x16x32_bf16 v[184:187], a[8:11], a[200:203], v[184:187]
    v_cvt_pk_bf16_f32 v176, v176, v177
    v_accvgpr_read_b32 v209, a216
    v_cmp_nlt_f32 vcc, v209, v246
    v_mfma_f32_16x16x32_bf16 v[184:187], a[12:15], a[204:207], v[184:187]
    v_exp_f32 v179, v179
    v_rcp_f32 v208, v209
    v_mfma_f32_16x16x32_bf16 v[188:191], a[16:19], a[192:195], v[216:219]
    s_or_b64 s[66:67], s[66:67], vcc
    v_pk_mul_f32 v[64:65], v[64:65], v[208:209] op_sel_hi:[1,0]
    v_mfma_f32_16x16x32_bf16 v[188:191], a[20:23], a[196:199], v[188:191]
    v_pk_mul_f32 v[66:67], v[66:67], v[208:209] op_sel_hi:[1,0]
    v_exp_f32 v180, v180
    v_mfma_f32_16x16x32_bf16 v[188:191], a[24:27], a[200:203], v[188:191]
    v_pk_mul_f32 v[68:69], v[68:69], v[208:209] op_sel_hi:[1,0]
    v_pk_mul_f32 v[70:71], v[70:71], v[208:209] op_sel_hi:[1,0]
    v_cvt_pk_bf16_f32 v64, v64, v65
    v_mfma_f32_16x16x32_bf16 v[188:191], a[28:31], a[204:207], v[188:191]
    v_cvt_pk_bf16_f32 v65, v66, v67
    v_cvt_pk_bf16_f32 v177, v178, v179
    v_cvt_pk_bf16_f32 v66, v68, v69
    v_mfma_f32_16x16x32_bf16 v[96:99], a[32:35], v[168:171], v[96:99]
    v_cvt_pk_bf16_f32 v67, v70, v71
    buffer_store_dwordx4 v[64:67], v241, s[28:31], s48 offen offset:2048 sc1
    v_exp_f32 v181, v181
    v_mfma_f32_16x16x32_bf16 v[100:103], a[36:39], v[168:171], v[100:103]
    ds_write_b128 v251, v[64:67] offset:8192
    v_pk_mul_f32 v[72:73], v[72:73], v[208:209] op_sel_hi:[1,0]
    v_mfma_f32_16x16x32_bf16 v[104:107], a[40:43], v[168:171], v[104:107]
    v_pk_mul_f32 v[74:75], v[74:75], v[208:209] op_sel_hi:[1,0]
    v_pk_mul_f32 v[76:77], v[76:77], v[208:209] op_sel_hi:[1,0]
    v_pk_mul_f32 v[78:79], v[78:79], v[208:209] op_sel_hi:[1,0]
    v_mfma_f32_16x16x32_bf16 v[108:111], a[44:47], v[168:171], v[108:111]
    v_exp_f32 v182, v182
    v_cvt_pk_bf16_f32 v72, v72, v73
    v_mfma_f32_16x16x32_bf16 v[112:115], a[48:51], v[168:171], v[112:115]
    v_cvt_pk_bf16_f32 v73, v74, v75
    v_cvt_pk_bf16_f32 v74, v76, v77
    v_cvt_pk_bf16_f32 v75, v78, v79
    v_mfma_f32_16x16x32_bf16 v[116:119], a[52:55], v[168:171], v[116:119]
    v_cvt_pk_bf16_f32 v178, v180, v181
    buffer_store_dwordx4 v[72:75], v241, s[28:31], s49 offen offset:2048 sc1
    ds_write_b128 v251, v[72:75] offset:9216
    v_mfma_f32_16x16x32_bf16 v[120:123], a[56:59], v[168:171], v[120:123]
    v_pk_mul_f32 v[80:81], v[80:81], v[208:209] op_sel_hi:[1,0]
    v_exp_f32 v183, v183
    v_mfma_f32_16x16x32_bf16 v[124:127], a[60:63], v[168:171], v[124:127]
    v_pk_mul_f32 v[82:83], v[82:83], v[208:209] op_sel_hi:[1,0]
    v_pk_mul_f32 v[84:85], v[84:85], v[208:209] op_sel_hi:[1,0]
    v_pk_mul_f32 v[86:87], v[86:87], v[208:209] op_sel_hi:[1,0]
    v_mfma_f32_16x16x32_bf16 a[220:223], a[228:231], v[168:171], a[220:223]
    v_cvt_pk_bf16_f32 v80, v80, v81
    v_cvt_pk_bf16_f32 v179, v182, v183
    v_cvt_pk_bf16_f32 v81, v82, v83
    v_mfma_f32_16x16x32_bf16 v[192:195], a[64:67], a[192:195], v[216:219]
    v_exp_f32 v184, v184
    v_mfma_f32_16x16x32_bf16 v[192:195], a[68:71], a[196:199], v[192:195]
    v_exp_f32 v185, v185
    v_mfma_f32_16x16x32_bf16 v[192:195], a[72:75], a[200:203], v[192:195]
    v_exp_f32 v186, v186
    v_mfma_f32_16x16x32_bf16 v[192:195], a[76:79], a[204:207], v[192:195]
    v_cvt_pk_bf16_f32 v184, v184, v185
    v_cvt_pk_bf16_f32 v82, v84, v85
    v_mfma_f32_16x16x32_bf16 v[196:199], a[80:83], a[192:195], v[216:219]
    v_exp_f32 v187, v187
    v_mfma_f32_16x16x32_bf16 v[196:199], a[84:87], a[196:199], v[196:199]
    v_cvt_pk_bf16_f32 v83, v86, v87
    buffer_store_dwordx4 v[80:83], v241, s[28:31], s50 offen offset:2048 sc1
    v_mfma_f32_16x16x32_bf16 v[196:199], a[88:91], a[200:203], v[196:199]
    v_exp_f32 v188, v188
    v_mfma_f32_16x16x32_bf16 v[196:199], a[92:95], a[204:207], v[196:199]
    ds_write_b128 v251, v[80:83] offset:10240
    v_pk_mul_f32 v[88:89], v[88:89], v[208:209] op_sel_hi:[1,0]
    v_mfma_f32_16x16x32_bf16 v[96:99], a[96:99], v[176:179], v[96:99]
    v_cvt_pk_bf16_f32 v185, v186, v187
    v_pk_mul_f32 v[90:91], v[90:91], v[208:209] op_sel_hi:[1,0]
    v_mfma_f32_16x16x32_bf16 v[100:103], a[100:103], v[176:179], v[100:103]
    v_exp_f32 v189, v189
    v_mfma_f32_16x16x32_bf16 v[104:107], a[104:107], v[176:179], v[104:107]
    v_pk_mul_f32 v[92:93], v[92:93], v[208:209] op_sel_hi:[1,0]
    v_pk_mul_f32 v[94:95], v[94:95], v[208:209] op_sel_hi:[1,0]
    v_mfma_f32_16x16x32_bf16 v[108:111], a[108:111], v[176:179], v[108:111]
    v_cvt_pk_bf16_f32 v88, v88, v89
    v_exp_f32 v190, v190
    v_mfma_f32_16x16x32_bf16 v[112:115], a[112:115], v[176:179], v[112:115]
    v_cvt_pk_bf16_f32 v89, v90, v91
    v_mfma_f32_16x16x32_bf16 v[116:119], a[116:119], v[176:179], v[116:119]
    v_cvt_pk_bf16_f32 v186, v188, v189
    v_cvt_pk_bf16_f32 v90, v92, v93
    v_mfma_f32_16x16x32_bf16 v[120:123], a[120:123], v[176:179], v[120:123]
    v_cvt_pk_bf16_f32 v91, v94, v95
    v_exp_f32 v191, v191
    v_mfma_f32_16x16x32_bf16 v[124:127], a[124:127], v[176:179], v[124:127]
    buffer_store_dwordx4 v[88:91], v241, s[28:31], s51 offen offset:2048 sc1
    v_mfma_f32_16x16x32_bf16 a[220:223], a[228:231], v[176:179], a[220:223]
    v_cvt_pk_bf16_f32 v187, v190, v191
    ds_write_b128 v251, v[88:91] offset:11264
    s_waitcnt vmcnt(12)
    s_barrier
    v_mfma_f32_16x16x32_bf16 v[128:131], a[32:35], v[184:187], v[128:131]
    v_exp_f32 v192, v192
    v_exp_f32 v193, v193
    v_exp_f32 v194, v194
    v_cvt_pk_bf16_f32 v192, v192, v193
    v_accvgpr_read_b32 v213, a220
    v_mfma_f32_16x16x32_bf16 v[132:135], a[36:39], v[184:187], v[132:135]
    v_cmp_nlt_f32 vcc, v213, v246
    ds_read_b64_tr_b16 a[0:1], v250 offset:0
    ds_read_b64_tr_b16 a[2:3], v250 offset:2560
    v_exp_f32 v195, v195
    v_rcp_f32 v212, v213
    s_or_b64 s[66:67], s[66:67], vcc
    v_mfma_f32_16x16x32_bf16 v[136:139], a[40:43], v[184:187], v[136:139]
    ds_read_b64_tr_b16 a[4:5], v250 offset:32
    ds_read_b64_tr_b16 a[6:7], v250 offset:2592
    v_pk_mul_f32 v[96:97], v[96:97], v[212:213] op_sel_hi:[1,0]
    v_pk_mul_f32 v[98:99], v[98:99], v[212:213] op_sel_hi:[1,0]
    v_exp_f32 v196, v196
    v_pk_mul_f32 v[100:101], v[100:101], v[212:213] op_sel_hi:[1,0]
    v_mfma_f32_16x16x32_bf16 v[140:143], a[44:47], v[184:187], v[140:143]
    ds_read_b64_tr_b16 a[8:9], v250 offset:64
    ds_read_b64_tr_b16 a[10:11], v250 offset:2624
    v_pk_mul_f32 v[102:103], v[102:103], v[212:213] op_sel_hi:[1,0]
    v_cvt_pk_bf16_f32 v96, v96, v97
    v_cvt_pk_bf16_f32 v97, v98, v99
    v_cvt_pk_bf16_f32 v193, v194, v195
    ds_read_b64_tr_b16 a[12:13], v250 offset:96
    ds_read_b64_tr_b16 a[14:15], v250 offset:2656
    v_cvt_pk_bf16_f32 v98, v100, v101
    v_mfma_f32_16x16x32_bf16 v[144:147], a[48:51], v[184:187], v[144:147]
    v_cvt_pk_bf16_f32 v99, v102, v103
    buffer_store_dwordx4 v[96:99], v241, s[28:31], s48 offen offset:3072 sc1
    ds_read_b64_tr_b16 a[16:17], v250 offset:128
    ds_read_b64_tr_b16 a[18:19], v250 offset:2688
    v_exp_f32 v197, v197
    ds_write_b128 v251, v[96:99] offset:12288
    v_mfma_f32_16x16x32_bf16 v[148:151], a[52:55], v[184:187], v[148:151]
    v_pk_mul_f32 v[104:105], v[104:105], v[212:213] op_sel_hi:[1,0]
    v_pk_mul_f32 v[106:107], v[106:107], v[212:213] op_sel_hi:[1,0]
    ds_read_b64_tr_b16 a[20:21], v250 offset:5120
    ds_read_b64_tr_b16 a[22:23], v250 offset:7680
    v_pk_mul_f32 v[108:109], v[108:109], v[212:213] op_sel_hi:[1,0]
    v_pk_mul_f32 v[110:111], v[110:111], v[212:213] op_sel_hi:[1,0]
    v_exp_f32 v198, v198
    v_mfma_f32_16x16x32_bf16 v[152:155], a[56:59], v[184:187], v[152:155]
    v_cvt_pk_bf16_f32 v104, v104, v105
    ds_read_b64_tr_b16 a[24:25], v250 offset:5152
    ds_read_b64_tr_b16 a[26:27], v250 offset:7712
    v_cvt_pk_bf16_f32 v105, v106, v107
    v_cvt_pk_bf16_f32 v106, v108, v109
    v_cvt_pk_bf16_f32 v107, v110, v111
    v_cvt_pk_bf16_f32 v194, v196, v197
    ds_read_b64_tr_b16 a[28:29], v250 offset:5184
    ds_read_b64_tr_b16 a[30:31], v250 offset:7744
    v_mfma_f32_16x16x32_bf16 v[156:159], a[60:63], v[184:187], v[156:159]
    buffer_store_dwordx4 v[104:107], v241, s[28:31], s49 offen offset:3072 sc1
    ds_write_b128 v251, v[104:107] offset:13312
    v_pk_mul_f32 v[112:113], v[112:113], v[212:213] op_sel_hi:[1,0]
    v_exp_f32 v199, v199
    ds_read_b64_tr_b16 a[64:65], v250 offset:5216
    ds_read_b64_tr_b16 a[66:67], v250 offset:7776
    v_mfma_f32_16x16x32_bf16 a[224:227], a[228:231], v[184:187], a[224:227]
    v_pk_mul_f32 v[114:115], v[114:115], v[212:213] op_sel_hi:[1,0]
    v_pk_mul_f32 v[116:117], v[116:117], v[212:213] op_sel_hi:[1,0]
    v_pk_mul_f32 v[118:119], v[118:119], v[212:213] op_sel_hi:[1,0]
    ds_read_b64_tr_b16 a[68:69], v250 offset:5248
    ds_read_b64_tr_b16 a[70:71], v250 offset:7808
    v_cvt_pk_bf16_f32 v112, v112, v113
    v_cvt_pk_bf16_f32 v195, v198, v199
    v_cvt_pk_bf16_f32 v113, v114, v115
    s_nop 0
    v_mfma_f32_16x16x32_bf16 v[128:131], a[96:99], v[192:195], v[128:131]
    v_cvt_pk_bf16_f32 v114, v116, v117
    ds_read_b64_tr_b16 a[72:73], v250 offset:10240
    ds_read_b64_tr_b16 a[74:75], v250 offset:12800
    v_cvt_pk_bf16_f32 v115, v118, v119
    v_mfma_f32_16x16x32_bf16 v[132:135], a[100:103], v[192:195], v[132:135]
    ds_read_b64_tr_b16 a[76:77], v250 offset:10272
    ds_read_b64_tr_b16 a[78:79], v250 offset:12832
    buffer_store_dwordx4 v[112:115], v241, s[28:31], s50 offen offset:3072 sc1
    ds_write_b128 v251, v[112:115] offset:14336
    v_mfma_f32_16x16x32_bf16 v[136:139], a[104:107], v[192:195], v[136:139]
    ds_read_b64_tr_b16 a[80:81], v250 offset:10304
    ds_read_b64_tr_b16 a[82:83], v250 offset:12864
    v_pk_mul_f32 v[120:121], v[120:121], v[212:213] op_sel_hi:[1,0]
    v_mfma_f32_16x16x32_bf16 v[140:143], a[108:111], v[192:195], v[140:143]
    ds_read_b64_tr_b16 a[84:85], v250 offset:10336
    ds_read_b64_tr_b16 a[86:87], v250 offset:12896
    v_pk_mul_f32 v[122:123], v[122:123], v[212:213] op_sel_hi:[1,0]
    ds_read_b64_tr_b16 a[88:89], v250 offset:10368
    ds_read_b64_tr_b16 a[90:91], v250 offset:12928
    v_mfma_f32_16x16x32_bf16 v[144:147], a[112:115], v[192:195], v[144:147]
    v_pk_mul_f32 v[124:125], v[124:125], v[212:213] op_sel_hi:[1,0]
    v_pk_mul_f32 v[126:127], v[126:127], v[212:213] op_sel_hi:[1,0]
    v_mfma_f32_16x16x32_bf16 v[148:151], a[116:119], v[192:195], v[148:151]
    ds_read_b64_tr_b16 a[92:93], v249 offset:0
    ds_read_b64_tr_b16 a[94:95], v249 offset:2560
    v_cvt_pk_bf16_f32 v120, v120, v121
    ds_read_b64_tr_b16 a[232:233], v249 offset:32
    ds_read_b64_tr_b16 a[234:235], v249 offset:2592
    v_mfma_f32_16x16x32_bf16 v[152:155], a[120:123], v[192:195], v[152:155]
    v_cvt_pk_bf16_f32 v121, v122, v123
    v_cvt_pk_bf16_f32 v122, v124, v125
    ds_read_b64_tr_b16 a[236:237], v249 offset:64
    ds_read_b64_tr_b16 a[238:239], v249 offset:2624
    v_mfma_f32_16x16x32_bf16 v[156:159], a[124:127], v[192:195], v[156:159]
    v_cvt_pk_bf16_f32 v123, v126, v127
    ds_read_b64_tr_b16 a[240:241], v249 offset:96
    ds_read_b64_tr_b16 a[242:243], v249 offset:2656
    v_mfma_f32_16x16x32_bf16 a[224:227], a[228:231], v[192:195], a[224:227]
    buffer_store_dwordx4 v[120:123], v241, s[28:31], s51 offen offset:3072 sc1
    ds_read_b64_tr_b16 a[244:245], v249 offset:128
    ds_read_b64_tr_b16 a[246:247], v249 offset:2688
    ds_write_b128 v251, v[120:123] offset:15360
    s_nop 3
    v_accvgpr_read_b32 v217, a224
    v_cmp_nlt_f32 vcc, v217, v246
    v_rcp_f32 v216, v217
    s_or_b64 s[66:67], s[66:67], vcc
    v_pk_mul_f32 v[128:129], v[128:129], v[216:217] op_sel_hi:[1,0]
    v_pk_mul_f32 v[130:131], v[130:131], v[216:217] op_sel_hi:[1,0]
    v_pk_mul_f32 v[132:133], v[132:133], v[216:217] op_sel_hi:[1,0]
    v_pk_mul_f32 v[134:135], v[134:135], v[216:217] op_sel_hi:[1,0]
    v_cvt_pk_bf16_f32 v128, v128, v129
    v_cvt_pk_bf16_f32 v129, v130, v131
    v_cvt_pk_bf16_f32 v130, v132, v133
    v_cvt_pk_bf16_f32 v131, v134, v135
    buffer_store_dwordx4 v[128:131], v242, s[28:31], s48 offen offset:0 sc1
    s_waitcnt lgkmcnt(0)
    s_barrier
    v_mfma_f32_16x16x32_bf16 v[4:7], a[0:3], v[0:3], 0
    ds_write_b128 v252, v[128:131] offset:0
    v_pk_mul_f32 v[136:137], v[136:137], v[216:217] op_sel_hi:[1,0]
    v_mfma_f32_16x16x32_bf16 v[4:7], a[20:23], v[8:11], v[4:7]
    v_pk_mul_f32 v[138:139], v[138:139], v[216:217] op_sel_hi:[1,0]
    v_mfma_f32_16x16x32_bf16 v[4:7], a[72:75], v[16:19], v[4:7]
    v_pk_mul_f32 v[140:141], v[140:141], v[216:217] op_sel_hi:[1,0]
    v_pk_mul_f32 v[142:143], v[142:143], v[216:217] op_sel_hi:[1,0]
    v_mfma_f32_16x16x32_bf16 v[4:7], a[92:95], v[24:27], v[4:7]
    v_cvt_pk_bf16_f32 v136, v136, v137
    v_cvt_pk_bf16_f32 v137, v138, v139
    v_mfma_f32_16x16x32_bf16 v[12:15], a[4:7], v[0:3], 0
    v_cvt_pk_bf16_f32 v138, v140, v141
    v_cvt_pk_bf16_f32 v139, v142, v143
    v_mfma_f32_16x16x32_bf16 v[12:15], a[24:27], v[8:11], v[12:15]
    buffer_store_dwordx4 v[136:139], v242, s[28:31], s49 offen offset:0 sc1
    v_mfma_f32_16x16x32_bf16 v[12:15], a[76:79], v[16:19], v[12:15]
    ds_write_b128 v252, v[136:139] offset:1024
    v_pk_mul_f32 v[144:145], v[144:145], v[216:217] op_sel_hi:[1,0]
    v_mfma_f32_16x16x32_bf16 v[12:15], a[232:235], v[24:27], v[12:15]
    v_pk_mul_f32 v[146:147], v[146:147], v[216:217] op_sel_hi:[1,0]
    v_pk_mul_f32 v[148:149], v[148:149], v[216:217] op_sel_hi:[1,0]
    v_mfma_f32_16x16x32_bf16 v[20:23], a[8:11], v[0:3], 0
    v_pk_mul_f32 v[150:151], v[150:151], v[216:217] op_sel_hi:[1,0]
    v_mfma_f32_16x16x32_bf16 v[20:23], a[28:31], v[8:11], v[20:23]
    v_cvt_pk_bf16_f32 v144, v144, v145
    v_cvt_pk_bf16_f32 v145, v146, v147
    v_mfma_f32_16x16x32_bf16 v[20:23], a[80:83], v[16:19], v[20:23]
    v_cvt_pk_bf16_f32 v146, v148, v149
    v_cvt_pk_bf16_f32 v147, v150, v151
    v_mfma_f32_16x16x32_bf16 v[20:23], a[236:239], v[24:27], v[20:23]
    buffer_store_dwordx4 v[144:147], v242, s[28:31], s50 offen offset:0 sc1
    ds_write_b128 v252, v[144:147] offset:2048
    v_mfma_f32_16x16x32_bf16 v[28:31], a[12:15], v[0:3], 0
    v_pk_mul_f32 v[152:153], v[152:153], v[216:217] op_sel_hi:[1,0]
    v_mfma_f32_16x16x32_bf16 v[28:31], a[64:67], v[8:11], v[28:31]
    v_pk_mul_f32 v[154:155], v[154:155], v[216:217] op_sel_hi:[1,0]
    v_pk_mul_f32 v[156:157], v[156:157], v[216:217] op_sel_hi:[1,0]
    v_mfma_f32_16x16x32_bf16 v[28:31], a[84:87], v[16:19], v[28:31]
    v_pk_mul_f32 v[158:159], v[158:159], v[216:217] op_sel_hi:[1,0]
    v_cvt_pk_bf16_f32 v152, v152, v153
    v_mfma_f32_16x16x32_bf16 v[28:31], a[240:243], v[24:27], v[28:31]
    v_cvt_pk_bf16_f32 v153, v154, v155
    v_mfma_f32_16x16x32_bf16 v[200:203], a[16:19], v[0:3], 0
    v_cvt_pk_bf16_f32 v154, v156, v157
    v_cvt_pk_bf16_f32 v155, v158, v159
    v_mfma_f32_16x16x32_bf16 v[200:203], a[68:71], v[8:11], v[200:203]
    buffer_store_dwordx4 v[152:155], v242, s[28:31], s51 offen offset:0 sc1
    ds_write_b128 v252, v[152:155] offset:3072
    v_mfma_f32_16x16x32_bf16 v[200:203], a[88:91], v[16:19], v[200:203]
    v_mfma_f32_16x16x32_bf16 v[200:203], a[244:247], v[24:27], v[200:203]
    s_cmp_lg_u64 s[66:67], 0
    s_cselect_b32 s55, 1, 0
    s_lshl_b32 s56, s3, 2
    s_add_u32 s56, s56, 147456
    v_mfma_f32_16x16x32_bf16 v[36:39], a[0:3], v[32:35], 0
    v_mov_b32 v246, s55
    v_mfma_f32_16x16x32_bf16 v[36:39], a[20:23], v[40:43], v[36:39]
    v_mov_b32 v245, s56
    ds_write_b32 v245, v246
    v_mfma_f32_16x16x32_bf16 v[36:39], a[72:75], v[48:51], v[36:39]
    v_mov_b32 v245, 147456
    v_mfma_f32_16x16x32_bf16 v[36:39], a[92:95], v[56:59], v[36:39]
    v_xor_b32 v252, 0x2000, v252
    v_xor_b32 v247, 0x10000, v251
    s_waitcnt lgkmcnt(0)
    s_barrier
    v_mfma_f32_16x16x32_bf16 v[44:47], a[4:7], v[32:35], 0
    ds_read_b128 v[160:163], v245
    ds_read_b128 a[32:35], v247 offset:0
    v_mfma_f32_16x16x32_bf16 v[44:47], a[24:27], v[40:43], v[44:47]
    ds_read_b128 a[36:39], v247 offset:1024
    v_mfma_f32_16x16x32_bf16 v[44:47], a[76:79], v[48:51], v[44:47]
    ds_read_b128 a[40:43], v247 offset:2048
    ds_read_b128 a[44:47], v247 offset:3072
    v_mfma_f32_16x16x32_bf16 v[44:47], a[232:235], v[56:59], v[44:47]
    ds_read_b128 a[48:51], v247 offset:4096
    v_mfma_f32_16x16x32_bf16 v[52:55], a[8:11], v[32:35], 0
    ds_read_b128 a[52:55], v247 offset:5120
    ds_read_b128 a[56:59], v247 offset:6144
    v_mfma_f32_16x16x32_bf16 v[52:55], a[28:31], v[40:43], v[52:55]
    ds_read_b128 a[60:63], v247 offset:7168
    s_waitcnt lgkmcnt(8)
    v_or_b32 v245, v160, v161
    v_or3_b32 v245, v245, v162, v163
    v_mfma_f32_16x16x32_bf16 v[52:55], a[80:83], v[48:51], v[52:55]
    v_readfirstlane_b32 s55, v245
    v_mfma_f32_16x16x32_bf16 v[52:55], a[236:239], v[56:59], v[52:55]
    s_nop 2
    s_cmp_eq_u32 s55, 0
    s_cbranch_scc1 K1_OK
    s_cmp_eq_u32 s62, 0
    s_cbranch_scc1 K1_FALL
K1_OK:
    v_mfma_f32_16x16x32_bf16 v[60:63], a[12:15], v[32:35], 0
    s_load_dwordx2 s[56:57], s[0:1], 40
    v_and_b32 v230, 3, v255
    v_mfma_f32_16x16x32_bf16 v[60:63], a[64:67], v[40:43], v[60:63]
    ds_read_b64_tr_b16 a[128:129], v249 offset:5120
    ds_read_b64_tr_b16 a[130:131], v249 offset:7680
    v_lshlrev_b32 v230, 3, v230
    v_mfma_f32_16x16x32_bf16 v[60:63], a[84:87], v[48:51], v[60:63]
    ds_read_b64_tr_b16 a[148:149], v249 offset:10240
    ds_read_b64_tr_b16 a[150:151], v249 offset:12800
    v_mfma_f32_16x16x32_bf16 v[60:63], a[240:243], v[56:59], v[60:63]
    s_mul_i32 s53, s4, 5120
    v_add_u32 v225, s53, v243
    v_mfma_f32_16x16x32_bf16 v[204:207], a[16:19], v[32:35], 0
    ds_read_b64_tr_b16 a[168:169], v249 offset:15360
    ds_read_b64_tr_b16 a[170:171], v249 offset:17920
    v_mfma_f32_16x16x32_bf16 v[204:207], a[68:71], v[40:43], v[204:207]
    ds_read_b64_tr_b16 a[188:189], v249 offset:20480
    ds_read_b64_tr_b16 a[190:191], v249 offset:23040
    v_add_u32 v226, 81920, v225
    v_mfma_f32_16x16x32_bf16 v[204:207], a[88:91], v[48:51], v[204:207]
    ds_read_b64_tr_b16 a[132:133], v249 offset:5152
    ds_read_b64_tr_b16 a[134:135], v249 offset:7712
    v_mfma_f32_16x16x32_bf16 v[204:207], a[244:247], v[56:59], v[204:207]
    s_mul_i32 s53, s5, 5120
    s_add_u32 s53, s53, 20480
    v_add_u32 v227, s53, v241
    v_mfma_f32_16x16x32_bf16 v[68:71], a[0:3], v[64:67], 0
    ds_read_b64_tr_b16 a[152:153], v249 offset:10272
    ds_read_b64_tr_b16 a[154:155], v249 offset:12832
    v_mfma_f32_16x16x32_bf16 v[68:71], a[20:23], v[72:75], v[68:71]
    ds_read_b64_tr_b16 a[172:173], v249 offset:15392
    ds_read_b64_tr_b16 a[174:175], v249 offset:17952
    v_add_u32 v228, 81920, v227
    v_mfma_f32_16x16x32_bf16 v[68:71], a[72:75], v[80:83], v[68:71]
    ds_read_b64_tr_b16 a[192:193], v249 offset:20512
    ds_read_b64_tr_b16 a[194:195], v249 offset:23072
    v_mfma_f32_16x16x32_bf16 v[68:71], a[92:95], v[88:91], v[68:71]
    ds_read_b64_tr_b16 a[136:137], v249 offset:5184
    ds_read_b64_tr_b16 a[138:139], v249 offset:7744
    v_mfma_f32_16x16x32_bf16 v[76:79], a[4:7], v[64:67], 0
    s_lshl_b32 s53, s5, 1
    s_add_u32 s53, s53, s4
    s_mul_i32 s64, s53, 5120
    v_mfma_f32_16x16x32_bf16 v[76:79], a[24:27], v[72:75], v[76:79]
    ds_read_b64_tr_b16 a[156:157], v249 offset:10304
    ds_read_b64_tr_b16 a[158:159], v249 offset:12864
    v_mfma_f32_16x16x32_bf16 v[76:79], a[76:79], v[80:83], v[76:79]
    ds_read_b64_tr_b16 a[176:177], v249 offset:15424
    ds_read_b64_tr_b16 a[178:179], v249 offset:17984
    v_mfma_f32_16x16x32_bf16 v[76:79], a[232:235], v[88:91], v[76:79]
    s_mul_i32 s65, s3, 5120
    s_add_u32 s65, s65, 20480
    v_mfma_f32_16x16x32_bf16 v[84:87], a[8:11], v[64:67], 0
    ds_read_b64_tr_b16 a[196:197], v249 offset:20544
    ds_read_b64_tr_b16 a[198:199], v249 offset:23104
    ds_read_b64_tr_b16 a[140:141], v249 offset:5216
    ds_read_b64_tr_b16 a[142:143], v249 offset:7776
    v_mfma_f32_16x16x32_bf16 v[84:87], a[28:31], v[72:75], v[84:87]
    v_mfma_f32_16x16x32_bf16 v[84:87], a[80:83], v[80:83], v[84:87]
    s_cmp_le_u32 s42, 0
    s_cselect_b32 s53, 1, 0
    s_mul_i32 s59, s53, 40960
    s_add_u32 s36, s44, s59
    v_mfma_f32_16x16x32_bf16 v[84:87], a[236:239], v[88:91], v[84:87]
    ds_read_b64_tr_b16 a[160:161], v249 offset:10336
    ds_read_b64_tr_b16 a[162:163], v249 offset:12896
    v_mfma_f32_16x16x32_bf16 v[92:95], a[12:15], v[64:67], 0
    ds_read_b64_tr_b16 a[180:181], v249 offset:15456
    ds_read_b64_tr_b16 a[182:183], v249 offset:18016
    v_mfma_f32_16x16x32_bf16 v[92:95], a[64:67], v[72:75], v[92:95]
    s_mul_i32 s59, s53, 327680
    s_add_u32 s39, s45, s59
    v_mfma_f32_16x16x32_bf16 v[92:95], a[84:87], v[80:83], v[92:95]
    ds_read_b64_tr_b16 a[200:201], v249 offset:20576
    ds_read_b64_tr_b16 a[202:203], v249 offset:23136
    ds_read_b64_tr_b16 a[144:145], v249 offset:5248
    ds_read_b64_tr_b16 a[146:147], v249 offset:7808
    v_mfma_f32_16x16x32_bf16 v[92:95], a[240:243], v[88:91], v[92:95]
    ds_read_b64_tr_b16 a[164:165], v249 offset:10368
    ds_read_b64_tr_b16 a[166:167], v249 offset:12928
    v_mfma_f32_16x16x32_bf16 v[208:211], a[16:19], v[64:67], 0
    s_cmp_le_u32 s42, 1
    s_cselect_b32 s53, 2, 1
    s_mul_i32 s59, s53, 40960
    s_add_u32 s37, s44, s59
    v_mfma_f32_16x16x32_bf16 v[208:211], a[68:71], v[72:75], v[208:211]
    v_mfma_f32_16x16x32_bf16 v[208:211], a[88:91], v[80:83], v[208:211]
    ds_read_b64_tr_b16 a[184:185], v249 offset:15488
    ds_read_b64_tr_b16 a[186:187], v249 offset:18048
    v_mfma_f32_16x16x32_bf16 v[208:211], a[244:247], v[88:91], v[208:211]
    ds_read_b64_tr_b16 a[204:205], v249 offset:20608
    ds_read_b64_tr_b16 a[206:207], v249 offset:23168
    ds_read_b128 a[96:99], v247 offset:8192
    v_mfma_f32_16x16x32_bf16 v[100:103], a[0:3], v[96:99], 0
    s_mul_i32 s59, s53, 327680
    s_add_u32 s40, s45, s59
    v_mfma_f32_16x16x32_bf16 v[100:103], a[20:23], v[104:107], v[100:103]
    ds_read_b128 a[100:103], v247 offset:9216
    ds_read_b128 a[104:107], v247 offset:10240
    ds_read_b128 a[108:111], v247 offset:11264
    v_mfma_f32_16x16x32_bf16 v[100:103], a[72:75], v[112:115], v[100:103]
    ds_read_b128 a[112:115], v247 offset:12288
    ds_read_b128 a[116:119], v247 offset:13312
    v_mfma_f32_16x16x32_bf16 v[100:103], a[92:95], v[120:123], v[100:103]
    s_cmp_le_u32 s42, 2
    s_cselect_b32 s53, 3, 2
    s_mul_i32 s59, s53, 40960
    s_add_u32 s38, s44, s59
    v_mfma_f32_16x16x32_bf16 v[108:111], a[4:7], v[96:99], 0
    ds_read_b128 a[120:123], v247 offset:14336
    v_mfma_f32_16x16x32_bf16 v[108:111], a[24:27], v[104:107], v[108:111]
    ds_read_b128 a[124:127], v247 offset:15360
    ds_read_b128 a[208:211], v252 offset:0
    v_mfma_f32_16x16x32_bf16 v[108:111], a[76:79], v[112:115], v[108:111]
    ds_read_b128 a[212:215], v252 offset:1024
    s_mul_i32 s59, s53, 327680
    s_add_u32 s41, s45, s59
    v_mfma_f32_16x16x32_bf16 v[108:111], a[232:235], v[120:123], v[108:111]
    ds_read_b128 a[216:219], v252 offset:2048
    ds_read_b128 a[220:223], v252 offset:3072
    v_mfma_f32_16x16x32_bf16 v[116:119], a[8:11], v[96:99], 0
    v_mfma_f32_16x16x32_bf16 v[116:119], a[28:31], v[104:107], v[116:119]
    v_mfma_f32_16x16x32_bf16 v[116:119], a[80:83], v[112:115], v[116:119]
    v_mfma_f32_16x16x32_bf16 v[116:119], a[236:239], v[120:123], v[116:119]
    s_waitcnt vmcnt(0) lgkmcnt(0)
    s_barrier
    s_cmp_lg_u32 s3, 0
    s_cbranch_scc1 K1_NOPUB
    v_mov_b32 v246, s80
    v_mov_b32 v247, s81
    s_mov_b64 exec, 1
    buffer_store_dwordx2 v[246:247], v254, s[28:31], s46 offen sc1
    s_mov_b64 exec, -1
K1_NOPUB:
    v_mfma_f32_16x16x32_bf16 v[124:127], a[12:15], v[96:99], 0
    v_mfma_f32_16x16x32_bf16 v[124:127], a[64:67], v[104:107], v[124:127]
    s_add_u32 m0, s64, 0
    s_add_u32 s54, s39, 0
    buffer_load_dwordx4 v220, s[32:35], s54 offen offset:0 lds
    v_mfma_f32_16x16x32_bf16 v[124:127], a[84:87], v[112:115], v[124:127]
    v_mfma_f32_16x16x32_bf16 v[124:127], a[240:243], v[120:123], v[124:127]
    buffer_load_dwordx4 v221, s[32:35], s54 offen offset:1024 lds
    v_mfma_f32_16x16x32_bf16 v[212:215], a[16:19], v[96:99], 0
    buffer_load_dwordx4 v222, s[32:35], s54 offen offset:2048 lds
    v_mfma_f32_16x16x32_bf16 v[212:215], a[68:71], v[104:107], v[212:215]
    buffer_load_dwordx4 v223, s[32:35], s54 offen offset:3072 lds
    v_mfma_f32_16x16x32_bf16 v[212:215], a[88:91], v[112:115], v[212:215]
    v_mfma_f32_16x16x32_bf16 v[212:215], a[244:247], v[120:123], v[212:215]
    s_add_u32 m0, s64, 4096
    s_nop 0
    buffer_load_dwordx4 v224, s[32:35], s54 offen offset:0 lds
    v_mfma_f32_16x16x32_bf16 v[132:135], a[0:3], v[128:131], 0
    v_mfma_f32_16x16x32_bf16 v[132:135], a[20:23], v[136:139], v[132:135]
    v_mfma_f32_16x16x32_bf16 v[132:135], a[72:75], v[144:147], v[132:135]
    s_add_u32 m0, s64, 40960
    s_add_u32 s54, s39, 81920
    buffer_load_dwordx4 v220, s[32:35], s54 offen offset:0 lds
    v_mfma_f32_16x16x32_bf16 v[132:135], a[92:95], v[152:155], v[132:135]
    v_mfma_f32_16x16x32_bf16 v[140:143], a[4:7], v[128:131], 0
    buffer_load_dwordx4 v221, s[32:35], s54 offen offset:1024 lds
    v_mfma_f32_16x16x32_bf16 v[140:143], a[24:27], v[136:139], v[140:143]
    buffer_load_dwordx4 v222, s[32:35], s54 offen offset:2048 lds
    v_mfma_f32_16x16x32_bf16 v[140:143], a[76:79], v[144:147], v[140:143]
    buffer_load_dwordx4 v223, s[32:35], s54 offen offset:3072 lds
    v_mfma_f32_16x16x32_bf16 v[140:143], a[232:235], v[152:155], v[140:143]
    v_mfma_f32_16x16x32_bf16 v[148:151], a[8:11], v[128:131], 0
    s_add_u32 m0, s64, 45056
    s_nop 0
    buffer_load_dwordx4 v224, s[32:35], s54 offen offset:0 lds
    v_mfma_f32_16x16x32_bf16 v[148:151], a[28:31], v[136:139], v[148:151]
    v_mfma_f32_16x16x32_bf16 v[148:151], a[80:83], v[144:147], v[148:151]
    v_mfma_f32_16x16x32_bf16 v[148:151], a[236:239], v[152:155], v[148:151]
    s_add_u32 m0, s64, 81920
    s_add_u32 s54, s39, 163840
    buffer_load_dwordx4 v220, s[32:35], s54 offen offset:0 lds
    v_mfma_f32_16x16x32_bf16 v[156:159], a[12:15], v[128:131], 0
    v_mfma_f32_16x16x32_bf16 v[156:159], a[64:67], v[136:139], v[156:159]
    buffer_load_dwordx4 v221, s[32:35], s54 offen offset:1024 lds
    v_mfma_f32_16x16x32_bf16 v[156:159], a[84:87], v[144:147], v[156:159]
    buffer_load_dwordx4 v222, s[32:35], s54 offen offset:2048 lds
    v_mfma_f32_16x16x32_bf16 v[156:159], a[240:243], v[152:155], v[156:159]
    buffer_load_dwordx4 v223, s[32:35], s54 offen offset:3072 lds
    v_mfma_f32_16x16x32_bf16 v[216:219], a[16:19], v[128:131], 0
    v_mfma_f32_16x16x32_bf16 v[216:219], a[68:71], v[136:139], v[216:219]
    s_add_u32 m0, s64, 86016
    s_nop 0
    buffer_load_dwordx4 v224, s[32:35], s54 offen offset:0 lds
    v_mfma_f32_16x16x32_bf16 v[216:219], a[88:91], v[144:147], v[216:219]
    v_mfma_f32_16x16x32_bf16 v[216:219], a[244:247], v[152:155], v[216:219]
    v_mfma_f32_16x16x32_bf16 v[4:7], a[128:131], a[32:35], v[4:7]
    s_add_u32 m0, s64, 122880
    s_add_u32 s54, s39, 245760
    buffer_load_dwordx4 v220, s[32:35], s54 offen offset:0 lds
    v_mfma_f32_16x16x32_bf16 v[4:7], a[148:151], a[36:39], v[4:7]
    v_mfma_f32_16x16x32_bf16 v[4:7], a[168:171], a[40:43], v[4:7]
    buffer_load_dwordx4 v221, s[32:35], s54 offen offset:1024 lds
    v_mfma_f32_16x16x32_bf16 v[4:7], a[188:191], a[44:47], v[4:7]
    buffer_load_dwordx4 v222, s[32:35], s54 offen offset:2048 lds
    v_mfma_f32_16x16x32_bf16 v[36:39], a[128:131], a[48:51], v[36:39]
    buffer_load_dwordx4 v223, s[32:35], s54 offen offset:3072 lds
    v_mfma_f32_16x16x32_bf16 v[36:39], a[148:151], a[52:55], v[36:39]
    v_mfma_f32_16x16x32_bf16 v[36:39], a[168:171], a[56:59], v[36:39]
    s_add_u32 m0, s64, 126976
    s_nop 0
    buffer_load_dwordx4 v224, s[32:35], s54 offen offset:0 lds
    v_mfma_f32_16x16x32_bf16 v[36:39], a[188:191], a[60:63], v[36:39]
    v_mfma_f32_16x16x32_bf16 v[68:71], a[128:131], a[96:99], v[68:71]
    v_mfma_f32_16x16x32_bf16 v[68:71], a[148:151], a[100:103], v[68:71]
    s_mov_b32 s12, s56
    s_and_b32 s13, s57, 0xffff
    s_mov_b32 s14, 3276800
    s_mov_b32 s15, 0x20000
    v_mfma_f32_16x16x32_bf16 v[68:71], a[168:171], a[104:107], v[68:71]
    v_mfma_f32_16x16x32_bf16 v[68:71], a[188:191], a[108:111], v[68:71]
    buffer_load_dwordx2 v[160:161], v230, s[28:31], s47 offen sc1
    v_mfma_f32_16x16x32_bf16 v[100:103], a[128:131], a[112:115], v[100:103]
    v_mfma_f32_16x16x32_bf16 v[100:103], a[148:151], a[116:119], v[100:103]
    v_mfma_f32_16x16x32_bf16 v[100:103], a[168:171], a[120:123], v[100:103]
    v_mfma_f32_16x16x32_bf16 v[100:103], a[188:191], a[124:127], v[100:103]
    v_mfma_f32_16x16x32_bf16 v[132:135], a[128:131], a[208:211], v[132:135]
    v_mfma_f32_16x16x32_bf16 v[132:135], a[148:151], a[212:215], v[132:135]
    v_mfma_f32_16x16x32_bf16 v[132:135], a[168:171], a[216:219], v[132:135]
    v_mfma_f32_16x16x32_bf16 v[132:135], a[188:191], a[220:223], v[132:135]
    v_mfma_f32_16x16x32_bf16 v[12:15], a[132:135], a[32:35], v[12:15]
    v_mfma_f32_16x16x32_bf16 v[12:15], a[152:155], a[36:39], v[12:15]
    v_mfma_f32_16x16x32_bf16 v[12:15], a[172:175], a[40:43], v[12:15]
    v_mfma_f32_16x16x32_bf16 v[12:15], a[192:195], a[44:47], v[12:15]
    v_mfma_f32_16x16x32_bf16 v[44:47], a[132:135], a[48:51], v[44:47]
    v_mfma_f32_16x16x32_bf16 v[44:47], a[152:155], a[52:55], v[44:47]
    v_mfma_f32_16x16x32_bf16 v[44:47], a[172:175], a[56:59], v[44:47]
    v_mfma_f32_16x16x32_bf16 v[44:47], a[192:195], a[60:63], v[44:47]
    v_mfma_f32_16x16x32_bf16 v[76:79], a[132:135], a[96:99], v[76:79]
    v_mfma_f32_16x16x32_bf16 v[76:79], a[152:155], a[100:103], v[76:79]
    v_mfma_f32_16x16x32_bf16 v[76:79], a[172:175], a[104:107], v[76:79]
    v_mfma_f32_16x16x32_bf16 v[76:79], a[192:195], a[108:111], v[76:79]
    v_mfma_f32_16x16x32_bf16 v[108:111], a[132:135], a[112:115], v[108:111]
    v_mfma_f32_16x16x32_bf16 v[108:111], a[152:155], a[116:119], v[108:111]
    v_mfma_f32_16x16x32_bf16 v[108:111], a[172:175], a[120:123], v[108:111]
    v_mfma_f32_16x16x32_bf16 v[108:111], a[192:195], a[124:127], v[108:111]
    v_mfma_f32_16x16x32_bf16 v[140:143], a[132:135], a[208:211], v[140:143]
    v_mfma_f32_16x16x32_bf16 v[140:143], a[152:155], a[212:215], v[140:143]
    v_mfma_f32_16x16x32_bf16 v[140:143], a[172:175], a[216:219], v[140:143]
    v_mfma_f32_16x16x32_bf16 v[140:143], a[192:195], a[220:223], v[140:143]
    v_mfma_f32_16x16x32_bf16 v[20:23], a[136:139], a[32:35], v[20:23]
    v_mfma_f32_16x16x32_bf16 v[20:23], a[156:159], a[36:39], v[20:23]
    v_mfma_f32_16x16x32_bf16 v[20:23], a[176:179], a[40:43], v[20:23]
    v_mfma_f32_16x16x32_bf16 v[20:23], a[196:199], a[44:47], v[20:23]
    v_mfma_f32_16x16x32_bf16 v[52:55], a[136:139], a[48:51], v[52:55]
    v_mfma_f32_16x16x32_bf16 v[52:55], a[156:159], a[52:55], v[52:55]
    v_mfma_f32_16x16x32_bf16 v[52:55], a[176:179], a[56:59], v[52:55]
    v_mfma_f32_16x16x32_bf16 v[52:55], a[196:199], a[60:63], v[52:55]
    v_mfma_f32_16x16x32_bf16 v[84:87], a[136:139], a[96:99], v[84:87]
    v_mfma_f32_16x16x32_bf16 v[84:87], a[156:159], a[100:103], v[84:87]
    v_mfma_f32_16x16x32_bf16 v[84:87], a[176:179], a[104:107], v[84:87]
    v_mfma_f32_16x16x32_bf16 v[84:87], a[196:199], a[108:111], v[84:87]
    s_mov_b32 s63, 0
    s_branch K1_POLL_CHK
K1_POLL:
    buffer_load_dwordx2 v[160:161], v230, s[28:31], s47 offen sc1
K1_POLL_CHK:
    s_waitcnt vmcnt(0)
    v_cmp_ne_u64 vcc, s[80:81], v[160:161]
    s_nop 3
    s_cmp_eq_u64 vcc, 0
    s_cbranch_scc1 K1_POLL_GO
    s_sleep 1
    s_add_u32 s63, s63, 1
    s_cmp_lt_u32 s63, 0x100000
    s_cbranch_scc1 K1_POLL
K1_POLL_GO:
    v_mfma_f32_16x16x32_bf16 v[116:119], a[136:139], a[112:115], v[116:119]
    v_mfma_f32_16x16x32_bf16 v[116:119], a[156:159], a[116:119], v[116:119]
    v_mfma_f32_16x16x32_bf16 v[116:119], a[176:179], a[120:123], v[116:119]
    v_mfma_f32_16x16x32_bf16 v[116:119], a[196:199], a[124:127], v[116:119]
    s_add_u32 m0, s65, 0
    s_add_u32 s54, s36, 0
    buffer_load_dwordx4 v241, s[28:31], s54 offen offset:0 sc1 lds
    v_mfma_f32_16x16x32_bf16 v[148:151], a[136:139], a[208:211], v[148:151]
    v_mfma_f32_16x16x32_bf16 v[148:151], a[156:159], a[212:215], v[148:151]
    v_mfma_f32_16x16x32_bf16 v[148:151], a[176:179], a[216:219], v[148:151]
    v_mfma_f32_16x16x32_bf16 v[148:151], a[196:199], a[220:223], v[148:151]
    v_mfma_f32_16x16x32_bf16 v[28:31], a[140:143], a[32:35], v[28:31]
    v_mfma_f32_16x16x32_bf16 v[28:31], a[160:163], a[36:39], v[28:31]
    buffer_load_dwordx4 v241, s[28:31], s54 offen offset:1024 sc1 lds
    v_mfma_f32_16x16x32_bf16 v[28:31], a[180:183], a[40:43], v[28:31]
    v_mfma_f32_16x16x32_bf16 v[28:31], a[200:203], a[44:47], v[28:31]
    buffer_load_dwordx4 v241, s[28:31], s54 offen offset:2048 sc1 lds
    v_mfma_f32_16x16x32_bf16 v[60:63], a[140:143], a[48:51], v[60:63]
    v_mfma_f32_16x16x32_bf16 v[60:63], a[160:163], a[52:55], v[60:63]
    v_mfma_f32_16x16x32_bf16 v[60:63], a[180:183], a[56:59], v[60:63]
    buffer_load_dwordx4 v241, s[28:31], s54 offen offset:3072 sc1 lds
    v_mfma_f32_16x16x32_bf16 v[60:63], a[200:203], a[60:63], v[60:63]
    v_mfma_f32_16x16x32_bf16 v[92:95], a[140:143], a[96:99], v[92:95]
    v_mfma_f32_16x16x32_bf16 v[92:95], a[160:163], a[100:103], v[92:95]
    v_mfma_f32_16x16x32_bf16 v[92:95], a[180:183], a[104:107], v[92:95]
    v_mfma_f32_16x16x32_bf16 v[92:95], a[200:203], a[108:111], v[92:95]
    s_add_u32 m0, s65, 4096
    s_nop 0
    buffer_load_dwordx4 v242, s[28:31], s54 offen offset:0 sc1 lds
    v_mfma_f32_16x16x32_bf16 v[124:127], a[140:143], a[112:115], v[124:127]
    v_mfma_f32_16x16x32_bf16 v[124:127], a[160:163], a[116:119], v[124:127]
    v_mfma_f32_16x16x32_bf16 v[124:127], a[180:183], a[120:123], v[124:127]
    v_mfma_f32_16x16x32_bf16 v[124:127], a[200:203], a[124:127], v[124:127]
    v_mfma_f32_16x16x32_bf16 v[156:159], a[140:143], a[208:211], v[156:159]
    v_mfma_f32_16x16x32_bf16 v[156:159], a[160:163], a[212:215], v[156:159]
    v_mfma_f32_16x16x32_bf16 v[156:159], a[180:183], a[216:219], v[156:159]
    v_mfma_f32_16x16x32_bf16 v[156:159], a[200:203], a[220:223], v[156:159]
    s_add_u32 m0, s65, 40960
    s_add_u32 s54, s36, 10240
    buffer_load_dwordx4 v241, s[28:31], s54 offen offset:0 sc1 lds
    v_mfma_f32_16x16x32_bf16 v[200:203], a[144:147], a[32:35], v[200:203]
    v_mfma_f32_16x16x32_bf16 v[200:203], a[164:167], a[36:39], v[200:203]
    v_mfma_f32_16x16x32_bf16 v[200:203], a[184:187], a[40:43], v[200:203]
    v_mfma_f32_16x16x32_bf16 v[200:203], a[204:207], a[44:47], v[200:203]
    v_mfma_f32_16x16x32_bf16 v[204:207], a[144:147], a[48:51], v[204:207]
    v_mfma_f32_16x16x32_bf16 v[204:207], a[164:167], a[52:55], v[204:207]
    buffer_load_dwordx4 v241, s[28:31], s54 offen offset:1024 sc1 lds
    v_mfma_f32_16x16x32_bf16 v[204:207], a[184:187], a[56:59], v[204:207]
    v_mfma_f32_16x16x32_bf16 v[204:207], a[204:207], a[60:63], v[204:207]
    buffer_load_dwordx4 v241, s[28:31], s54 offen offset:2048 sc1 lds
    v_mfma_f32_16x16x32_bf16 v[208:211], a[144:147], a[96:99], v[208:211]
    v_mfma_f32_16x16x32_bf16 v[208:211], a[164:167], a[100:103], v[208:211]
    v_mfma_f32_16x16x32_bf16 v[208:211], a[184:187], a[104:107], v[208:211]
    buffer_load_dwordx4 v241, s[28:31], s54 offen offset:3072 sc1 lds
    v_mfma_f32_16x16x32_bf16 v[208:211], a[204:207], a[108:111], v[208:211]
    v_mfma_f32_16x16x32_bf16 v[212:215], a[144:147], a[112:115], v[212:215]
    v_mfma_f32_16x16x32_bf16 v[212:215], a[164:167], a[116:119], v[212:215]
    v_mfma_f32_16x16x32_bf16 v[212:215], a[184:187], a[120:123], v[212:215]
    v_mfma_f32_16x16x32_bf16 v[212:215], a[204:207], a[124:127], v[212:215]
    s_add_u32 m0, s65, 45056
    s_nop 0
    buffer_load_dwordx4 v242, s[28:31], s54 offen offset:0 sc1 lds
    v_mfma_f32_16x16x32_bf16 v[216:219], a[144:147], a[208:211], v[216:219]
    v_mfma_f32_16x16x32_bf16 v[216:219], a[164:167], a[212:215], v[216:219]
    v_mfma_f32_16x16x32_bf16 v[216:219], a[184:187], a[216:219], v[216:219]
    v_mfma_f32_16x16x32_bf16 v[216:219], a[204:207], a[220:223], v[216:219]
    s_waitcnt vmcnt(5)
    s_barrier
    ds_read_b64_tr_b16 a[0:1], v225 offset:0
    ds_read_b64_tr_b16 a[2:3], v225 offset:2560
    ds_read_b128 a[40:43], v227 offset:0
    ds_read_b64_tr_b16 a[4:5], v225 offset:10240
    ds_read_b64_tr_b16 a[6:7], v225 offset:12800
    ds_read_b128 a[44:47], v227 offset:10240
    ds_read_b64_tr_b16 a[8:9], v225 offset:32
    ds_read_b64_tr_b16 a[10:11], v225 offset:2592
    ds_read_b128 a[48:51], v227 offset:1024
    ds_read_b64_tr_b16 a[12:13], v225 offset:10272
    ds_read_b64_tr_b16 a[14:15], v225 offset:12832
    ds_read_b128 a[52:55], v227 offset:11264
    ds_read_b64_tr_b16 a[16:17], v225 offset:64
    ds_read_b64_tr_b16 a[18:19], v225 offset:2624
    ds_read_b128 a[56:59], v227 offset:2048
    ds_read_b64_tr_b16 a[20:21], v225 offset:10304
    ds_read_b64_tr_b16 a[22:23], v225 offset:12864
    ds_read_b128 a[60:63], v227 offset:12288
    ds_read_b64_tr_b16 a[24:25], v225 offset:96
    ds_read_b64_tr_b16 a[26:27], v225 offset:2656
    ds_read_b128 a[64:67], v227 offset:3072
    ds_read_b64_tr_b16 a[28:29], v225 offset:10336
    ds_read_b64_tr_b16 a[30:31], v225 offset:12896
    ds_read_b128 a[68:71], v227 offset:13312
    ds_read_b64_tr_b16 a[32:33], v225 offset:128
    ds_read_b64_tr_b16 a[34:35], v225 offset:2688
    ds_read_b128 a[72:75], v227 offset:4096
    ds_read_b64_tr_b16 a[36:37], v225 offset:10368
    ds_read_b64_tr_b16 a[38:39], v225 offset:12928
    ds_read_b128 a[76:79], v227 offset:14336
    s_waitcnt vmcnt(0) lgkmcnt(0)
    v_mfma_f32_16x16x32_bf16 v[4:7], a[0:3], a[40:43], v[4:7]
    s_barrier
    ds_read_b64_tr_b16 a[80:81], v225 offset:40960
    v_mfma_f32_16x16x32_bf16 v[4:7], a[4:7], a[44:47], v[4:7]
    ds_read_b64_tr_b16 a[82:83], v225 offset:43520
    v_mfma_f32_16x16x32_bf16 v[36:39], a[0:3], a[48:51], v[36:39]
    ds_read_b128 a[120:123], v227 offset:40960
    s_add_u32 m0, s65, 81920
    s_add_u32 s54, s36, 20480
    buffer_load_dwordx4 v241, s[28:31], s54 offen offset:0 sc1 lds
    v_mfma_f32_16x16x32_bf16 v[36:39], a[4:7], a[52:55], v[36:39]
    v_mfma_f32_16x16x32_bf16 v[68:71], a[0:3], a[56:59], v[68:71]
    ds_read_b64_tr_b16 a[84:85], v225 offset:51200
    v_mfma_f32_16x16x32_bf16 v[68:71], a[4:7], a[60:63], v[68:71]
    ds_read_b64_tr_b16 a[86:87], v225 offset:53760
    buffer_load_dwordx4 v241, s[28:31], s54 offen offset:1024 sc1 lds
    v_mfma_f32_16x16x32_bf16 v[100:103], a[0:3], a[64:67], v[100:103]
    ds_read_b128 a[124:127], v227 offset:51200
    v_mfma_f32_16x16x32_bf16 v[100:103], a[4:7], a[68:71], v[100:103]
    v_mfma_f32_16x16x32_bf16 v[132:135], a[0:3], a[72:75], v[132:135]
    ds_read_b64_tr_b16 a[88:89], v225 offset:40992
    v_mfma_f32_16x16x32_bf16 v[132:135], a[4:7], a[76:79], v[132:135]
    ds_read_b64_tr_b16 a[90:91], v225 offset:43552
    buffer_load_dwordx4 v241, s[28:31], s54 offen offset:2048 sc1 lds
    v_mfma_f32_16x16x32_bf16 v[12:15], a[8:11], a[40:43], v[12:15]
    ds_read_b128 a[128:131], v227 offset:41984
    v_mfma_f32_16x16x32_bf16 v[12:15], a[12:15], a[44:47], v[12:15]
    v_mfma_f32_16x16x32_bf16 v[44:47], a[8:11], a[48:51], v[44:47]
    ds_read_b64_tr_b16 a[92:93], v225 offset:51232
    v_mfma_f32_16x16x32_bf16 v[44:47], a[12:15], a[52:55], v[44:47]
    ds_read_b64_tr_b16 a[94:95], v225 offset:53792
    buffer_load_dwordx4 v241, s[28:31], s54 offen offset:3072 sc1 lds
    v_mfma_f32_16x16x32_bf16 v[76:79], a[8:11], a[56:59], v[76:79]
    v_mfma_f32_16x16x32_bf16 v[76:79], a[12:15], a[60:63], v[76:79]
    ds_read_b128 a[132:135], v227 offset:52224
    v_mfma_f32_16x16x32_bf16 v[108:111], a[8:11], a[64:67], v[108:111]
    ds_read_b64_tr_b16 a[96:97], v225 offset:41024
    v_mfma_f32_16x16x32_bf16 v[108:111], a[12:15], a[68:71], v[108:111]
    ds_read_b64_tr_b16 a[98:99], v225 offset:43584
    s_add_u32 m0, s65, 86016
    s_nop 0
    buffer_load_dwordx4 v242, s[28:31], s54 offen offset:0 sc1 lds
    v_mfma_f32_16x16x32_bf16 v[140:143], a[8:11], a[72:75], v[140:143]
    v_mfma_f32_16x16x32_bf16 v[140:143], a[12:15], a[76:79], v[140:143]
    ds_read_b128 a[136:139], v227 offset:43008
    v_mfma_f32_16x16x32_bf16 v[20:23], a[16:19], a[40:43], v[20:23]
    ds_read_b64_tr_b16 a[100:101], v225 offset:51264
    v_mfma_f32_16x16x32_bf16 v[20:23], a[20:23], a[44:47], v[20:23]
    ds_read_b64_tr_b16 a[102:103], v225 offset:53824
    s_add_u32 m0, s65, 122880
    s_add_u32 s54, s36, 30720
    buffer_load_dwordx4 v241, s[28:31], s54 offen offset:0 sc1 lds
    v_mfma_f32_16x16x32_bf16 v[52:55], a[16:19], a[48:51], v[52:55]
    v_mfma_f32_16x16x32_bf16 v[52:55], a[20:23], a[52:55], v[52:55]
    ds_read_b128 a[140:143], v227 offset:53248
    v_mfma_f32_16x16x32_bf16 v[84:87], a[16:19], a[56:59], v[84:87]
    ds_read_b64_tr_b16 a[104:105], v225 offset:41056
    v_mfma_f32_16x16x32_bf16 v[84:87], a[20:23], a[60:63], v[84:87]
    ds_read_b64_tr_b16 a[106:107], v225 offset:43616
    buffer_load_dwordx4 v241, s[28:31], s54 offen offset:1024 sc1 lds
    v_mfma_f32_16x16x32_bf16 v[116:119], a[16:19], a[64:67], v[116:119]
    v_mfma_f32_16x16x32_bf16 v[116:119], a[20:23], a[68:71], v[116:119]
    ds_read_b128 a[144:147], v227 offset:44032
    v_mfma_f32_16x16x32_bf16 v[148:151], a[16:19], a[72:75], v[148:151]
    ds_read_b64_tr_b16 a[108:109], v225 offset:51296
    buffer_load_dwordx4 v241, s[28:31], s54 offen offset:2048 sc1 lds
    v_mfma_f32_16x16x32_bf16 v[148:151], a[20:23], a[76:79], v[148:151]
    v_mfma_f32_16x16x32_bf16 v[28:31], a[24:27], a[40:43], v[28:31]
    ds_read_b64_tr_b16 a[110:111], v225 offset:53856
    v_mfma_f32_16x16x32_bf16 v[28:31], a[28:31], a[44:47], v[28:31]
    ds_read_b128 a[148:151], v227 offset:54272
    v_mfma_f32_16x16x32_bf16 v[60:63], a[24:27], a[48:51], v[60:63]
    ds_read_b64_tr_b16 a[112:113], v225 offset:41088
    buffer_load_dwordx4 v241, s[28:31], s54 offen offset:3072 sc1 lds
    v_mfma_f32_16x16x32_bf16 v[60:63], a[28:31], a[52:55], v[60:63]
    v_mfma_f32_16x16x32_bf16 v[92:95], a[24:27], a[56:59], v[92:95]
    ds_read_b64_tr_b16 a[114:115], v225 offset:43648
    v_mfma_f32_16x16x32_bf16 v[92:95], a[28:31], a[60:63], v[92:95]
    ds_read_b128 a[152:155], v227 offset:45056
    v_mfma_f32_16x16x32_bf16 v[124:127], a[24:27], a[64:67], v[124:127]
    ds_read_b64_tr_b16 a[116:117], v225 offset:51328
    s_add_u32 m0, s65, 126976
    s_nop 0
    buffer_load_dwordx4 v242, s[28:31], s54 offen offset:0 sc1 lds
    v_mfma_f32_16x16x32_bf16 v[124:127], a[28:31], a[68:71], v[124:127]
    v_mfma_f32_16x16x32_bf16 v[156:159], a[24:27], a[72:75], v[156:159]
    ds_read_b64_tr_b16 a[118:119], v225 offset:53888
    v_mfma_f32_16x16x32_bf16 v[156:159], a[28:31], a[76:79], v[156:159]
    ds_read_b128 a[156:159], v227 offset:55296
    v_mfma_f32_16x16x32_bf16 v[200:203], a[32:35], a[40:43], v[200:203]
    s_add_u32 m0, s65, 0
    s_add_u32 s54, s37, 0
    buffer_load_dwordx4 v241, s[28:31], s54 offen offset:0 sc1 lds
    v_mfma_f32_16x16x32_bf16 v[200:203], a[36:39], a[44:47], v[200:203]
    v_mfma_f32_16x16x32_bf16 v[204:207], a[32:35], a[48:51], v[204:207]
    v_mfma_f32_16x16x32_bf16 v[204:207], a[36:39], a[52:55], v[204:207]
    v_mfma_f32_16x16x32_bf16 v[208:211], a[32:35], a[56:59], v[208:211]
    buffer_load_dwordx4 v241, s[28:31], s54 offen offset:1024 sc1 lds
    v_mfma_f32_16x16x32_bf16 v[208:211], a[36:39], a[60:63], v[208:211]
    v_mfma_f32_16x16x32_bf16 v[212:215], a[32:35], a[64:67], v[212:215]
    v_mfma_f32_16x16x32_bf16 v[212:215], a[36:39], a[68:71], v[212:215]
    v_mfma_f32_16x16x32_bf16 v[216:219], a[32:35], a[72:75], v[216:219]
    v_mfma_f32_16x16x32_bf16 v[216:219], a[36:39], a[76:79], v[216:219]
    s_waitcnt vmcnt(7) lgkmcnt(0)
    v_mfma_f32_16x16x32_bf16 v[4:7], a[80:83], a[120:123], v[4:7]
    s_barrier
    ds_read_b64_tr_b16 a[0:1], v226 offset:0
    v_mfma_f32_16x16x32_bf16 v[4:7], a[84:87], a[124:127], v[4:7]
    ds_read_b64_tr_b16 a[2:3], v226 offset:2560
    v_mfma_f32_16x16x32_bf16 v[36:39], a[80:83], a[128:131], v[36:39]
    ds_read_b128 a[40:43], v228 offset:0
    buffer_load_dwordx4 v241, s[28:31], s54 offen offset:2048 sc1 lds
    v_mfma_f32_16x16x32_bf16 v[36:39], a[84:87], a[132:135], v[36:39]
    v_mfma_f32_16x16x32_bf16 v[68:71], a[80:83], a[136:139], v[68:71]
    ds_read_b64_tr_b16 a[4:5], v226 offset:10240
    v_mfma_f32_16x16x32_bf16 v[68:71], a[84:87], a[140:143], v[68:71]
    ds_read_b64_tr_b16 a[6:7], v226 offset:12800
    buffer_load_dwordx4 v241, s[28:31], s54 offen offset:3072 sc1 lds
    v_mfma_f32_16x16x32_bf16 v[100:103], a[80:83], a[144:147], v[100:103]
    ds_read_b128 a[44:47], v228 offset:10240
    v_mfma_f32_16x16x32_bf16 v[100:103], a[84:87], a[148:151], v[100:103]
    v_mfma_f32_16x16x32_bf16 v[132:135], a[80:83], a[152:155], v[132:135]
    ds_read_b64_tr_b16 a[8:9], v226 offset:32
    v_mfma_f32_16x16x32_bf16 v[132:135], a[84:87], a[156:159], v[132:135]
    ds_read_b64_tr_b16 a[10:11], v226 offset:2592
    s_add_u32 m0, s65, 4096
    s_nop 0
    buffer_load_dwordx4 v242, s[28:31], s54 offen offset:0 sc1 lds
    v_mfma_f32_16x16x32_bf16 v[12:15], a[88:91], a[120:123], v[12:15]
    ds_read_b128 a[48:51], v228 offset:1024
    v_mfma_f32_16x16x32_bf16 v[12:15], a[92:95], a[124:127], v[12:15]
    v_mfma_f32_16x16x32_bf16 v[44:47], a[88:91], a[128:131], v[44:47]
    ds_read_b64_tr_b16 a[12:13], v226 offset:10272
    v_mfma_f32_16x16x32_bf16 v[44:47], a[92:95], a[132:135], v[44:47]
    ds_read_b64_tr_b16 a[14:15], v226 offset:12832
    s_add_u32 m0, s64, 0
    s_add_u32 s54, s40, 0
    buffer_load_dwordx4 v220, s[32:35], s54 offen offset:0 lds
    v_mfma_f32_16x16x32_bf16 v[76:79], a[88:91], a[136:139], v[76:79]
    v_mfma_f32_16x16x32_bf16 v[76:79], a[92:95], a[140:143], v[76:79]
    ds_read_b128 a[52:55], v228 offset:11264
    v_mfma_f32_16x16x32_bf16 v[108:111], a[88:91], a[144:147], v[108:111]
    ds_read_b64_tr_b16 a[16:17], v226 offset:64
    v_mfma_f32_16x16x32_bf16 v[108:111], a[92:95], a[148:151], v[108:111]
    ds_read_b64_tr_b16 a[18:19], v226 offset:2624
    buffer_load_dwordx4 v221, s[32:35], s54 offen offset:1024 lds
    v_mfma_f32_16x16x32_bf16 v[140:143], a[88:91], a[152:155], v[140:143]
    v_mfma_f32_16x16x32_bf16 v[140:143], a[92:95], a[156:159], v[140:143]
    ds_read_b128 a[56:59], v228 offset:2048
    v_mfma_f32_16x16x32_bf16 v[20:23], a[96:99], a[120:123], v[20:23]
    ds_read_b64_tr_b16 a[20:21], v226 offset:10304
    v_mfma_f32_16x16x32_bf16 v[20:23], a[100:103], a[124:127], v[20:23]
    ds_read_b64_tr_b16 a[22:23], v226 offset:12864
    buffer_load_dwordx4 v222, s[32:35], s54 offen offset:2048 lds
    v_mfma_f32_16x16x32_bf16 v[52:55], a[96:99], a[128:131], v[52:55]
    v_mfma_f32_16x16x32_bf16 v[52:55], a[100:103], a[132:135], v[52:55]
    ds_read_b128 a[60:63], v228 offset:12288
    v_mfma_f32_16x16x32_bf16 v[84:87], a[96:99], a[136:139], v[84:87]
    ds_read_b64_tr_b16 a[24:25], v226 offset:96
    v_mfma_f32_16x16x32_bf16 v[84:87], a[100:103], a[140:143], v[84:87]
    ds_read_b64_tr_b16 a[26:27], v226 offset:2656
    buffer_load_dwordx4 v223, s[32:35], s54 offen offset:3072 lds
    v_mfma_f32_16x16x32_bf16 v[116:119], a[96:99], a[144:147], v[116:119]
    v_mfma_f32_16x16x32_bf16 v[116:119], a[100:103], a[148:151], v[116:119]
    ds_read_b128 a[64:67], v228 offset:3072
    v_mfma_f32_16x16x32_bf16 v[148:151], a[96:99], a[152:155], v[148:151]
    ds_read_b64_tr_b16 a[28:29], v226 offset:10336
    s_add_u32 m0, s64, 4096
    s_nop 0
    buffer_load_dwordx4 v224, s[32:35], s54 offen offset:0 lds
    v_mfma_f32_16x16x32_bf16 v[148:151], a[100:103], a[156:159], v[148:151]
    v_mfma_f32_16x16x32_bf16 v[28:31], a[104:107], a[120:123], v[28:31]
    ds_read_b64_tr_b16 a[30:31], v226 offset:12896
    v_mfma_f32_16x16x32_bf16 v[28:31], a[108:111], a[124:127], v[28:31]
    ds_read_b128 a[68:71], v228 offset:13312
    v_mfma_f32_16x16x32_bf16 v[60:63], a[104:107], a[128:131], v[60:63]
    ds_read_b64_tr_b16 a[32:33], v226 offset:128
    s_add_u32 m0, s65, 40960
    s_add_u32 s54, s37, 10240
    buffer_load_dwordx4 v241, s[28:31], s54 offen offset:0 sc1 lds
    v_mfma_f32_16x16x32_bf16 v[60:63], a[108:111], a[132:135], v[60:63]
    v_mfma_f32_16x16x32_bf16 v[92:95], a[104:107], a[136:139], v[92:95]
    ds_read_b64_tr_b16 a[34:35], v226 offset:2688
    v_mfma_f32_16x16x32_bf16 v[92:95], a[108:111], a[140:143], v[92:95]
    ds_read_b128 a[72:75], v228 offset:4096
    v_mfma_f32_16x16x32_bf16 v[124:127], a[104:107], a[144:147], v[124:127]
    ds_read_b64_tr_b16 a[36:37], v226 offset:10368
    buffer_load_dwordx4 v241, s[28:31], s54 offen offset:1024 sc1 lds
    v_mfma_f32_16x16x32_bf16 v[124:127], a[108:111], a[148:151], v[124:127]
    v_mfma_f32_16x16x32_bf16 v[156:159], a[104:107], a[152:155], v[156:159]
    ds_read_b64_tr_b16 a[38:39], v226 offset:12928
    v_mfma_f32_16x16x32_bf16 v[156:159], a[108:111], a[156:159], v[156:159]
    ds_read_b128 a[76:79], v228 offset:14336
    v_mfma_f32_16x16x32_bf16 v[200:203], a[112:115], a[120:123], v[200:203]
    buffer_load_dwordx4 v241, s[28:31], s54 offen offset:2048 sc1 lds
    v_mfma_f32_16x16x32_bf16 v[200:203], a[116:119], a[124:127], v[200:203]
    v_mfma_f32_16x16x32_bf16 v[204:207], a[112:115], a[128:131], v[204:207]
    v_mfma_f32_16x16x32_bf16 v[204:207], a[116:119], a[132:135], v[204:207]
    v_mfma_f32_16x16x32_bf16 v[208:211], a[112:115], a[136:139], v[208:211]
    buffer_load_dwordx4 v241, s[28:31], s54 offen offset:3072 sc1 lds
    v_mfma_f32_16x16x32_bf16 v[208:211], a[116:119], a[140:143], v[208:211]
    v_mfma_f32_16x16x32_bf16 v[212:215], a[112:115], a[144:147], v[212:215]
    v_mfma_f32_16x16x32_bf16 v[212:215], a[116:119], a[148:151], v[212:215]
    v_mfma_f32_16x16x32_bf16 v[216:219], a[112:115], a[152:155], v[216:219]
    v_mfma_f32_16x16x32_bf16 v[216:219], a[116:119], a[156:159], v[216:219]
    s_waitcnt vmcnt(14) lgkmcnt(0)
    v_mfma_f32_16x16x32_bf16 v[4:7], a[0:3], a[40:43], v[4:7]
    s_barrier
    ds_read_b64_tr_b16 a[80:81], v226 offset:40960
    v_mfma_f32_16x16x32_bf16 v[4:7], a[4:7], a[44:47], v[4:7]
    ds_read_b64_tr_b16 a[82:83], v226 offset:43520
    v_mfma_f32_16x16x32_bf16 v[36:39], a[0:3], a[48:51], v[36:39]
    ds_read_b128 a[120:123], v228 offset:40960
    s_add_u32 m0, s65, 45056
    s_nop 0
    buffer_load_dwordx4 v242, s[28:31], s54 offen offset:0 sc1 lds
    v_mfma_f32_16x16x32_bf16 v[36:39], a[4:7], a[52:55], v[36:39]
    v_mfma_f32_16x16x32_bf16 v[68:71], a[0:3], a[56:59], v[68:71]
    ds_read_b64_tr_b16 a[84:85], v226 offset:51200
    v_mfma_f32_16x16x32_bf16 v[68:71], a[4:7], a[60:63], v[68:71]
    ds_read_b64_tr_b16 a[86:87], v226 offset:53760
    s_add_u32 m0, s64, 40960
    s_add_u32 s54, s40, 81920
    buffer_load_dwordx4 v220, s[32:35], s54 offen offset:0 lds
    v_mfma_f32_16x16x32_bf16 v[100:103], a[0:3], a[64:67], v[100:103]
    ds_read_b128 a[124:127], v228 offset:51200
    v_mfma_f32_16x16x32_bf16 v[100:103], a[4:7], a[68:71], v[100:103]
    v_mfma_f32_16x16x32_bf16 v[132:135], a[0:3], a[72:75], v[132:135]
    ds_read_b64_tr_b16 a[88:89], v226 offset:40992
    v_mfma_f32_16x16x32_bf16 v[132:135], a[4:7], a[76:79], v[132:135]
    ds_read_b64_tr_b16 a[90:91], v226 offset:43552
    buffer_load_dwordx4 v221, s[32:35], s54 offen offset:1024 lds
    v_mfma_f32_16x16x32_bf16 v[12:15], a[8:11], a[40:43], v[12:15]
    ds_read_b128 a[128:131], v228 offset:41984
    v_mfma_f32_16x16x32_bf16 v[12:15], a[12:15], a[44:47], v[12:15]
    v_mfma_f32_16x16x32_bf16 v[44:47], a[8:11], a[48:51], v[44:47]
    ds_read_b64_tr_b16 a[92:93], v226 offset:51232
    v_mfma_f32_16x16x32_bf16 v[44:47], a[12:15], a[52:55], v[44:47]
    ds_read_b64_tr_b16 a[94:95], v226 offset:53792
    buffer_load_dwordx4 v222, s[32:35], s54 offen offset:2048 lds
    v_mfma_f32_16x16x32_bf16 v[76:79], a[8:11], a[56:59], v[76:79]
    v_mfma_f32_16x16x32_bf16 v[76:79], a[12:15], a[60:63], v[76:79]
    ds_read_b128 a[132:135], v228 offset:52224
    v_mfma_f32_16x16x32_bf16 v[108:111], a[8:11], a[64:67], v[108:111]
    ds_read_b64_tr_b16 a[96:97], v226 offset:41024
    v_mfma_f32_16x16x32_bf16 v[108:111], a[12:15], a[68:71], v[108:111]
    ds_read_b64_tr_b16 a[98:99], v226 offset:43584
    buffer_load_dwordx4 v223, s[32:35], s54 offen offset:3072 lds
    v_mfma_f32_16x16x32_bf16 v[140:143], a[8:11], a[72:75], v[140:143]
    v_mfma_f32_16x16x32_bf16 v[140:143], a[12:15], a[76:79], v[140:143]
    ds_read_b128 a[136:139], v228 offset:43008
    v_mfma_f32_16x16x32_bf16 v[20:23], a[16:19], a[40:43], v[20:23]
    ds_read_b64_tr_b16 a[100:101], v226 offset:51264
    v_mfma_f32_16x16x32_bf16 v[20:23], a[20:23], a[44:47], v[20:23]
    ds_read_b64_tr_b16 a[102:103], v226 offset:53824
    s_add_u32 m0, s64, 45056
    s_nop 0
    buffer_load_dwordx4 v224, s[32:35], s54 offen offset:0 lds
    v_mfma_f32_16x16x32_bf16 v[52:55], a[16:19], a[48:51], v[52:55]
    v_mfma_f32_16x16x32_bf16 v[52:55], a[20:23], a[52:55], v[52:55]
    ds_read_b128 a[140:143], v228 offset:53248
    v_mfma_f32_16x16x32_bf16 v[84:87], a[16:19], a[56:59], v[84:87]
    ds_read_b64_tr_b16 a[104:105], v226 offset:41056
    v_mfma_f32_16x16x32_bf16 v[84:87], a[20:23], a[60:63], v[84:87]
    ds_read_b64_tr_b16 a[106:107], v226 offset:43616
    s_add_u32 m0, s65, 81920
    s_add_u32 s54, s37, 20480
    buffer_load_dwordx4 v241, s[28:31], s54 offen offset:0 sc1 lds
    v_mfma_f32_16x16x32_bf16 v[116:119], a[16:19], a[64:67], v[116:119]
    v_mfma_f32_16x16x32_bf16 v[116:119], a[20:23], a[68:71], v[116:119]
    ds_read_b128 a[144:147], v228 offset:44032
    v_mfma_f32_16x16x32_bf16 v[148:151], a[16:19], a[72:75], v[148:151]
    ds_read_b64_tr_b16 a[108:109], v226 offset:51296
    buffer_load_dwordx4 v241, s[28:31], s54 offen offset:1024 sc1 lds
    v_mfma_f32_16x16x32_bf16 v[148:151], a[20:23], a[76:79], v[148:151]
    v_mfma_f32_16x16x32_bf16 v[28:31], a[24:27], a[40:43], v[28:31]
    ds_read_b64_tr_b16 a[110:111], v226 offset:53856
    v_mfma_f32_16x16x32_bf16 v[28:31], a[28:31], a[44:47], v[28:31]
    ds_read_b128 a[148:151], v228 offset:54272
    v_mfma_f32_16x16x32_bf16 v[60:63], a[24:27], a[48:51], v[60:63]
    ds_read_b64_tr_b16 a[112:113], v226 offset:41088
    buffer_load_dwordx4 v241, s[28:31], s54 offen offset:2048 sc1 lds
    v_mfma_f32_16x16x32_bf16 v[60:63], a[28:31], a[52:55], v[60:63]
    v_mfma_f32_16x16x32_bf16 v[92:95], a[24:27], a[56:59], v[92:95]
    ds_read_b64_tr_b16 a[114:115], v226 offset:43648
    v_mfma_f32_16x16x32_bf16 v[92:95], a[28:31], a[60:63], v[92:95]
    ds_read_b128 a[152:155], v228 offset:45056
    v_mfma_f32_16x16x32_bf16 v[124:127], a[24:27], a[64:67], v[124:127]
    ds_read_b64_tr_b16 a[116:117], v226 offset:51328
    buffer_load_dwordx4 v241, s[28:31], s54 offen offset:3072 sc1 lds
    v_mfma_f32_16x16x32_bf16 v[124:127], a[28:31], a[68:71], v[124:127]
    v_mfma_f32_16x16x32_bf16 v[156:159], a[24:27], a[72:75], v[156:159]
    ds_read_b64_tr_b16 a[118:119], v226 offset:53888
    v_mfma_f32_16x16x32_bf16 v[156:159], a[28:31], a[76:79], v[156:159]
    ds_read_b128 a[156:159], v228 offset:55296
    v_mfma_f32_16x16x32_bf16 v[200:203], a[32:35], a[40:43], v[200:203]
    s_add_u32 m0, s65, 86016
    s_nop 0
    buffer_load_dwordx4 v242, s[28:31], s54 offen offset:0 sc1 lds
    v_mfma_f32_16x16x32_bf16 v[200:203], a[36:39], a[44:47], v[200:203]
    v_mfma_f32_16x16x32_bf16 v[204:207], a[32:35], a[48:51], v[204:207]
    v_mfma_f32_16x16x32_bf16 v[204:207], a[36:39], a[52:55], v[204:207]
    v_mfma_f32_16x16x32_bf16 v[208:211], a[32:35], a[56:59], v[208:211]
    s_add_u32 m0, s64, 81920
    s_add_u32 s54, s40, 163840
    buffer_load_dwordx4 v220, s[32:35], s54 offen offset:0 lds
    v_mfma_f32_16x16x32_bf16 v[208:211], a[36:39], a[60:63], v[208:211]
    v_mfma_f32_16x16x32_bf16 v[212:215], a[32:35], a[64:67], v[212:215]
    v_mfma_f32_16x16x32_bf16 v[212:215], a[36:39], a[68:71], v[212:215]
    v_mfma_f32_16x16x32_bf16 v[216:219], a[32:35], a[72:75], v[216:219]
    v_mfma_f32_16x16x32_bf16 v[216:219], a[36:39], a[76:79], v[216:219]
    s_waitcnt vmcnt(16) lgkmcnt(0)
    v_mfma_f32_16x16x32_bf16 v[4:7], a[80:83], a[120:123], v[4:7]
    s_barrier
    ds_read_b64_tr_b16 a[0:1], v225 offset:0
    v_mfma_f32_16x16x32_bf16 v[4:7], a[84:87], a[124:127], v[4:7]
    ds_read_b64_tr_b16 a[2:3], v225 offset:2560
    v_mfma_f32_16x16x32_bf16 v[36:39], a[80:83], a[128:131], v[36:39]
    ds_read_b128 a[40:43], v227 offset:0
    buffer_load_dwordx4 v221, s[32:35], s54 offen offset:1024 lds
    v_mfma_f32_16x16x32_bf16 v[36:39], a[84:87], a[132:135], v[36:39]
    v_mfma_f32_16x16x32_bf16 v[68:71], a[80:83], a[136:139], v[68:71]
    ds_read_b64_tr_b16 a[4:5], v225 offset:10240
    v_mfma_f32_16x16x32_bf16 v[68:71], a[84:87], a[140:143], v[68:71]
    ds_read_b64_tr_b16 a[6:7], v225 offset:12800
    buffer_load_dwordx4 v222, s[32:35], s54 offen offset:2048 lds
    v_mfma_f32_16x16x32_bf16 v[100:103], a[80:83], a[144:147], v[100:103]
    ds_read_b128 a[44:47], v227 offset:10240
    v_mfma_f32_16x16x32_bf16 v[100:103], a[84:87], a[148:151], v[100:103]
    v_mfma_f32_16x16x32_bf16 v[132:135], a[80:83], a[152:155], v[132:135]
    ds_read_b64_tr_b16 a[8:9], v225 offset:32
    v_mfma_f32_16x16x32_bf16 v[132:135], a[84:87], a[156:159], v[132:135]
    ds_read_b64_tr_b16 a[10:11], v225 offset:2592
    buffer_load_dwordx4 v223, s[32:35], s54 offen offset:3072 lds
    v_mfma_f32_16x16x32_bf16 v[12:15], a[88:91], a[120:123], v[12:15]
    ds_read_b128 a[48:51], v227 offset:1024
    v_mfma_f32_16x16x32_bf16 v[12:15], a[92:95], a[124:127], v[12:15]
    v_mfma_f32_16x16x32_bf16 v[44:47], a[88:91], a[128:131], v[44:47]
    ds_read_b64_tr_b16 a[12:13], v225 offset:10272
    v_mfma_f32_16x16x32_bf16 v[44:47], a[92:95], a[132:135], v[44:47]
    ds_read_b64_tr_b16 a[14:15], v225 offset:12832
    s_add_u32 m0, s64, 86016
    s_nop 0
    buffer_load_dwordx4 v224, s[32:35], s54 offen offset:0 lds
    v_mfma_f32_16x16x32_bf16 v[76:79], a[88:91], a[136:139], v[76:79]
    v_mfma_f32_16x16x32_bf16 v[76:79], a[92:95], a[140:143], v[76:79]
    ds_read_b128 a[52:55], v227 offset:11264
    v_mfma_f32_16x16x32_bf16 v[108:111], a[88:91], a[144:147], v[108:111]
    ds_read_b64_tr_b16 a[16:17], v225 offset:64
    v_mfma_f32_16x16x32_bf16 v[108:111], a[92:95], a[148:151], v[108:111]
    ds_read_b64_tr_b16 a[18:19], v225 offset:2624
    s_add_u32 m0, s65, 122880
    s_add_u32 s54, s37, 30720
    buffer_load_dwordx4 v241, s[28:31], s54 offen offset:0 sc1 lds
    v_mfma_f32_16x16x32_bf16 v[140:143], a[88:91], a[152:155], v[140:143]
    v_mfma_f32_16x16x32_bf16 v[140:143], a[92:95], a[156:159], v[140:143]
    ds_read_b128 a[56:59], v227 offset:2048
    v_mfma_f32_16x16x32_bf16 v[20:23], a[96:99], a[120:123], v[20:23]
    ds_read_b64_tr_b16 a[20:21], v225 offset:10304
    v_mfma_f32_16x16x32_bf16 v[20:23], a[100:103], a[124:127], v[20:23]
    ds_read_b64_tr_b16 a[22:23], v225 offset:12864
    buffer_load_dwordx4 v241, s[28:31], s54 offen offset:1024 sc1 lds
    v_mfma_f32_16x16x32_bf16 v[52:55], a[96:99], a[128:131], v[52:55]
    v_mfma_f32_16x16x32_bf16 v[52:55], a[100:103], a[132:135], v[52:55]
    ds_read_b128 a[60:63], v227 offset:12288
    v_mfma_f32_16x16x32_bf16 v[84:87], a[96:99], a[136:139], v[84:87]
    ds_read_b64_tr_b16 a[24:25], v225 offset:96
    v_mfma_f32_16x16x32_bf16 v[84:87], a[100:103], a[140:143], v[84:87]
    ds_read_b64_tr_b16 a[26:27], v225 offset:2656
    buffer_load_dwordx4 v241, s[28:31], s54 offen offset:2048 sc1 lds
    v_mfma_f32_16x16x32_bf16 v[116:119], a[96:99], a[144:147], v[116:119]
    v_mfma_f32_16x16x32_bf16 v[116:119], a[100:103], a[148:151], v[116:119]
    ds_read_b128 a[64:67], v227 offset:3072
    v_mfma_f32_16x16x32_bf16 v[148:151], a[96:99], a[152:155], v[148:151]
    ds_read_b64_tr_b16 a[28:29], v225 offset:10336
    buffer_load_dwordx4 v241, s[28:31], s54 offen offset:3072 sc1 lds
    v_mfma_f32_16x16x32_bf16 v[148:151], a[100:103], a[156:159], v[148:151]
    v_mfma_f32_16x16x32_bf16 v[28:31], a[104:107], a[120:123], v[28:31]
    ds_read_b64_tr_b16 a[30:31], v225 offset:12896
    v_mfma_f32_16x16x32_bf16 v[28:31], a[108:111], a[124:127], v[28:31]
    ds_read_b128 a[68:71], v227 offset:13312
    v_mfma_f32_16x16x32_bf16 v[60:63], a[104:107], a[128:131], v[60:63]
    ds_read_b64_tr_b16 a[32:33], v225 offset:128
    s_add_u32 m0, s65, 126976
    s_nop 0
    buffer_load_dwordx4 v242, s[28:31], s54 offen offset:0 sc1 lds
    v_mfma_f32_16x16x32_bf16 v[60:63], a[108:111], a[132:135], v[60:63]
    v_mfma_f32_16x16x32_bf16 v[92:95], a[104:107], a[136:139], v[92:95]
    ds_read_b64_tr_b16 a[34:35], v225 offset:2688
    v_mfma_f32_16x16x32_bf16 v[92:95], a[108:111], a[140:143], v[92:95]
    ds_read_b128 a[72:75], v227 offset:4096
    v_mfma_f32_16x16x32_bf16 v[124:127], a[104:107], a[144:147], v[124:127]
    ds_read_b64_tr_b16 a[36:37], v225 offset:10368
    s_add_u32 m0, s64, 122880
    s_add_u32 s54, s40, 245760
    buffer_load_dwordx4 v220, s[32:35], s54 offen offset:0 lds
    v_mfma_f32_16x16x32_bf16 v[124:127], a[108:111], a[148:151], v[124:127]
    v_mfma_f32_16x16x32_bf16 v[156:159], a[104:107], a[152:155], v[156:159]
    ds_read_b64_tr_b16 a[38:39], v225 offset:12928
    v_mfma_f32_16x16x32_bf16 v[156:159], a[108:111], a[156:159], v[156:159]
    ds_read_b128 a[76:79], v227 offset:14336
    v_mfma_f32_16x16x32_bf16 v[200:203], a[112:115], a[120:123], v[200:203]
    buffer_load_dwordx4 v221, s[32:35], s54 offen offset:1024 lds
    v_mfma_f32_16x16x32_bf16 v[200:203], a[116:119], a[124:127], v[200:203]
    v_mfma_f32_16x16x32_bf16 v[204:207], a[112:115], a[128:131], v[204:207]
    v_mfma_f32_16x16x32_bf16 v[204:207], a[116:119], a[132:135], v[204:207]
    v_mfma_f32_16x16x32_bf16 v[208:211], a[112:115], a[136:139], v[208:211]
    buffer_load_dwordx4 v222, s[32:35], s54 offen offset:2048 lds
    v_mfma_f32_16x16x32_bf16 v[208:211], a[116:119], a[140:143], v[208:211]
    v_mfma_f32_16x16x32_bf16 v[212:215], a[112:115], a[144:147], v[212:215]
    v_mfma_f32_16x16x32_bf16 v[212:215], a[116:119], a[148:151], v[212:215]
    v_mfma_f32_16x16x32_bf16 v[216:219], a[112:115], a[152:155], v[216:219]
    v_mfma_f32_16x16x32_bf16 v[216:219], a[116:119], a[156:159], v[216:219]
    s_waitcnt vmcnt(18) lgkmcnt(0)
    v_mfma_f32_16x16x32_bf16 v[4:7], a[0:3], a[40:43], v[4:7]
    s_barrier
    ds_read_b64_tr_b16 a[80:81], v225 offset:40960
    v_mfma_f32_16x16x32_bf16 v[4:7], a[4:7], a[44:47], v[4:7]
    ds_read_b64_tr_b16 a[82:83], v225 offset:43520
    v_mfma_f32_16x16x32_bf16 v[36:39], a[0:3], a[48:51], v[36:39]
    ds_read_b128 a[120:123], v227 offset:40960
    buffer_load_dwordx4 v223, s[32:35], s54 offen offset:3072 lds
    v_mfma_f32_16x16x32_bf16 v[36:39], a[4:7], a[52:55], v[36:39]
    v_mfma_f32_16x16x32_bf16 v[68:71], a[0:3], a[56:59], v[68:71]
    ds_read_b64_tr_b16 a[84:85], v225 offset:51200
    v_mfma_f32_16x16x32_bf16 v[68:71], a[4:7], a[60:63], v[68:71]
    ds_read_b64_tr_b16 a[86:87], v225 offset:53760
    s_add_u32 m0, s64, 126976
    s_nop 0
    buffer_load_dwordx4 v224, s[32:35], s54 offen offset:0 lds
    v_mfma_f32_16x16x32_bf16 v[100:103], a[0:3], a[64:67], v[100:103]
    ds_read_b128 a[124:127], v227 offset:51200
    v_mfma_f32_16x16x32_bf16 v[100:103], a[4:7], a[68:71], v[100:103]
    v_mfma_f32_16x16x32_bf16 v[132:135], a[0:3], a[72:75], v[132:135]
    ds_read_b64_tr_b16 a[88:89], v225 offset:40992
    v_mfma_f32_16x16x32_bf16 v[132:135], a[4:7], a[76:79], v[132:135]
    ds_read_b64_tr_b16 a[90:91], v225 offset:43552
    s_add_u32 m0, s65, 0
    s_add_u32 s54, s38, 0
    buffer_load_dwordx4 v241, s[28:31], s54 offen offset:0 sc1 lds
    v_mfma_f32_16x16x32_bf16 v[12:15], a[8:11], a[40:43], v[12:15]
    ds_read_b128 a[128:131], v227 offset:41984
    v_mfma_f32_16x16x32_bf16 v[12:15], a[12:15], a[44:47], v[12:15]
    v_mfma_f32_16x16x32_bf16 v[44:47], a[8:11], a[48:51], v[44:47]
    ds_read_b64_tr_b16 a[92:93], v225 offset:51232
    v_mfma_f32_16x16x32_bf16 v[44:47], a[12:15], a[52:55], v[44:47]
    ds_read_b64_tr_b16 a[94:95], v225 offset:53792
    buffer_load_dwordx4 v241, s[28:31], s54 offen offset:1024 sc1 lds
    v_mfma_f32_16x16x32_bf16 v[76:79], a[8:11], a[56:59], v[76:79]
    v_mfma_f32_16x16x32_bf16 v[76:79], a[12:15], a[60:63], v[76:79]
    ds_read_b128 a[132:135], v227 offset:52224
    v_mfma_f32_16x16x32_bf16 v[108:111], a[8:11], a[64:67], v[108:111]
    ds_read_b64_tr_b16 a[96:97], v225 offset:41024
    v_mfma_f32_16x16x32_bf16 v[108:111], a[12:15], a[68:71], v[108:111]
    ds_read_b64_tr_b16 a[98:99], v225 offset:43584
    buffer_load_dwordx4 v241, s[28:31], s54 offen offset:2048 sc1 lds
    v_mfma_f32_16x16x32_bf16 v[140:143], a[8:11], a[72:75], v[140:143]
    v_mfma_f32_16x16x32_bf16 v[140:143], a[12:15], a[76:79], v[140:143]
    ds_read_b128 a[136:139], v227 offset:43008
    v_mfma_f32_16x16x32_bf16 v[20:23], a[16:19], a[40:43], v[20:23]
    ds_read_b64_tr_b16 a[100:101], v225 offset:51264
    v_mfma_f32_16x16x32_bf16 v[20:23], a[20:23], a[44:47], v[20:23]
    ds_read_b64_tr_b16 a[102:103], v225 offset:53824
    buffer_load_dwordx4 v241, s[28:31], s54 offen offset:3072 sc1 lds
    v_mfma_f32_16x16x32_bf16 v[52:55], a[16:19], a[48:51], v[52:55]
    v_mfma_f32_16x16x32_bf16 v[52:55], a[20:23], a[52:55], v[52:55]
    ds_read_b128 a[140:143], v227 offset:53248
    v_mfma_f32_16x16x32_bf16 v[84:87], a[16:19], a[56:59], v[84:87]
    ds_read_b64_tr_b16 a[104:105], v225 offset:41056
    v_mfma_f32_16x16x32_bf16 v[84:87], a[20:23], a[60:63], v[84:87]
    ds_read_b64_tr_b16 a[106:107], v225 offset:43616
    s_add_u32 m0, s65, 4096
    s_nop 0
    buffer_load_dwordx4 v242, s[28:31], s54 offen offset:0 sc1 lds
    v_mfma_f32_16x16x32_bf16 v[116:119], a[16:19], a[64:67], v[116:119]
    v_mfma_f32_16x16x32_bf16 v[116:119], a[20:23], a[68:71], v[116:119]
    ds_read_b128 a[144:147], v227 offset:44032
    v_mfma_f32_16x16x32_bf16 v[148:151], a[16:19], a[72:75], v[148:151]
    ds_read_b64_tr_b16 a[108:109], v225 offset:51296
    s_add_u32 m0, s64, 0
    s_add_u32 s54, s41, 0
    buffer_load_dwordx4 v220, s[32:35], s54 offen offset:0 lds
    v_mfma_f32_16x16x32_bf16 v[148:151], a[20:23], a[76:79], v[148:151]
    v_mfma_f32_16x16x32_bf16 v[28:31], a[24:27], a[40:43], v[28:31]
    ds_read_b64_tr_b16 a[110:111], v225 offset:53856
    v_mfma_f32_16x16x32_bf16 v[28:31], a[28:31], a[44:47], v[28:31]
    ds_read_b128 a[148:151], v227 offset:54272
    v_mfma_f32_16x16x32_bf16 v[60:63], a[24:27], a[48:51], v[60:63]
    ds_read_b64_tr_b16 a[112:113], v225 offset:41088
    buffer_load_dwordx4 v221, s[32:35], s54 offen offset:1024 lds
    v_mfma_f32_16x16x32_bf16 v[60:63], a[28:31], a[52:55], v[60:63]
    v_mfma_f32_16x16x32_bf16 v[92:95], a[24:27], a[56:59], v[92:95]
    ds_read_b64_tr_b16 a[114:115], v225 offset:43648
    v_mfma_f32_16x16x32_bf16 v[92:95], a[28:31], a[60:63], v[92:95]
    ds_read_b128 a[152:155], v227 offset:45056
    v_mfma_f32_16x16x32_bf16 v[124:127], a[24:27], a[64:67], v[124:127]
    ds_read_b64_tr_b16 a[116:117], v225 offset:51328
    buffer_load_dwordx4 v222, s[32:35], s54 offen offset:2048 lds
    v_mfma_f32_16x16x32_bf16 v[124:127], a[28:31], a[68:71], v[124:127]
    v_mfma_f32_16x16x32_bf16 v[156:159], a[24:27], a[72:75], v[156:159]
    ds_read_b64_tr_b16 a[118:119], v225 offset:53888
    v_mfma_f32_16x16x32_bf16 v[156:159], a[28:31], a[76:79], v[156:159]
    ds_read_b128 a[156:159], v227 offset:55296
    v_mfma_f32_16x16x32_bf16 v[200:203], a[32:35], a[40:43], v[200:203]
    buffer_load_dwordx4 v223, s[32:35], s54 offen offset:3072 lds
    v_mfma_f32_16x16x32_bf16 v[200:203], a[36:39], a[44:47], v[200:203]
    v_mfma_f32_16x16x32_bf16 v[204:207], a[32:35], a[48:51], v[204:207]
    v_mfma_f32_16x16x32_bf16 v[204:207], a[36:39], a[52:55], v[204:207]
    v_mfma_f32_16x16x32_bf16 v[208:211], a[32:35], a[56:59], v[208:211]
    s_add_u32 m0, s64, 4096
    s_nop 0
    buffer_load_dwordx4 v224, s[32:35], s54 offen offset:0 lds
    v_mfma_f32_16x16x32_bf16 v[208:211], a[36:39], a[60:63], v[208:211]
    v_mfma_f32_16x16x32_bf16 v[212:215], a[32:35], a[64:67], v[212:215]
    v_mfma_f32_16x16x32_bf16 v[212:215], a[36:39], a[68:71], v[212:215]
    v_mfma_f32_16x16x32_bf16 v[216:219], a[32:35], a[72:75], v[216:219]
    v_mfma_f32_16x16x32_bf16 v[216:219], a[36:39], a[76:79], v[216:219]
    s_waitcnt vmcnt(20) lgkmcnt(0)
    v_mfma_f32_16x16x32_bf16 v[4:7], a[80:83], a[120:123], v[4:7]
    s_barrier
    ds_read_b64_tr_b16 a[0:1], v226 offset:0
    v_mfma_f32_16x16x32_bf16 v[4:7], a[84:87], a[124:127], v[4:7]
    ds_read_b64_tr_b16 a[2:3], v226 offset:2560
    v_mfma_f32_16x16x32_bf16 v[36:39], a[80:83], a[128:131], v[36:39]
    ds_read_b128 a[40:43], v228 offset:0
    s_add_u32 m0, s65, 40960
    s_add_u32 s54, s38, 10240
    buffer_load_dwordx4 v241, s[28:31], s54 offen offset:0 sc1 lds
    v_mfma_f32_16x16x32_bf16 v[36:39], a[84:87], a[132:135], v[36:39]
    v_mfma_f32_16x16x32_bf16 v[68:71], a[80:83], a[136:139], v[68:71]
    ds_read_b64_tr_b16 a[4:5], v226 offset:10240
    v_mfma_f32_16x16x32_bf16 v[68:71], a[84:87], a[140:143], v[68:71]
    ds_read_b64_tr_b16 a[6:7], v226 offset:12800
    v_mfma_f32_16x16x32_bf16 v[100:103], a[80:83], a[144:147], v[100:103]
    ds_read_b128 a[44:47], v228 offset:10240
    buffer_load_dwordx4 v241, s[28:31], s54 offen offset:1024 sc1 lds
    v_mfma_f32_16x16x32_bf16 v[100:103], a[84:87], a[148:151], v[100:103]
    v_mfma_f32_16x16x32_bf16 v[132:135], a[80:83], a[152:155], v[132:135]
    ds_read_b64_tr_b16 a[8:9], v226 offset:32
    v_mfma_f32_16x16x32_bf16 v[132:135], a[84:87], a[156:159], v[132:135]
    ds_read_b64_tr_b16 a[10:11], v226 offset:2592
    v_mfma_f32_16x16x32_bf16 v[12:15], a[88:91], a[120:123], v[12:15]
    ds_read_b128 a[48:51], v228 offset:1024
    v_mfma_f32_16x16x32_bf16 v[12:15], a[92:95], a[124:127], v[12:15]
    buffer_load_dwordx4 v241, s[28:31], s54 offen offset:2048 sc1 lds
    v_mfma_f32_16x16x32_bf16 v[44:47], a[88:91], a[128:131], v[44:47]
    ds_read_b64_tr_b16 a[12:13], v226 offset:10272
    v_mfma_f32_16x16x32_bf16 v[44:47], a[92:95], a[132:135], v[44:47]
    ds_read_b64_tr_b16 a[14:15], v226 offset:12832
    v_mfma_f32_16x16x32_bf16 v[76:79], a[88:91], a[136:139], v[76:79]
    v_mfma_f32_16x16x32_bf16 v[76:79], a[92:95], a[140:143], v[76:79]
    ds_read_b128 a[52:55], v228 offset:11264
    buffer_load_dwordx4 v241, s[28:31], s54 offen offset:3072 sc1 lds
    v_mfma_f32_16x16x32_bf16 v[108:111], a[88:91], a[144:147], v[108:111]
    ds_read_b64_tr_b16 a[16:17], v226 offset:64
    v_mfma_f32_16x16x32_bf16 v[108:111], a[92:95], a[148:151], v[108:111]
    ds_read_b64_tr_b16 a[18:19], v226 offset:2624
    v_mfma_f32_16x16x32_bf16 v[140:143], a[88:91], a[152:155], v[140:143]
    v_mfma_f32_16x16x32_bf16 v[140:143], a[92:95], a[156:159], v[140:143]
    ds_read_b128 a[56:59], v228 offset:2048
    v_mfma_f32_16x16x32_bf16 v[20:23], a[96:99], a[120:123], v[20:23]
    ds_read_b64_tr_b16 a[20:21], v226 offset:10304
    s_add_u32 m0, s65, 45056
    s_nop 0
    buffer_load_dwordx4 v242, s[28:31], s54 offen offset:0 sc1 lds
    v_mfma_f32_16x16x32_bf16 v[20:23], a[100:103], a[124:127], v[20:23]
    ds_read_b64_tr_b16 a[22:23], v226 offset:12864
    v_mfma_f32_16x16x32_bf16 v[52:55], a[96:99], a[128:131], v[52:55]
    v_mfma_f32_16x16x32_bf16 v[52:55], a[100:103], a[132:135], v[52:55]
    ds_read_b128 a[60:63], v228 offset:12288
    v_mfma_f32_16x16x32_bf16 v[84:87], a[96:99], a[136:139], v[84:87]
    ds_read_b64_tr_b16 a[24:25], v226 offset:96
    v_mfma_f32_16x16x32_bf16 v[84:87], a[100:103], a[140:143], v[84:87]
    ds_read_b64_tr_b16 a[26:27], v226 offset:2656
    s_add_u32 m0, s64, 40960
    s_add_u32 s54, s41, 81920
    buffer_load_dwordx4 v220, s[32:35], s54 offen offset:0 lds
    v_mfma_f32_16x16x32_bf16 v[116:119], a[96:99], a[144:147], v[116:119]
    v_mfma_f32_16x16x32_bf16 v[116:119], a[100:103], a[148:151], v[116:119]
    ds_read_b128 a[64:67], v228 offset:3072
    v_mfma_f32_16x16x32_bf16 v[148:151], a[96:99], a[152:155], v[148:151]
    ds_read_b64_tr_b16 a[28:29], v226 offset:10336
    v_mfma_f32_16x16x32_bf16 v[148:151], a[100:103], a[156:159], v[148:151]
    buffer_load_dwordx4 v221, s[32:35], s54 offen offset:1024 lds
    v_mfma_f32_16x16x32_bf16 v[28:31], a[104:107], a[120:123], v[28:31]
    ds_read_b64_tr_b16 a[30:31], v226 offset:12896
    v_mfma_f32_16x16x32_bf16 v[28:31], a[108:111], a[124:127], v[28:31]
    ds_read_b128 a[68:71], v228 offset:13312
    v_mfma_f32_16x16x32_bf16 v[60:63], a[104:107], a[128:131], v[60:63]
    ds_read_b64_tr_b16 a[32:33], v226 offset:128
    v_mfma_f32_16x16x32_bf16 v[60:63], a[108:111], a[132:135], v[60:63]
    v_mfma_f32_16x16x32_bf16 v[92:95], a[104:107], a[136:139], v[92:95]
    ds_read_b64_tr_b16 a[34:35], v226 offset:2688
    buffer_load_dwordx4 v222, s[32:35], s54 offen offset:2048 lds
    v_mfma_f32_16x16x32_bf16 v[92:95], a[108:111], a[140:143], v[92:95]
    ds_read_b128 a[72:75], v228 offset:4096
    v_mfma_f32_16x16x32_bf16 v[124:127], a[104:107], a[144:147], v[124:127]
    ds_read_b64_tr_b16 a[36:37], v226 offset:10368
    v_mfma_f32_16x16x32_bf16 v[124:127], a[108:111], a[148:151], v[124:127]
    v_mfma_f32_16x16x32_bf16 v[156:159], a[104:107], a[152:155], v[156:159]
    ds_read_b64_tr_b16 a[38:39], v226 offset:12928
    buffer_load_dwordx4 v223, s[32:35], s54 offen offset:3072 lds
    v_mfma_f32_16x16x32_bf16 v[156:159], a[108:111], a[156:159], v[156:159]
    ds_read_b128 a[76:79], v228 offset:14336
    v_mfma_f32_16x16x32_bf16 v[200:203], a[112:115], a[120:123], v[200:203]
    v_mfma_f32_16x16x32_bf16 v[200:203], a[116:119], a[124:127], v[200:203]
    v_mfma_f32_16x16x32_bf16 v[204:207], a[112:115], a[128:131], v[204:207]
    v_mfma_f32_16x16x32_bf16 v[204:207], a[116:119], a[132:135], v[204:207]
    s_add_u32 m0, s64, 45056
    s_nop 0
    buffer_load_dwordx4 v224, s[32:35], s54 offen offset:0 lds
    v_mfma_f32_16x16x32_bf16 v[208:211], a[112:115], a[136:139], v[208:211]
    v_mfma_f32_16x16x32_bf16 v[208:211], a[116:119], a[140:143], v[208:211]
    v_mfma_f32_16x16x32_bf16 v[212:215], a[112:115], a[144:147], v[212:215]
    v_mfma_f32_16x16x32_bf16 v[212:215], a[116:119], a[148:151], v[212:215]
    v_mfma_f32_16x16x32_bf16 v[216:219], a[112:115], a[152:155], v[216:219]
    v_mfma_f32_16x16x32_bf16 v[216:219], a[116:119], a[156:159], v[216:219]
    s_waitcnt vmcnt(20) lgkmcnt(0)
    v_mfma_f32_16x16x32_bf16 v[4:7], a[0:3], a[40:43], v[4:7]
    s_barrier
    ds_read_b64_tr_b16 a[80:81], v226 offset:40960
    v_mfma_f32_16x16x32_bf16 v[4:7], a[4:7], a[44:47], v[4:7]
    ds_read_b64_tr_b16 a[82:83], v226 offset:43520
    v_mfma_f32_16x16x32_bf16 v[36:39], a[0:3], a[48:51], v[36:39]
    ds_read_b128 a[120:123], v228 offset:40960
    s_add_u32 m0, s65, 81920
    s_add_u32 s54, s38, 20480
    buffer_load_dwordx4 v241, s[28:31], s54 offen offset:0 sc1 lds
    v_mfma_f32_16x16x32_bf16 v[36:39], a[4:7], a[52:55], v[36:39]
    v_mfma_f32_16x16x32_bf16 v[68:71], a[0:3], a[56:59], v[68:71]
    ds_read_b64_tr_b16 a[84:85], v226 offset:51200
    v_mfma_f32_16x16x32_bf16 v[68:71], a[4:7], a[60:63], v[68:71]
    ds_read_b64_tr_b16 a[86:87], v226 offset:53760
    v_mfma_f32_16x16x32_bf16 v[100:103], a[0:3], a[64:67], v[100:103]
    ds_read_b128 a[124:127], v228 offset:51200
    buffer_load_dwordx4 v241, s[28:31], s54 offen offset:1024 sc1 lds
    v_mfma_f32_16x16x32_bf16 v[100:103], a[4:7], a[68:71], v[100:103]
    v_mfma_f32_16x16x32_bf16 v[132:135], a[0:3], a[72:75], v[132:135]
    ds_read_b64_tr_b16 a[88:89], v226 offset:40992
    v_mfma_f32_16x16x32_bf16 v[132:135], a[4:7], a[76:79], v[132:135]
    ds_read_b64_tr_b16 a[90:91], v226 offset:43552
    v_mfma_f32_16x16x32_bf16 v[12:15], a[8:11], a[40:43], v[12:15]
    ds_read_b128 a[128:131], v228 offset:41984
    v_mfma_f32_16x16x32_bf16 v[12:15], a[12:15], a[44:47], v[12:15]
    buffer_load_dwordx4 v241, s[28:31], s54 offen offset:2048 sc1 lds
    v_mfma_f32_16x16x32_bf16 v[44:47], a[8:11], a[48:51], v[44:47]
    ds_read_b64_tr_b16 a[92:93], v226 offset:51232
    v_mfma_f32_16x16x32_bf16 v[44:47], a[12:15], a[52:55], v[44:47]
    ds_read_b64_tr_b16 a[94:95], v226 offset:53792
    v_mfma_f32_16x16x32_bf16 v[76:79], a[8:11], a[56:59], v[76:79]
    v_mfma_f32_16x16x32_bf16 v[76:79], a[12:15], a[60:63], v[76:79]
    ds_read_b128 a[132:135], v228 offset:52224
    buffer_load_dwordx4 v241, s[28:31], s54 offen offset:3072 sc1 lds
    v_mfma_f32_16x16x32_bf16 v[108:111], a[8:11], a[64:67], v[108:111]
    ds_read_b64_tr_b16 a[96:97], v226 offset:41024
    v_mfma_f32_16x16x32_bf16 v[108:111], a[12:15], a[68:71], v[108:111]
    ds_read_b64_tr_b16 a[98:99], v226 offset:43584
    v_mfma_f32_16x16x32_bf16 v[140:143], a[8:11], a[72:75], v[140:143]
    v_mfma_f32_16x16x32_bf16 v[140:143], a[12:15], a[76:79], v[140:143]
    ds_read_b128 a[136:139], v228 offset:43008
    v_mfma_f32_16x16x32_bf16 v[20:23], a[16:19], a[40:43], v[20:23]
    ds_read_b64_tr_b16 a[100:101], v226 offset:51264
    s_add_u32 m0, s65, 86016
    s_nop 0
    buffer_load_dwordx4 v242, s[28:31], s54 offen offset:0 sc1 lds
    v_mfma_f32_16x16x32_bf16 v[20:23], a[20:23], a[44:47], v[20:23]
    ds_read_b64_tr_b16 a[102:103], v226 offset:53824
    v_mfma_f32_16x16x32_bf16 v[52:55], a[16:19], a[48:51], v[52:55]
    v_mfma_f32_16x16x32_bf16 v[52:55], a[20:23], a[52:55], v[52:55]
    ds_read_b128 a[140:143], v228 offset:53248
    v_mfma_f32_16x16x32_bf16 v[84:87], a[16:19], a[56:59], v[84:87]
    ds_read_b64_tr_b16 a[104:105], v226 offset:41056
    v_mfma_f32_16x16x32_bf16 v[84:87], a[20:23], a[60:63], v[84:87]
    ds_read_b64_tr_b16 a[106:107], v226 offset:43616
    s_add_u32 m0, s64, 81920
    s_add_u32 s54, s41, 163840
    buffer_load_dwordx4 v220, s[32:35], s54 offen offset:0 lds
    v_mfma_f32_16x16x32_bf16 v[116:119], a[16:19], a[64:67], v[116:119]
    v_mfma_f32_16x16x32_bf16 v[116:119], a[20:23], a[68:71], v[116:119]
    ds_read_b128 a[144:147], v228 offset:44032
    v_mfma_f32_16x16x32_bf16 v[148:151], a[16:19], a[72:75], v[148:151]
    ds_read_b64_tr_b16 a[108:109], v226 offset:51296
    v_mfma_f32_16x16x32_bf16 v[148:151], a[20:23], a[76:79], v[148:151]
    buffer_load_dwordx4 v221, s[32:35], s54 offen offset:1024 lds
    v_mfma_f32_16x16x32_bf16 v[28:31], a[24:27], a[40:43], v[28:31]
    ds_read_b64_tr_b16 a[110:111], v226 offset:53856
    v_mfma_f32_16x16x32_bf16 v[28:31], a[28:31], a[44:47], v[28:31]
    ds_read_b128 a[148:151], v228 offset:54272
    v_mfma_f32_16x16x32_bf16 v[60:63], a[24:27], a[48:51], v[60:63]
    ds_read_b64_tr_b16 a[112:113], v226 offset:41088
    v_mfma_f32_16x16x32_bf16 v[60:63], a[28:31], a[52:55], v[60:63]
    v_mfma_f32_16x16x32_bf16 v[92:95], a[24:27], a[56:59], v[92:95]
    ds_read_b64_tr_b16 a[114:115], v226 offset:43648
    buffer_load_dwordx4 v222, s[32:35], s54 offen offset:2048 lds
    v_mfma_f32_16x16x32_bf16 v[92:95], a[28:31], a[60:63], v[92:95]
    ds_read_b128 a[152:155], v228 offset:45056
    v_mfma_f32_16x16x32_bf16 v[124:127], a[24:27], a[64:67], v[124:127]
    ds_read_b64_tr_b16 a[116:117], v226 offset:51328
    v_mfma_f32_16x16x32_bf16 v[124:127], a[28:31], a[68:71], v[124:127]
    v_mfma_f32_16x16x32_bf16 v[156:159], a[24:27], a[72:75], v[156:159]
    ds_read_b64_tr_b16 a[118:119], v226 offset:53888
    buffer_load_dwordx4 v223, s[32:35], s54 offen offset:3072 lds
    v_mfma_f32_16x16x32_bf16 v[156:159], a[28:31], a[76:79], v[156:159]
    ds_read_b128 a[156:159], v228 offset:55296
    v_mfma_f32_16x16x32_bf16 v[200:203], a[32:35], a[40:43], v[200:203]
    v_mfma_f32_16x16x32_bf16 v[200:203], a[36:39], a[44:47], v[200:203]
    v_mfma_f32_16x16x32_bf16 v[204:207], a[32:35], a[48:51], v[204:207]
    v_mfma_f32_16x16x32_bf16 v[204:207], a[36:39], a[52:55], v[204:207]
    s_add_u32 m0, s64, 86016
    s_nop 0
    buffer_load_dwordx4 v224, s[32:35], s54 offen offset:0 lds
    v_mfma_f32_16x16x32_bf16 v[208:211], a[32:35], a[56:59], v[208:211]
    v_mfma_f32_16x16x32_bf16 v[208:211], a[36:39], a[60:63], v[208:211]
    v_mfma_f32_16x16x32_bf16 v[212:215], a[32:35], a[64:67], v[212:215]
    v_mfma_f32_16x16x32_bf16 v[212:215], a[36:39], a[68:71], v[212:215]
    v_mfma_f32_16x16x32_bf16 v[216:219], a[32:35], a[72:75], v[216:219]
    v_mfma_f32_16x16x32_bf16 v[216:219], a[36:39], a[76:79], v[216:219]
    s_waitcnt vmcnt(20) lgkmcnt(0)
    v_mfma_f32_16x16x32_bf16 v[4:7], a[80:83], a[120:123], v[4:7]
    s_barrier
    ds_read_b64_tr_b16 a[0:1], v225 offset:0
    v_mfma_f32_16x16x32_bf16 v[4:7], a[84:87], a[124:127], v[4:7]
    ds_read_b64_tr_b16 a[2:3], v225 offset:2560
    v_mfma_f32_16x16x32_bf16 v[36:39], a[80:83], a[128:131], v[36:39]
    ds_read_b128 a[40:43], v227 offset:0
    s_add_u32 m0, s65, 122880
    s_add_u32 s54, s38, 30720
    buffer_load_dwordx4 v241, s[28:31], s54 offen offset:0 sc1 lds
    v_mfma_f32_16x16x32_bf16 v[36:39], a[84:87], a[132:135], v[36:39]
    v_mfma_f32_16x16x32_bf16 v[68:71], a[80:83], a[136:139], v[68:71]
    ds_read_b64_tr_b16 a[4:5], v225 offset:10240
    v_mfma_f32_16x16x32_bf16 v[68:71], a[84:87], a[140:143], v[68:71]
    ds_read_b64_tr_b16 a[6:7], v225 offset:12800
    v_mfma_f32_16x16x32_bf16 v[100:103], a[80:83], a[144:147], v[100:103]
    ds_read_b128 a[44:47], v227 offset:10240
    buffer_load_dwordx4 v241, s[28:31], s54 offen offset:1024 sc1 lds
    v_mfma_f32_16x16x32_bf16 v[100:103], a[84:87], a[148:151], v[100:103]
    v_mfma_f32_16x16x32_bf16 v[132:135], a[80:83], a[152:155], v[132:135]
    ds_read_b64_tr_b16 a[8:9], v225 offset:32
    v_mfma_f32_16x16x32_bf16 v[132:135], a[84:87], a[156:159], v[132:135]
    ds_read_b64_tr_b16 a[10:11], v225 offset:2592
    v_mfma_f32_16x16x32_bf16 v[12:15], a[88:91], a[120:123], v[12:15]
    ds_read_b128 a[48:51], v227 offset:1024
    v_mfma_f32_16x16x32_bf16 v[12:15], a[92:95], a[124:127], v[12:15]
    buffer_load_dwordx4 v241, s[28:31], s54 offen offset:2048 sc1 lds
    v_mfma_f32_16x16x32_bf16 v[44:47], a[88:91], a[128:131], v[44:47]
    ds_read_b64_tr_b16 a[12:13], v225 offset:10272
    v_mfma_f32_16x16x32_bf16 v[44:47], a[92:95], a[132:135], v[44:47]
    ds_read_b64_tr_b16 a[14:15], v225 offset:12832
    v_mfma_f32_16x16x32_bf16 v[76:79], a[88:91], a[136:139], v[76:79]
    v_mfma_f32_16x16x32_bf16 v[76:79], a[92:95], a[140:143], v[76:79]
    ds_read_b128 a[52:55], v227 offset:11264
    buffer_load_dwordx4 v241, s[28:31], s54 offen offset:3072 sc1 lds
    v_mfma_f32_16x16x32_bf16 v[108:111], a[88:91], a[144:147], v[108:111]
    ds_read_b64_tr_b16 a[16:17], v225 offset:64
    v_mfma_f32_16x16x32_bf16 v[108:111], a[92:95], a[148:151], v[108:111]
    ds_read_b64_tr_b16 a[18:19], v225 offset:2624
    v_mfma_f32_16x16x32_bf16 v[140:143], a[88:91], a[152:155], v[140:143]
    v_mfma_f32_16x16x32_bf16 v[140:143], a[92:95], a[156:159], v[140:143]
    ds_read_b128 a[56:59], v227 offset:2048
    v_mfma_f32_16x16x32_bf16 v[20:23], a[96:99], a[120:123], v[20:23]
    ds_read_b64_tr_b16 a[20:21], v225 offset:10304
    s_add_u32 m0, s65, 126976
    s_nop 0
    buffer_load_dwordx4 v242, s[28:31], s54 offen offset:0 sc1 lds
    v_mfma_f32_16x16x32_bf16 v[20:23], a[100:103], a[124:127], v[20:23]
    ds_read_b64_tr_b16 a[22:23], v225 offset:12864
    v_mfma_f32_16x16x32_bf16 v[52:55], a[96:99], a[128:131], v[52:55]
    v_mfma_f32_16x16x32_bf16 v[52:55], a[100:103], a[132:135], v[52:55]
    ds_read_b128 a[60:63], v227 offset:12288
    v_mfma_f32_16x16x32_bf16 v[84:87], a[96:99], a[136:139], v[84:87]
    ds_read_b64_tr_b16 a[24:25], v225 offset:96
    v_mfma_f32_16x16x32_bf16 v[84:87], a[100:103], a[140:143], v[84:87]
    ds_read_b64_tr_b16 a[26:27], v225 offset:2656
    s_add_u32 m0, s64, 122880
    s_add_u32 s54, s41, 245760
    buffer_load_dwordx4 v220, s[32:35], s54 offen offset:0 lds
    v_mfma_f32_16x16x32_bf16 v[116:119], a[96:99], a[144:147], v[116:119]
    v_mfma_f32_16x16x32_bf16 v[116:119], a[100:103], a[148:151], v[116:119]
    ds_read_b128 a[64:67], v227 offset:3072
    v_mfma_f32_16x16x32_bf16 v[148:151], a[96:99], a[152:155], v[148:151]
    ds_read_b64_tr_b16 a[28:29], v225 offset:10336
    v_mfma_f32_16x16x32_bf16 v[148:151], a[100:103], a[156:159], v[148:151]
    buffer_load_dwordx4 v221, s[32:35], s54 offen offset:1024 lds
    v_mfma_f32_16x16x32_bf16 v[28:31], a[104:107], a[120:123], v[28:31]
    ds_read_b64_tr_b16 a[30:31], v225 offset:12896
    v_mfma_f32_16x16x32_bf16 v[28:31], a[108:111], a[124:127], v[28:31]
    ds_read_b128 a[68:71], v227 offset:13312
    v_mfma_f32_16x16x32_bf16 v[60:63], a[104:107], a[128:131], v[60:63]
    ds_read_b64_tr_b16 a[32:33], v225 offset:128
    v_mfma_f32_16x16x32_bf16 v[60:63], a[108:111], a[132:135], v[60:63]
    v_mfma_f32_16x16x32_bf16 v[92:95], a[104:107], a[136:139], v[92:95]
    ds_read_b64_tr_b16 a[34:35], v225 offset:2688
    buffer_load_dwordx4 v222, s[32:35], s54 offen offset:2048 lds
    v_mfma_f32_16x16x32_bf16 v[92:95], a[108:111], a[140:143], v[92:95]
    ds_read_b128 a[72:75], v227 offset:4096
    v_mfma_f32_16x16x32_bf16 v[124:127], a[104:107], a[144:147], v[124:127]
    ds_read_b64_tr_b16 a[36:37], v225 offset:10368
    v_mfma_f32_16x16x32_bf16 v[124:127], a[108:111], a[148:151], v[124:127]
    v_mfma_f32_16x16x32_bf16 v[156:159], a[104:107], a[152:155], v[156:159]
    ds_read_b64_tr_b16 a[38:39], v225 offset:12928
    buffer_load_dwordx4 v223, s[32:35], s54 offen offset:3072 lds
    v_mfma_f32_16x16x32_bf16 v[156:159], a[108:111], a[156:159], v[156:159]
    ds_read_b128 a[76:79], v227 offset:14336
    v_mfma_f32_16x16x32_bf16 v[200:203], a[112:115], a[120:123], v[200:203]
    v_mfma_f32_16x16x32_bf16 v[200:203], a[116:119], a[124:127], v[200:203]
    v_mfma_f32_16x16x32_bf16 v[204:207], a[112:115], a[128:131], v[204:207]
    v_mfma_f32_16x16x32_bf16 v[204:207], a[116:119], a[132:135], v[204:207]
    s_add_u32 m0, s64, 126976
    s_nop 0
    buffer_load_dwordx4 v224, s[32:35], s54 offen offset:0 lds
    v_mfma_f32_16x16x32_bf16 v[208:211], a[112:115], a[136:139], v[208:211]
    v_mfma_f32_16x16x32_bf16 v[208:211], a[116:119], a[140:143], v[208:211]
    v_mfma_f32_16x16x32_bf16 v[212:215], a[112:115], a[144:147], v[212:215]
    v_mfma_f32_16x16x32_bf16 v[212:215], a[116:119], a[148:151], v[212:215]
    v_mfma_f32_16x16x32_bf16 v[216:219], a[112:115], a[152:155], v[216:219]
    v_mfma_f32_16x16x32_bf16 v[216:219], a[116:119], a[156:159], v[216:219]
    s_waitcnt vmcnt(20) lgkmcnt(0)
    v_mfma_f32_16x16x32_bf16 v[4:7], a[0:3], a[40:43], v[4:7]
    s_barrier
    ds_read_b64_tr_b16 a[80:81], v225 offset:40960
    v_mfma_f32_16x16x32_bf16 v[4:7], a[4:7], a[44:47], v[4:7]
    ds_read_b64_tr_b16 a[82:83], v225 offset:43520
    s_lshl_b32 s53, s6, 2
    s_add_u32 s53, s53, s42
    s_lshl_b32 s53, s53, 4
    s_add_u32 s53, s53, s3
    v_mfma_f32_16x16x32_bf16 v[36:39], a[0:3], a[48:51], v[36:39]
    ds_read_b128 a[120:123], v227 offset:40960
    s_mul_i32 s66, s53, 13312
    s_add_u32 s66, s66, 20971520
    s_mul_i32 s59, s43, 53248
    s_add_u32 s67, s66, s59
    v_mfma_f32_16x16x32_bf16 v[36:39], a[4:7], a[52:55], v[36:39]
    v_mfma_f32_16x16x32_bf16 v[68:71], a[0:3], a[56:59], v[68:71]
    ds_read_b64_tr_b16 a[84:85], v225 offset:51200
    s_lshl_b32 s59, s43, 10
    s_add_u32 s66, s66, s59
    v_mfma_f32_16x16x32_bf16 v[68:71], a[4:7], a[60:63], v[68:71]
    ds_read_b64_tr_b16 a[86:87], v225 offset:53760
    s_lshl_b32 s53, s6, 1
    s_add_u32 s53, s53, s5
    s_mul_i32 s58, s53, 102400
    v_mfma_f32_16x16x32_bf16 v[100:103], a[0:3], a[64:67], v[100:103]
    ds_read_b128 a[124:127], v227 offset:51200
    v_mfma_f32_16x16x32_bf16 v[100:103], a[4:7], a[68:71], v[100:103]
    s_mul_i32 s53, s42, 320
    s_add_u32 s58, s58, s53
    s_mul_i32 s53, s4, 160
    s_add_u32 s58, s58, s53
    v_mfma_f32_16x16x32_bf16 v[132:135], a[0:3], a[72:75], v[132:135]
    ds_read_b64_tr_b16 a[88:89], v225 offset:40992
    v_mfma_f32_16x16x32_bf16 v[132:135], a[4:7], a[76:79], v[132:135]
    ds_read_b64_tr_b16 a[90:91], v225 offset:43552
    v_and_b32 v247, 15, v255
    v_mfma_f32_16x16x32_bf16 v[12:15], a[8:11], a[40:43], v[12:15]
    ds_read_b128 a[128:131], v227 offset:41984
    v_mul_u32_u24 v247, 1280, v247
    v_mfma_f32_16x16x32_bf16 v[12:15], a[12:15], a[44:47], v[12:15]
    v_mfma_f32_16x16x32_bf16 v[44:47], a[8:11], a[48:51], v[44:47]
    ds_read_b64_tr_b16 a[92:93], v225 offset:51232
    v_lshrrev_b32 v245, 4, v255
    v_mfma_f32_16x16x32_bf16 v[44:47], a[12:15], a[52:55], v[44:47]
    ds_read_b64_tr_b16 a[94:95], v225 offset:53792
    v_lshl_add_u32 v229, v245, 3, v247
    v_mfma_f32_16x16x32_bf16 v[76:79], a[8:11], a[56:59], v[76:79]
    v_mfma_f32_16x16x32_bf16 v[76:79], a[12:15], a[60:63], v[76:79]
    ds_read_b128 a[132:135], v227 offset:52224
    s_lshl_b32 s53, s43, 1
    s_add_u32 s53, s53, 0
    s_mul_i32 s59, s53, 52
    s_lshr_b32 s59, s59, 8
    v_mfma_f32_16x16x32_bf16 v[108:111], a[8:11], a[64:67], v[108:111]
    ds_read_b64_tr_b16 a[96:97], v225 offset:41024
    v_mfma_f32_16x16x32_bf16 v[108:111], a[12:15], a[68:71], v[108:111]
    ds_read_b64_tr_b16 a[98:99], v225 offset:43584
    s_mul_i32 s55, s59, 5
    s_sub_u32 s55, s53, s55
    s_mul_i32 s55, s55, 20480
    s_lshl_b32 s59, s59, 5
    v_mfma_f32_16x16x32_bf16 v[140:143], a[8:11], a[72:75], v[140:143]
    s_add_u32 s55, s55, s59
    s_add_u32 s55, s55, s58
    s_cmp_lt_u32 s53, 25
    s_cselect_b32 s44, s55, 0x40000000
    v_mfma_f32_16x16x32_bf16 v[140:143], a[12:15], a[76:79], v[140:143]
    ds_read_b128 a[136:139], v227 offset:43008
    v_mfma_f32_16x16x32_bf16 v[20:23], a[16:19], a[40:43], v[20:23]
    ds_read_b64_tr_b16 a[100:101], v225 offset:51264
    s_lshl_b32 s53, s43, 1
    s_add_u32 s53, s53, 1
    s_mul_i32 s59, s53, 52
    s_lshr_b32 s59, s59, 8
    v_mfma_f32_16x16x32_bf16 v[20:23], a[20:23], a[44:47], v[20:23]
    ds_read_b64_tr_b16 a[102:103], v225 offset:53824
    s_mul_i32 s55, s59, 5
    s_sub_u32 s55, s53, s55
    s_mul_i32 s55, s55, 20480
    s_lshl_b32 s59, s59, 5
    v_mfma_f32_16x16x32_bf16 v[52:55], a[16:19], a[48:51], v[52:55]
    v_mfma_f32_16x16x32_bf16 v[52:55], a[20:23], a[52:55], v[52:55]
    ds_read_b128 a[140:143], v227 offset:53248
    s_add_u32 s55, s55, s59
    s_add_u32 s55, s55, s58
    s_cmp_lt_u32 s53, 25
    s_cselect_b32 s45, s55, 0x40000000
    v_mfma_f32_16x16x32_bf16 v[84:87], a[16:19], a[56:59], v[84:87]
    ds_read_b64_tr_b16 a[104:105], v225 offset:41056
    v_mfma_f32_16x16x32_bf16 v[84:87], a[20:23], a[60:63], v[84:87]
    ds_read_b64_tr_b16 a[106:107], v225 offset:43616
    s_lshl_b32 s53, s43, 1
    s_add_u32 s53, s53, 8
    s_mul_i32 s59, s53, 52
    s_lshr_b32 s59, s59, 8
    v_mfma_f32_16x16x32_bf16 v[116:119], a[16:19], a[64:67], v[116:119]
    s_mul_i32 s55, s59, 5
    s_sub_u32 s55, s53, s55
    s_mul_i32 s55, s55, 20480
    s_lshl_b32 s59, s59, 5
    v_mfma_f32_16x16x32_bf16 v[116:119], a[20:23], a[68:71], v[116:119]
    ds_read_b128 a[144:147], v227 offset:44032
    v_mfma_f32_16x16x32_bf16 v[148:151], a[16:19], a[72:75], v[148:151]
    ds_read_b64_tr_b16 a[108:109], v225 offset:51296
    s_add_u32 s55, s55, s59
    s_add_u32 s55, s55, s58
    s_cmp_lt_u32 s53, 25
    s_cselect_b32 s46, s55, 0x40000000
    v_mfma_f32_16x16x32_bf16 v[148:151], a[20:23], a[76:79], v[148:151]
    s_lshl_b32 s53, s43, 1
    s_add_u32 s53, s53, 9
    s_mul_i32 s59, s53, 52
    s_lshr_b32 s59, s59, 8
    v_mfma_f32_16x16x32_bf16 v[28:31], a[24:27], a[40:43], v[28:31]
    ds_read_b64_tr_b16 a[110:111], v225 offset:53856
    v_mfma_f32_16x16x32_bf16 v[28:31], a[28:31], a[44:47], v[28:31]
    ds_read_b128 a[148:151], v227 offset:54272
    s_mul_i32 s55, s59, 5
    s_sub_u32 s55, s53, s55
    s_mul_i32 s55, s55, 20480
    s_lshl_b32 s59, s59, 5
    v_mfma_f32_16x16x32_bf16 v[60:63], a[24:27], a[48:51], v[60:63]
    ds_read_b64_tr_b16 a[112:113], v225 offset:41088
    v_mfma_f32_16x16x32_bf16 v[60:63], a[28:31], a[52:55], v[60:63]
    s_add_u32 s55, s55, s59
    s_add_u32 s55, s55, s58
    s_cmp_lt_u32 s53, 25
    s_cselect_b32 s47, s55, 0x40000000
    v_mfma_f32_16x16x32_bf16 v[92:95], a[24:27], a[56:59], v[92:95]
    ds_read_b64_tr_b16 a[114:115], v225 offset:43648
    s_lshl_b32 s53, s43, 1
    s_add_u32 s53, s53, 16
    s_mul_i32 s59, s53, 52
    s_lshr_b32 s59, s59, 8
    v_mfma_f32_16x16x32_bf16 v[92:95], a[28:31], a[60:63], v[92:95]
    ds_read_b128 a[152:155], v227 offset:45056
    v_mfma_f32_16x16x32_bf16 v[124:127], a[24:27], a[64:67], v[124:127]
    ds_read_b64_tr_b16 a[116:117], v225 offset:51328
    s_mul_i32 s55, s59, 5
    s_sub_u32 s55, s53, s55
    s_mul_i32 s55, s55, 20480
    s_lshl_b32 s59, s59, 5
    v_mfma_f32_16x16x32_bf16 v[124:127], a[28:31], a[68:71], v[124:127]
    s_add_u32 s55, s55, s59
    s_add_u32 s55, s55, s58
    s_cmp_lt_u32 s53, 25
    s_cselect_b32 s48, s55, 0x40000000
    v_mfma_f32_16x16x32_bf16 v[156:159], a[24:27], a[72:75], v[156:159]
    ds_read_b64_tr_b16 a[118:119], v225 offset:53888
    v_mfma_f32_16x16x32_bf16 v[156:159], a[28:31], a[76:79], v[156:159]
    ds_read_b128 a[156:159], v227 offset:55296
    s_lshl_b32 s53, s43, 1
    s_add_u32 s53, s53, 17
    s_mul_i32 s59, s53, 52
    s_lshr_b32 s59, s59, 8
    v_mfma_f32_16x16x32_bf16 v[200:203], a[32:35], a[40:43], v[200:203]
    v_mfma_f32_16x16x32_bf16 v[200:203], a[36:39], a[44:47], v[200:203]
    s_mul_i32 s55, s59, 5
    s_sub_u32 s55, s53, s55
    s_mul_i32 s55, s55, 20480
    s_lshl_b32 s59, s59, 5
    v_mfma_f32_16x16x32_bf16 v[204:207], a[32:35], a[48:51], v[204:207]
    s_add_u32 s55, s55, s59
    s_add_u32 s55, s55, s58
    s_cmp_lt_u32 s53, 25
    s_cselect_b32 s49, s55, 0x40000000
    v_mfma_f32_16x16x32_bf16 v[204:207], a[36:39], a[52:55], v[204:207]
    v_mfma_f32_16x16x32_bf16 v[208:211], a[32:35], a[56:59], v[208:211]
    s_lshl_b32 s53, s43, 1
    s_add_u32 s53, s53, 24
    s_mul_i32 s59, s53, 52
    s_lshr_b32 s59, s59, 8
    v_mfma_f32_16x16x32_bf16 v[208:211], a[36:39], a[60:63], v[208:211]
    s_mul_i32 s55, s59, 5
    s_sub_u32 s55, s53, s55
    s_mul_i32 s55, s55, 20480
    s_lshl_b32 s59, s59, 5
    v_mfma_f32_16x16x32_bf16 v[212:215], a[32:35], a[64:67], v[212:215]
    v_mfma_f32_16x16x32_bf16 v[212:215], a[36:39], a[68:71], v[212:215]
    s_add_u32 s55, s55, s59
    s_add_u32 s55, s55, s58
    s_cmp_lt_u32 s53, 25
    s_cselect_b32 s50, s55, 0x40000000
    v_mfma_f32_16x16x32_bf16 v[216:219], a[32:35], a[72:75], v[216:219]
    v_mfma_f32_16x16x32_bf16 v[216:219], a[36:39], a[76:79], v[216:219]
    s_waitcnt vmcnt(0) lgkmcnt(0)
    v_mfma_f32_16x16x32_bf16 v[4:7], a[80:83], a[120:123], v[4:7]
    s_barrier
    ds_read_b64_tr_b16 a[0:1], v226 offset:0
    ds_read_b64_tr_b16 a[2:3], v226 offset:2560
    v_mfma_f32_16x16x32_bf16 v[4:7], a[84:87], a[124:127], v[4:7]
    ds_read_b128 a[40:43], v228 offset:0
    s_lshl_b32 s53, s43, 1
    s_add_u32 s53, s53, 25
    s_mul_i32 s59, s53, 52
    s_lshr_b32 s59, s59, 8
    v_mfma_f32_16x16x32_bf16 v[36:39], a[80:83], a[128:131], v[36:39]
    ds_read_b64_tr_b16 a[4:5], v226 offset:10240
    v_mfma_f32_16x16x32_bf16 v[36:39], a[84:87], a[132:135], v[36:39]
    ds_read_b64_tr_b16 a[6:7], v226 offset:12800
    ds_read_b128 a[44:47], v228 offset:10240
    v_mfma_f32_16x16x32_bf16 v[68:71], a[80:83], a[136:139], v[68:71]
    ds_read_b64_tr_b16 a[8:9], v226 offset:32
    v_mfma_f32_16x16x32_bf16 v[68:71], a[84:87], a[140:143], v[68:71]
    ds_read_b64_tr_b16 a[10:11], v226 offset:2592
    s_mul_i32 s55, s59, 5
    s_sub_u32 s55, s53, s55
    s_mul_i32 s55, s55, 20480
    s_lshl_b32 s59, s59, 5
    v_mfma_f32_16x16x32_bf16 v[100:103], a[80:83], a[144:147], v[100:103]
    ds_read_b128 a[48:51], v228 offset:1024
    ds_read_b64_tr_b16 a[12:13], v226 offset:10272
    v_mfma_f32_16x16x32_bf16 v[100:103], a[84:87], a[148:151], v[100:103]
    ds_read_b64_tr_b16 a[14:15], v226 offset:12832
    v_mfma_f32_16x16x32_bf16 v[132:135], a[80:83], a[152:155], v[132:135]
    ds_read_b128 a[52:55], v228 offset:11264
    v_mfma_f32_16x16x32_bf16 v[132:135], a[84:87], a[156:159], v[132:135]
    ds_read_b64_tr_b16 a[16:17], v226 offset:64
    ds_read_b64_tr_b16 a[18:19], v226 offset:2624
    s_add_u32 s55, s55, s59
    s_add_u32 s55, s55, s58
    s_cmp_lt_u32 s53, 25
    s_cselect_b32 s51, s55, 0x40000000
    v_mfma_f32_16x16x32_bf16 v[12:15], a[88:91], a[120:123], v[12:15]
    ds_read_b128 a[56:59], v228 offset:2048
    v_mfma_f32_16x16x32_bf16 v[12:15], a[92:95], a[124:127], v[12:15]
    ds_read_b64_tr_b16 a[20:21], v226 offset:10304
    v_mfma_f32_16x16x32_bf16 v[44:47], a[88:91], a[128:131], v[44:47]
    ds_read_b64_tr_b16 a[22:23], v226 offset:12864
    ds_read_b128 a[60:63], v228 offset:12288
    v_mfma_f32_16x16x32_bf16 v[44:47], a[92:95], a[132:135], v[44:47]
    ds_read_b64_tr_b16 a[24:25], v226 offset:96
    s_cmp_eq_u32 s43, 0
    s_cselect_b32 s36, 0x40000000, s67
    v_mfma_f32_16x16x32_bf16 v[76:79], a[88:91], a[136:139], v[76:79]
    ds_read_b64_tr_b16 a[26:27], v226 offset:2656
    v_mfma_f32_16x16x32_bf16 v[76:79], a[92:95], a[140:143], v[76:79]
    ds_read_b128 a[64:67], v228 offset:3072
    ds_read_b64_tr_b16 a[28:29], v226 offset:10336
    v_mfma_f32_16x16x32_bf16 v[108:111], a[88:91], a[144:147], v[108:111]
    ds_read_b64_tr_b16 a[30:31], v226 offset:12896
    v_mfma_f32_16x16x32_bf16 v[108:111], a[92:95], a[148:151], v[108:111]
    ds_read_b128 a[68:71], v228 offset:13312
    s_cmp_eq_u32 s43, 1
    s_cselect_b32 s37, 0x40000000, s67
    v_mfma_f32_16x16x32_bf16 v[140:143], a[88:91], a[152:155], v[140:143]
    ds_read_b64_tr_b16 a[32:33], v226 offset:128
    ds_read_b64_tr_b16 a[34:35], v226 offset:2688
    v_mfma_f32_16x16x32_bf16 v[140:143], a[92:95], a[156:159], v[140:143]
    ds_read_b128 a[72:75], v228 offset:4096
    v_mfma_f32_16x16x32_bf16 v[20:23], a[96:99], a[120:123], v[20:23]
    ds_read_b64_tr_b16 a[36:37], v226 offset:10368
    v_mfma_f32_16x16x32_bf16 v[20:23], a[100:103], a[124:127], v[20:23]
    ds_read_b64_tr_b16 a[38:39], v226 offset:12928
    ds_read_b128 a[76:79], v228 offset:14336
    s_cmp_eq_u32 s43, 2
    s_cselect_b32 s38, 0x40000000, s67
    v_mfma_f32_16x16x32_bf16 v[52:55], a[96:99], a[128:131], v[52:55]
    ds_read_b64_tr_b16 a[160:161], v226 offset:40960
    v_mfma_f32_16x16x32_bf16 v[52:55], a[100:103], a[132:135], v[52:55]
    ds_read_b64_tr_b16 a[162:163], v226 offset:43520
    v_mfma_f32_16x16x32_bf16 v[84:87], a[96:99], a[136:139], v[84:87]
    ds_read_b128 a[200:203], v228 offset:40960
    ds_read_b64_tr_b16 a[164:165], v226 offset:51200
    v_mfma_f32_16x16x32_bf16 v[84:87], a[100:103], a[140:143], v[84:87]
    ds_read_b64_tr_b16 a[166:167], v226 offset:53760
    s_cmp_eq_u32 s43, 3
    s_cselect_b32 s39, 0x40000000, s67
    v_mfma_f32_16x16x32_bf16 v[116:119], a[96:99], a[144:147], v[116:119]
    ds_read_b128 a[204:207], v228 offset:51200
    v_mfma_f32_16x16x32_bf16 v[116:119], a[100:103], a[148:151], v[116:119]
    ds_read_b64_tr_b16 a[168:169], v226 offset:40992
    ds_read_b64_tr_b16 a[170:171], v226 offset:43552
    v_mfma_f32_16x16x32_bf16 v[148:151], a[96:99], a[152:155], v[148:151]
    ds_read_b128 a[208:211], v228 offset:41984
    v_mfma_f32_16x16x32_bf16 v[148:151], a[100:103], a[156:159], v[148:151]
    ds_read_b64_tr_b16 a[172:173], v226 offset:51232
    s_add_u32 s53, s43, 1
    s_and_b32 s53, s53, 3
    s_mul_i32 s53, s53, 53248
    s_add_u32 s70, s66, s53
    v_mfma_f32_16x16x32_bf16 v[28:31], a[104:107], a[120:123], v[28:31]
    ds_read_b64_tr_b16 a[174:175], v226 offset:53792
    ds_read_b128 a[212:215], v228 offset:52224
    v_mfma_f32_16x16x32_bf16 v[28:31], a[108:111], a[124:127], v[28:31]
    ds_read_b64_tr_b16 a[176:177], v226 offset:41024
    v_mfma_f32_16x16x32_bf16 v[60:63], a[104:107], a[128:131], v[60:63]
    ds_read_b64_tr_b16 a[178:179], v226 offset:43584
    v_mfma_f32_16x16x32_bf16 v[60:63], a[108:111], a[132:135], v[60:63]
    ds_read_b128 a[216:219], v228 offset:43008
    ds_read_b64_tr_b16 a[180:181], v226 offset:51264
    s_add_u32 s53, s43, 2
    s_and_b32 s53, s53, 3
    s_mul_i32 s53, s53, 53248
    s_add_u32 s71, s66, s53
    v_mfma_f32_16x16x32_bf16 v[92:95], a[104:107], a[136:139], v[92:95]
    ds_read_b64_tr_b16 a[182:183], v226 offset:53824
    v_mfma_f32_16x16x32_bf16 v[92:95], a[108:111], a[140:143], v[92:95]
    ds_read_b128 a[220:223], v228 offset:53248
    v_mfma_f32_16x16x32_bf16 v[124:127], a[104:107], a[144:147], v[124:127]
    ds_read_b64_tr_b16 a[184:185], v226 offset:41056
    ds_read_b64_tr_b16 a[186:187], v226 offset:43616
    v_mfma_f32_16x16x32_bf16 v[124:127], a[108:111], a[148:151], v[124:127]
    ds_read_b128 a[224:227], v228 offset:44032
    s_add_u32 s53, s43, 3
    s_and_b32 s53, s53, 3
    s_mul_i32 s53, s53, 53248
    s_add_u32 s72, s66, s53
    v_mfma_f32_16x16x32_bf16 v[156:159], a[104:107], a[152:155], v[156:159]
    ds_read_b64_tr_b16 a[188:189], v226 offset:51296
    v_mfma_f32_16x16x32_bf16 v[156:159], a[108:111], a[156:159], v[156:159]
    ds_read_b64_tr_b16 a[190:191], v226 offset:53856
    ds_read_b128 a[228:231], v228 offset:54272
    v_mfma_f32_16x16x32_bf16 v[200:203], a[112:115], a[120:123], v[200:203]
    ds_read_b64_tr_b16 a[192:193], v226 offset:41088
    v_mfma_f32_16x16x32_bf16 v[200:203], a[116:119], a[124:127], v[200:203]
    ds_read_b64_tr_b16 a[194:195], v226 offset:43648
    v_add_u32 v231, 8192, v241
    v_mfma_f32_16x16x32_bf16 v[204:207], a[112:115], a[128:131], v[204:207]
    ds_read_b128 a[232:235], v228 offset:45056
    ds_read_b64_tr_b16 a[196:197], v226 offset:51328
    v_mfma_f32_16x16x32_bf16 v[204:207], a[116:119], a[132:135], v[204:207]
    ds_read_b64_tr_b16 a[198:199], v226 offset:53888
    v_mfma_f32_16x16x32_bf16 v[208:211], a[112:115], a[136:139], v[208:211]
    ds_read_b128 a[236:239], v228 offset:55296
    v_mfma_f32_16x16x32_bf16 v[208:211], a[116:119], a[140:143], v[208:211]
    v_add_u32 v232, 12288, v241
    v_mfma_f32_16x16x32_bf16 v[212:215], a[112:115], a[144:147], v[212:215]
    v_mfma_f32_16x16x32_bf16 v[212:215], a[116:119], a[148:151], v[212:215]
    v_mfma_f32_16x16x32_bf16 v[216:219], a[112:115], a[152:155], v[216:219]
    v_mfma_f32_16x16x32_bf16 v[216:219], a[116:119], a[156:159], v[216:219]
    s_waitcnt lgkmcnt(0)
    v_mfma_f32_16x16x32_bf16 v[4:7], a[0:3], a[40:43], v[4:7]
    v_mfma_f32_16x16x32_bf16 v[4:7], a[4:7], a[44:47], v[4:7]
    v_mfma_f32_16x16x32_bf16 v[4:7], a[160:163], a[200:203], v[4:7]
    v_mfma_f32_16x16x32_bf16 v[4:7], a[164:167], a[204:207], v[4:7]
    v_mfma_f32_16x16x32_bf16 v[36:39], a[0:3], a[48:51], v[36:39]
    v_mfma_f32_16x16x32_bf16 v[36:39], a[4:7], a[52:55], v[36:39]
    v_mfma_f32_16x16x32_bf16 v[36:39], a[160:163], a[208:211], v[36:39]
    v_mfma_f32_16x16x32_bf16 v[36:39], a[164:167], a[212:215], v[36:39]
    v_mfma_f32_16x16x32_bf16 v[68:71], a[0:3], a[56:59], v[68:71]
    v_mfma_f32_16x16x32_bf16 v[68:71], a[4:7], a[60:63], v[68:71]
    v_mfma_f32_16x16x32_bf16 v[68:71], a[160:163], a[216:219], v[68:71]
    v_mfma_f32_16x16x32_bf16 v[68:71], a[164:167], a[220:223], v[68:71]
    v_mfma_f32_16x16x32_bf16 v[100:103], a[0:3], a[64:67], v[100:103]
    v_mfma_f32_16x16x32_bf16 v[100:103], a[4:7], a[68:71], v[100:103]
    v_cvt_pk_bf16_f32 v0, v4, v5
    v_cvt_pk_bf16_f32 v1, v6, v7
    v_mfma_f32_16x16x32_bf16 v[100:103], a[160:163], a[224:227], v[100:103]
    v_cvt_pk_bf16_f32 v2, v36, v37
    v_mfma_f32_16x16x32_bf16 v[100:103], a[164:167], a[228:231], v[100:103]
    v_cvt_pk_bf16_f32 v3, v38, v39
    v_mfma_f32_16x16x32_bf16 v[132:135], a[0:3], a[72:75], v[132:135]
    buffer_store_dwordx4 v[0:3], v241, s[28:31], s36 offen offset:0 sc1
    v_mfma_f32_16x16x32_bf16 v[132:135], a[4:7], a[76:79], v[132:135]
    v_mfma_f32_16x16x32_bf16 v[132:135], a[160:163], a[232:235], v[132:135]
    v_mfma_f32_16x16x32_bf16 v[132:135], a[164:167], a[236:239], v[132:135]
    v_mfma_f32_16x16x32_bf16 v[12:15], a[8:11], a[40:43], v[12:15]
    v_mfma_f32_16x16x32_bf16 v[12:15], a[12:15], a[44:47], v[12:15]
    v_cvt_pk_bf16_f32 v8, v68, v69
    v_cvt_pk_bf16_f32 v9, v70, v71
    v_mfma_f32_16x16x32_bf16 v[12:15], a[168:171], a[200:203], v[12:15]
    v_cvt_pk_bf16_f32 v10, v100, v101
    v_mfma_f32_16x16x32_bf16 v[12:15], a[172:175], a[204:207], v[12:15]
    v_cvt_pk_bf16_f32 v11, v102, v103
    v_mfma_f32_16x16x32_bf16 v[44:47], a[8:11], a[48:51], v[44:47]
    buffer_store_dwordx4 v[8:11], v241, s[28:31], s37 offen offset:1024 sc1
    v_mfma_f32_16x16x32_bf16 v[44:47], a[12:15], a[52:55], v[44:47]
    v_mfma_f32_16x16x32_bf16 v[44:47], a[168:171], a[208:211], v[44:47]
    v_mfma_f32_16x16x32_bf16 v[44:47], a[172:175], a[212:215], v[44:47]
    v_mfma_f32_16x16x32_bf16 v[76:79], a[8:11], a[56:59], v[76:79]
    v_mfma_f32_16x16x32_bf16 v[76:79], a[12:15], a[60:63], v[76:79]
    v_cvt_pk_bf16_f32 v16, v132, v133
    v_cvt_pk_bf16_f32 v17, v134, v135
    v_mfma_f32_16x16x32_bf16 v[76:79], a[168:171], a[216:219], v[76:79]
    v_cvt_pk_bf16_f32 v18, v12, v13
    v_mfma_f32_16x16x32_bf16 v[76:79], a[172:175], a[220:223], v[76:79]
    v_cvt_pk_bf16_f32 v19, v14, v15
    v_mfma_f32_16x16x32_bf16 v[108:111], a[8:11], a[64:67], v[108:111]
    buffer_store_dwordx4 v[16:19], v241, s[28:31], s38 offen offset:2048 sc1
    v_mfma_f32_16x16x32_bf16 v[108:111], a[12:15], a[68:71], v[108:111]
    v_mfma_f32_16x16x32_bf16 v[108:111], a[168:171], a[224:227], v[108:111]
    v_mfma_f32_16x16x32_bf16 v[108:111], a[172:175], a[228:231], v[108:111]
    v_mfma_f32_16x16x32_bf16 v[140:143], a[8:11], a[72:75], v[140:143]
    v_mfma_f32_16x16x32_bf16 v[140:143], a[12:15], a[76:79], v[140:143]
    v_cvt_pk_bf16_f32 v24, v44, v45
    v_cvt_pk_bf16_f32 v25, v46, v47
    v_mfma_f32_16x16x32_bf16 v[140:143], a[168:171], a[232:235], v[140:143]
    v_cvt_pk_bf16_f32 v26, v76, v77
    v_mfma_f32_16x16x32_bf16 v[140:143], a[172:175], a[236:239], v[140:143]
    v_cvt_pk_bf16_f32 v27, v78, v79
    v_mfma_f32_16x16x32_bf16 v[20:23], a[16:19], a[40:43], v[20:23]
    buffer_store_dwordx4 v[24:27], v241, s[28:31], s39 offen offset:3072 sc1
    v_mfma_f32_16x16x32_bf16 v[20:23], a[20:23], a[44:47], v[20:23]
    v_mfma_f32_16x16x32_bf16 v[20:23], a[176:179], a[200:203], v[20:23]
    v_mfma_f32_16x16x32_bf16 v[20:23], a[180:183], a[204:207], v[20:23]
    v_mfma_f32_16x16x32_bf16 v[52:55], a[16:19], a[48:51], v[52:55]
    v_mfma_f32_16x16x32_bf16 v[52:55], a[20:23], a[52:55], v[52:55]
    v_cvt_pk_bf16_f32 v32, v108, v109
    v_cvt_pk_bf16_f32 v33, v110, v111
    v_mfma_f32_16x16x32_bf16 v[52:55], a[176:179], a[208:211], v[52:55]
    v_cvt_pk_bf16_f32 v34, v140, v141
    v_mfma_f32_16x16x32_bf16 v[52:55], a[180:183], a[212:215], v[52:55]
    v_cvt_pk_bf16_f32 v35, v142, v143
    v_mfma_f32_16x16x32_bf16 v[84:87], a[16:19], a[56:59], v[84:87]
    buffer_store_dwordx4 v[32:35], v242, s[28:31], s36 offen offset:0 sc1
    v_mfma_f32_16x16x32_bf16 v[84:87], a[20:23], a[60:63], v[84:87]
    v_mfma_f32_16x16x32_bf16 v[84:87], a[176:179], a[216:219], v[84:87]
    v_mfma_f32_16x16x32_bf16 v[84:87], a[180:183], a[220:223], v[84:87]
    v_mfma_f32_16x16x32_bf16 v[116:119], a[16:19], a[64:67], v[116:119]
    v_mfma_f32_16x16x32_bf16 v[116:119], a[20:23], a[68:71], v[116:119]
    v_cvt_pk_bf16_f32 v40, v20, v21
    v_cvt_pk_bf16_f32 v41, v22, v23
    v_mfma_f32_16x16x32_bf16 v[116:119], a[176:179], a[224:227], v[116:119]
    v_cvt_pk_bf16_f32 v42, v52, v53
    v_mfma_f32_16x16x32_bf16 v[116:119], a[180:183], a[228:231], v[116:119]
    v_cvt_pk_bf16_f32 v43, v54, v55
    v_mfma_f32_16x16x32_bf16 v[148:151], a[16:19], a[72:75], v[148:151]
    buffer_store_dwordx4 v[40:43], v242, s[28:31], s37 offen offset:1024 sc1
    v_mfma_f32_16x16x32_bf16 v[148:151], a[20:23], a[76:79], v[148:151]
    v_mfma_f32_16x16x32_bf16 v[148:151], a[176:179], a[232:235], v[148:151]
    v_mfma_f32_16x16x32_bf16 v[148:151], a[180:183], a[236:239], v[148:151]
    v_mfma_f32_16x16x32_bf16 v[28:31], a[24:27], a[40:43], v[28:31]
    v_mfma_f32_16x16x32_bf16 v[28:31], a[28:31], a[44:47], v[28:31]
    v_cvt_pk_bf16_f32 v48, v84, v85
    v_cvt_pk_bf16_f32 v49, v86, v87
    v_mfma_f32_16x16x32_bf16 v[28:31], a[184:187], a[200:203], v[28:31]
    v_cvt_pk_bf16_f32 v50, v116, v117
    v_mfma_f32_16x16x32_bf16 v[28:31], a[188:191], a[204:207], v[28:31]
    v_cvt_pk_bf16_f32 v51, v118, v119
    v_mfma_f32_16x16x32_bf16 v[60:63], a[24:27], a[48:51], v[60:63]
    buffer_store_dwordx4 v[48:51], v242, s[28:31], s38 offen offset:2048 sc1
    v_mfma_f32_16x16x32_bf16 v[60:63], a[28:31], a[52:55], v[60:63]
    v_mfma_f32_16x16x32_bf16 v[60:63], a[184:187], a[208:211], v[60:63]
    v_mfma_f32_16x16x32_bf16 v[60:63], a[188:191], a[212:215], v[60:63]
    v_mfma_f32_16x16x32_bf16 v[92:95], a[24:27], a[56:59], v[92:95]
    v_mfma_f32_16x16x32_bf16 v[92:95], a[28:31], a[60:63], v[92:95]
    v_cvt_pk_bf16_f32 v56, v148, v149
    v_cvt_pk_bf16_f32 v57, v150, v151
    v_mfma_f32_16x16x32_bf16 v[92:95], a[184:187], a[216:219], v[92:95]
    v_cvt_pk_bf16_f32 v58, v28, v29
    v_mfma_f32_16x16x32_bf16 v[92:95], a[188:191], a[220:223], v[92:95]
    v_cvt_pk_bf16_f32 v59, v30, v31
    v_mfma_f32_16x16x32_bf16 v[124:127], a[24:27], a[64:67], v[124:127]
    buffer_store_dwordx4 v[56:59], v242, s[28:31], s39 offen offset:3072 sc1
    v_mfma_f32_16x16x32_bf16 v[124:127], a[28:31], a[68:71], v[124:127]
    v_mfma_f32_16x16x32_bf16 v[124:127], a[184:187], a[224:227], v[124:127]
    v_mfma_f32_16x16x32_bf16 v[124:127], a[188:191], a[228:231], v[124:127]
    v_mfma_f32_16x16x32_bf16 v[156:159], a[24:27], a[72:75], v[156:159]
    v_mfma_f32_16x16x32_bf16 v[156:159], a[28:31], a[76:79], v[156:159]
    v_cvt_pk_bf16_f32 v64, v60, v61
    v_cvt_pk_bf16_f32 v65, v62, v63
    v_mfma_f32_16x16x32_bf16 v[156:159], a[184:187], a[232:235], v[156:159]
    v_cvt_pk_bf16_f32 v66, v92, v93
    v_mfma_f32_16x16x32_bf16 v[156:159], a[188:191], a[236:239], v[156:159]
    v_cvt_pk_bf16_f32 v67, v94, v95
    v_mfma_f32_16x16x32_bf16 v[200:203], a[32:35], a[40:43], v[200:203]
    buffer_store_dwordx4 v[64:67], v231, s[28:31], s36 offen offset:0 sc1
    v_mfma_f32_16x16x32_bf16 v[200:203], a[36:39], a[44:47], v[200:203]
    v_mfma_f32_16x16x32_bf16 v[200:203], a[192:195], a[200:203], v[200:203]
    v_mfma_f32_16x16x32_bf16 v[200:203], a[196:199], a[204:207], v[200:203]
    v_mfma_f32_16x16x32_bf16 v[204:207], a[32:35], a[48:51], v[204:207]
    v_mfma_f32_16x16x32_bf16 v[204:207], a[36:39], a[52:55], v[204:207]
    v_cvt_pk_bf16_f32 v72, v124, v125
    v_cvt_pk_bf16_f32 v73, v126, v127
    v_mfma_f32_16x16x32_bf16 v[204:207], a[192:195], a[208:211], v[204:207]
    v_cvt_pk_bf16_f32 v74, v156, v157
    v_mfma_f32_16x16x32_bf16 v[204:207], a[196:199], a[212:215], v[204:207]
    v_cvt_pk_bf16_f32 v75, v158, v159
    v_mfma_f32_16x16x32_bf16 v[208:211], a[32:35], a[56:59], v[208:211]
    buffer_store_dwordx4 v[72:75], v231, s[28:31], s37 offen offset:1024 sc1
    v_mfma_f32_16x16x32_bf16 v[208:211], a[36:39], a[60:63], v[208:211]
    v_mfma_f32_16x16x32_bf16 v[208:211], a[192:195], a[216:219], v[208:211]
    v_mfma_f32_16x16x32_bf16 v[208:211], a[196:199], a[220:223], v[208:211]
    v_mfma_f32_16x16x32_bf16 v[212:215], a[32:35], a[64:67], v[212:215]
    v_mfma_f32_16x16x32_bf16 v[212:215], a[36:39], a[68:71], v[212:215]
    v_cvt_pk_bf16_f32 v80, v200, v201
    v_cvt_pk_bf16_f32 v81, v202, v203
    v_mfma_f32_16x16x32_bf16 v[212:215], a[192:195], a[224:227], v[212:215]
    v_cvt_pk_bf16_f32 v82, v204, v205
    v_mfma_f32_16x16x32_bf16 v[212:215], a[196:199], a[228:231], v[212:215]
    v_cvt_pk_bf16_f32 v83, v206, v207
    v_mfma_f32_16x16x32_bf16 v[216:219], a[32:35], a[72:75], v[216:219]
    buffer_store_dwordx4 v[80:83], v231, s[28:31], s38 offen offset:2048 sc1
    v_mfma_f32_16x16x32_bf16 v[216:219], a[36:39], a[76:79], v[216:219]
    v_mfma_f32_16x16x32_bf16 v[216:219], a[192:195], a[232:235], v[216:219]
    v_mfma_f32_16x16x32_bf16 v[216:219], a[196:199], a[236:239], v[216:219]
    v_cvt_pk_bf16_f32 v88, v208, v209
    v_cvt_pk_bf16_f32 v89, v210, v211
    v_cvt_pk_bf16_f32 v90, v212, v213
    v_cvt_pk_bf16_f32 v91, v214, v215
    buffer_store_dwordx4 v[88:91], v231, s[28:31], s39 offen offset:3072 sc1
    s_nop 2
    v_cvt_pk_bf16_f32 v96, v216, v217
    v_cvt_pk_bf16_f32 v97, v218, v219
    buffer_store_dwordx4 v[96:99], v232, s[28:31], s36 offen offset:0 sc1
    s_cmp_lg_u32 s43, 0
    s_cbranch_scc1 K1_OWN1
    v_pk_mov_b32 v[104:105], v[4:5], v[4:5] op_sel:[0,1]
    v_pk_mov_b32 v[106:107], v[6:7], v[6:7] op_sel:[0,1]
    v_pk_mov_b32 v[112:113], v[36:37], v[36:37] op_sel:[0,1]
    v_pk_mov_b32 v[114:115], v[38:39], v[38:39] op_sel:[0,1]
    v_pk_mov_b32 v[120:121], v[108:109], v[108:109] op_sel:[0,1]
    v_pk_mov_b32 v[122:123], v[110:111], v[110:111] op_sel:[0,1]
    v_pk_mov_b32 v[128:129], v[140:141], v[140:141] op_sel:[0,1]
    v_pk_mov_b32 v[130:131], v[142:143], v[142:143] op_sel:[0,1]
    v_pk_mov_b32 v[136:137], v[60:61], v[60:61] op_sel:[0,1]
    v_pk_mov_b32 v[138:139], v[62:63], v[62:63] op_sel:[0,1]
    v_pk_mov_b32 v[144:145], v[92:93], v[92:93] op_sel:[0,1]
    v_pk_mov_b32 v[146:147], v[94:95], v[94:95] op_sel:[0,1]
    v_pk_mov_b32 v[152:153], v[216:217], v[216:217] op_sel:[0,1]
    v_pk_mov_b32 v[154:155], v[218:219], v[218:219] op_sel:[0,1]
    s_branch K1_OWNE
K1_OWN1:
    s_cmp_lg_u32 s43, 1
    s_cbranch_scc1 K1_OWN2
    v_pk_mov_b32 v[104:105], v[68:69], v[68:69] op_sel:[0,1]
    v_pk_mov_b32 v[106:107], v[70:71], v[70:71] op_sel:[0,1]
    v_pk_mov_b32 v[112:113], v[100:101], v[100:101] op_sel:[0,1]
    v_pk_mov_b32 v[114:115], v[102:103], v[102:103] op_sel:[0,1]
    v_pk_mov_b32 v[120:121], v[20:21], v[20:21] op_sel:[0,1]
    v_pk_mov_b32 v[122:123], v[22:23], v[22:23] op_sel:[0,1]
    v_pk_mov_b32 v[128:129], v[52:53], v[52:53] op_sel:[0,1]
    v_pk_mov_b32 v[130:131], v[54:55], v[54:55] op_sel:[0,1]
    v_pk_mov_b32 v[136:137], v[124:125], v[124:125] op_sel:[0,1]
    v_pk_mov_b32 v[138:139], v[126:127], v[126:127] op_sel:[0,1]
    v_pk_mov_b32 v[144:145], v[156:157], v[156:157] op_sel:[0,1]
    v_pk_mov_b32 v[146:147], v[158:159], v[158:159] op_sel:[0,1]
    s_branch K1_OWNE
K1_OWN2:
    s_cmp_lg_u32 s43, 2
    s_cbranch_scc1 K1_OWN3
    v_pk_mov_b32 v[104:105], v[132:133], v[132:133] op_sel:[0,1]
    v_pk_mov_b32 v[106:107], v[134:135], v[134:135] op_sel:[0,1]
    v_pk_mov_b32 v[112:113], v[12:13], v[12:13] op_sel:[0,1]
    v_pk_mov_b32 v[114:115], v[14:15], v[14:15] op_sel:[0,1]
    v_pk_mov_b32 v[120:121], v[84:85], v[84:85] op_sel:[0,1]
    v_pk_mov_b32 v[122:123], v[86:87], v[86:87] op_sel:[0,1]
    v_pk_mov_b32 v[128:129], v[116:117], v[116:117] op_sel:[0,1]
    v_pk_mov_b32 v[130:131], v[118:119], v[118:119] op_sel:[0,1]
    v_pk_mov_b32 v[136:137], v[200:201], v[200:201] op_sel:[0,1]
    v_pk_mov_b32 v[138:139], v[202:203], v[202:203] op_sel:[0,1]
    v_pk_mov_b32 v[144:145], v[204:205], v[204:205] op_sel:[0,1]
    v_pk_mov_b32 v[146:147], v[206:207], v[206:207] op_sel:[0,1]
    s_branch K1_OWNE
K1_OWN3:
    v_pk_mov_b32 v[104:105], v[44:45], v[44:45] op_sel:[0,1]
    v_pk_mov_b32 v[106:107], v[46:47], v[46:47] op_sel:[0,1]
    v_pk_mov_b32 v[112:113], v[76:77], v[76:77] op_sel:[0,1]
    v_pk_mov_b32 v[114:115], v[78:79], v[78:79] op_sel:[0,1]
    v_pk_mov_b32 v[120:121], v[148:149], v[148:149] op_sel:[0,1]
    v_pk_mov_b32 v[122:123], v[150:151], v[150:151] op_sel:[0,1]
    v_pk_mov_b32 v[128:129], v[28:29], v[28:29] op_sel:[0,1]
    v_pk_mov_b32 v[130:131], v[30:31], v[30:31] op_sel:[0,1]
    v_pk_mov_b32 v[136:137], v[208:209], v[208:209] op_sel:[0,1]
    v_pk_mov_b32 v[138:139], v[210:211], v[210:211] op_sel:[0,1]
    v_pk_mov_b32 v[144:145], v[212:213], v[212:213] op_sel:[0,1]
    v_pk_mov_b32 v[146:147], v[214:215], v[214:215] op_sel:[0,1]
K1_OWNE:
    s_waitcnt vmcnt(0)
    s_barrier
    s_cmp_lg_u32 s3, 0
    s_cbranch_scc1 K1_NOPUB2
    v_mov_b32 v246, s80
    v_mov_b32 v247, s81
    s_mov_b64 exec, 1
    buffer_store_dwordx2 v[246:247], v254, s[28:31], s20 offen sc1
    s_mov_b64 exec, -1
K1_NOPUB2:
    s_mov_b32 s63, 0
K1_POLL2:
    buffer_load_dwordx2 v[160:161], v230, s[28:31], s21 offen sc1
    s_waitcnt vmcnt(0)
    v_cmp_ne_u64 vcc, s[80:81], v[160:161]
    s_nop 3
    s_cmp_eq_u64 vcc, 0
    s_cbranch_scc1 K1_POLL2_GO
    s_sleep 1
    s_add_u32 s63, s63, 1
    s_cmp_lt_u32 s63, 0x100000
    s_cbranch_scc1 K1_POLL2
K1_POLL2_GO:
    buffer_load_dwordx4 v[0:3], v241, s[28:31], s70 offen sc1
    buffer_load_dwordx4 v[8:11], v241, s[28:31], s71 offen sc1
    buffer_load_dwordx4 v[16:19], v241, s[28:31], s72 offen sc1
    buffer_load_dwordx4 v[24:27], v242, s[28:31], s70 offen sc1
    buffer_load_dwordx4 v[32:35], v242, s[28:31], s71 offen sc1
    buffer_load_dwordx4 v[40:43], v242, s[28:31], s72 offen sc1
    buffer_load_dwordx4 v[48:51], v231, s[28:31], s70 offen sc1
    buffer_load_dwordx4 v[56:59], v231, s[28:31], s71 offen sc1
    buffer_load_dwordx4 v[64:67], v231, s[28:31], s72 offen sc1
    s_cmp_eq_u32 s43, 0
    s_cselect_b32 s70, s70, 0x40000000
    s_cselect_b32 s71, s71, 0x40000000
    s_cselect_b32 s72, s72, 0x40000000
    buffer_load_dwordx4 v[72:75], v232, s[28:31], s70 offen sc1
    buffer_load_dwordx4 v[80:83], v232, s[28:31], s71 offen sc1
    buffer_load_dwordx4 v[88:91], v232, s[28:31], s72 offen sc1
    s_waitcnt vmcnt(9)
    v_lshlrev_b32 v160, 16, v0
    v_and_b32 v161, s78, v0
    v_lshlrev_b32 v162, 16, v1
    v_and_b32 v163, s78, v1
    v_lshlrev_b32 v164, 16, v2
    v_and_b32 v165, s78, v2
    v_lshlrev_b32 v166, 16, v3
    v_and_b32 v167, s78, v3
    v_lshlrev_b32 v168, 16, v8
    v_and_b32 v169, s78, v8
    v_lshlrev_b32 v170, 16, v9
    v_and_b32 v171, s78, v9
    v_lshlrev_b32 v172, 16, v10
    v_and_b32 v173, s78, v10
    v_lshlrev_b32 v174, 16, v11
    v_and_b32 v175, s78, v11
    v_lshlrev_b32 v176, 16, v16
    v_and_b32 v177, s78, v16
    v_lshlrev_b32 v178, 16, v17
    v_and_b32 v179, s78, v17
    v_lshlrev_b32 v180, 16, v18
    v_and_b32 v181, s78, v18
    v_lshlrev_b32 v182, 16, v19
    v_and_b32 v183, s78, v19
    v_pk_add_f32 v[160:161], v[160:161], v[168:169]
    v_pk_add_f32 v[104:105], v[104:105], v[176:177]
    v_pk_add_f32 v[162:163], v[162:163], v[170:171]
    v_pk_add_f32 v[106:107], v[106:107], v[178:179]
    v_pk_add_f32 v[164:165], v[164:165], v[172:173]
    v_pk_add_f32 v[112:113], v[112:113], v[180:181]
    v_pk_add_f32 v[166:167], v[166:167], v[174:175]
    v_pk_add_f32 v[114:115], v[114:115], v[182:183]
    v_pk_add_f32 v[104:105], v[104:105], v[160:161]
    v_pk_add_f32 v[106:107], v[106:107], v[162:163]
    v_pk_add_f32 v[112:113], v[112:113], v[164:165]
    v_pk_add_f32 v[114:115], v[114:115], v[166:167]
    v_cvt_pk_bf16_f32 v0, v104, v105
    v_cvt_pk_bf16_f32 v1, v106, v107
    v_cvt_pk_bf16_f32 v2, v112, v113
    v_cvt_pk_bf16_f32 v3, v114, v115
    buffer_store_dwordx2 v[0:1], v229, s[12:15], s44 offen sc1
    buffer_store_dwordx2 v[2:3], v229, s[12:15], s45 offen sc1
    s_waitcnt vmcnt(8)
    v_lshlrev_b32 v160, 16, v24
    v_and_b32 v161, s78, v24
    v_lshlrev_b32 v162, 16, v25
    v_and_b32 v163, s78, v25
    v_lshlrev_b32 v164, 16, v26
    v_and_b32 v165, s78, v26
    v_lshlrev_b32 v166, 16, v27
    v_and_b32 v167, s78, v27
    v_lshlrev_b32 v168, 16, v32
    v_and_b32 v169, s78, v32
    v_lshlrev_b32 v170, 16, v33
    v_and_b32 v171, s78, v33
    v_lshlrev_b32 v172, 16, v34
    v_and_b32 v173, s78, v34
    v_lshlrev_b32 v174, 16, v35
    v_and_b32 v175, s78, v35
    v_lshlrev_b32 v176, 16, v40
    v_and_b32 v177, s78, v40
    v_lshlrev_b32 v178, 16, v41
    v_and_b32 v179, s78, v41
    v_lshlrev_b32 v180, 16, v42
    v_and_b32 v181, s78, v42
    v_lshlrev_b32 v182, 16, v43
    v_and_b32 v183, s78, v43
    v_pk_add_f32 v[160:161], v[160:161], v[168:169]
    v_pk_add_f32 v[120:121], v[120:121], v[176:177]
    v_pk_add_f32 v[162:163], v[162:163], v[170:171]
    v_pk_add_f32 v[122:123], v[122:123], v[178:179]
    v_pk_add_f32 v[164:165], v[164:165], v[172:173]
    v_pk_add_f32 v[128:129], v[128:129], v[180:181]
    v_pk_add_f32 v[166:167], v[166:167], v[174:175]
    v_pk_add_f32 v[130:131], v[130:131], v[182:183]
    v_pk_add_f32 v[120:121], v[120:121], v[160:161]
    v_pk_add_f32 v[122:123], v[122:123], v[162:163]
    v_pk_add_f32 v[128:129], v[128:129], v[164:165]
    v_pk_add_f32 v[130:131], v[130:131], v[166:167]
    v_cvt_pk_bf16_f32 v24, v120, v121
    v_cvt_pk_bf16_f32 v25, v122, v123
    v_cvt_pk_bf16_f32 v26, v128, v129
    v_cvt_pk_bf16_f32 v27, v130, v131
    buffer_store_dwordx2 v[24:25], v229, s[12:15], s46 offen sc1
    buffer_store_dwordx2 v[26:27], v229, s[12:15], s47 offen sc1
    s_waitcnt vmcnt(7)
    v_lshlrev_b32 v160, 16, v48
    v_and_b32 v161, s78, v48
    v_lshlrev_b32 v162, 16, v49
    v_and_b32 v163, s78, v49
    v_lshlrev_b32 v164, 16, v50
    v_and_b32 v165, s78, v50
    v_lshlrev_b32 v166, 16, v51
    v_and_b32 v167, s78, v51
    v_lshlrev_b32 v168, 16, v56
    v_and_b32 v169, s78, v56
    v_lshlrev_b32 v170, 16, v57
    v_and_b32 v171, s78, v57
    v_lshlrev_b32 v172, 16, v58
    v_and_b32 v173, s78, v58
    v_lshlrev_b32 v174, 16, v59
    v_and_b32 v175, s78, v59
    v_lshlrev_b32 v176, 16, v64
    v_and_b32 v177, s78, v64
    v_lshlrev_b32 v178, 16, v65
    v_and_b32 v179, s78, v65
    v_lshlrev_b32 v180, 16, v66
    v_and_b32 v181, s78, v66
    v_lshlrev_b32 v182, 16, v67
    v_and_b32 v183, s78, v67
    v_pk_add_f32 v[160:161], v[160:161], v[168:169]
    v_pk_add_f32 v[136:137], v[136:137], v[176:177]
    v_pk_add_f32 v[162:163], v[162:163], v[170:171]
    v_pk_add_f32 v[138:139], v[138:139], v[178:179]
    v_pk_add_f32 v[164:165], v[164:165], v[172:173]
    v_pk_add_f32 v[144:145], v[144:145], v[180:181]
    v_pk_add_f32 v[166:167], v[166:167], v[174:175]
    v_pk_add_f32 v[146:147], v[146:147], v[182:183]
    v_pk_add_f32 v[136:137], v[136:137], v[160:161]
    v_pk_add_f32 v[138:139], v[138:139], v[162:163]
    v_pk_add_f32 v[144:145], v[144:145], v[164:165]
    v_pk_add_f32 v[146:147], v[146:147], v[166:167]
    v_cvt_pk_bf16_f32 v48, v136, v137
    v_cvt_pk_bf16_f32 v49, v138, v139
    v_cvt_pk_bf16_f32 v50, v144, v145
    v_cvt_pk_bf16_f32 v51, v146, v147
    buffer_store_dwordx2 v[48:49], v229, s[12:15], s48 offen sc1
    buffer_store_dwordx2 v[50:51], v229, s[12:15], s49 offen sc1
    s_waitcnt vmcnt(6)
    v_lshlrev_b32 v160, 16, v72
    v_and_b32 v161, s78, v72
    v_lshlrev_b32 v162, 16, v73
    v_and_b32 v163, s78, v73
    v_lshlrev_b32 v164, 16, v74
    v_and_b32 v165, s78, v74
    v_lshlrev_b32 v166, 16, v75
    v_and_b32 v167, s78, v75
    v_lshlrev_b32 v168, 16, v80
    v_and_b32 v169, s78, v80
    v_lshlrev_b32 v170, 16, v81
    v_and_b32 v171, s78, v81
    v_lshlrev_b32 v172, 16, v82
    v_and_b32 v173, s78, v82
    v_lshlrev_b32 v174, 16, v83
    v_and_b32 v175, s78, v83
    v_lshlrev_b32 v176, 16, v88
    v_and_b32 v177, s78, v88
    v_lshlrev_b32 v178, 16, v89
    v_and_b32 v179, s78, v89
    v_lshlrev_b32 v180, 16, v90
    v_and_b32 v181, s78, v90
    v_lshlrev_b32 v182, 16, v91
    v_and_b32 v183, s78, v91
    v_pk_add_f32 v[160:161], v[160:161], v[168:169]
    v_pk_add_f32 v[152:153], v[152:153], v[176:177]
    v_pk_add_f32 v[162:163], v[162:163], v[170:171]
    v_pk_add_f32 v[154:155], v[154:155], v[178:179]
    v_pk_add_f32 v[164:165], v[164:165], v[172:173]
    v_pk_add_f32 v[184:185], v[184:185], v[180:181]
    v_pk_add_f32 v[166:167], v[166:167], v[174:175]
    v_pk_add_f32 v[186:187], v[186:187], v[182:183]
    v_pk_add_f32 v[152:153], v[152:153], v[160:161]
    v_pk_add_f32 v[154:155], v[154:155], v[162:163]
    v_pk_add_f32 v[184:185], v[184:185], v[164:165]
    v_pk_add_f32 v[186:187], v[186:187], v[166:167]
    v_cvt_pk_bf16_f32 v72, v152, v153
    v_cvt_pk_bf16_f32 v73, v154, v155
    v_cvt_pk_bf16_f32 v74, v184, v185
    v_cvt_pk_bf16_f32 v75, v186, v187
    buffer_store_dwordx2 v[72:73], v229, s[12:15], s50 offen sc1
    buffer_store_dwordx2 v[74:75], v229, s[12:15], s51 offen sc1
    s_endpgm
K1_TWAIT:
    s_mov_b32 s63, 0
K1_TW1:
    s_sleep 4
    global_load_dwordx2 v[188:189], v254, s[68:69] sc1
    s_waitcnt vmcnt(0)
    v_readfirstlane_b32 s80, v188
    v_readfirstlane_b32 s81, v189
    s_nop 3
    s_cmp_lg_u32 s80, 0
    s_cbranch_scc1 K1_TGO
    s_add_u32 s63, s63, 1
    s_cmp_lt_u32 s63, 0x100000
    s_cbranch_scc1 K1_TW1
    s_branch K1_TGO
K1_FALL:
    s_mov_b32 s62, 1
    v_xor_b32 v252, 0x2000, v252
    s_waitcnt vmcnt(0) lgkmcnt(0)
    s_nop 7
    v_mov_b32 v200, 0xff800000
    v_mov_b32 v204, 0xff800000
    v_mov_b32 v208, 0xff800000
    v_mov_b32 v212, 0xff800000
    v_mov_b32 v216, 0xff800000
    s_mov_b32 s75, s60
    s_mov_b32 s63, 0
K1_FB:
    s_barrier
    s_add_u32 m0, s61, 0
    s_nop 0
    buffer_load_dwordx4 v237, s[24:27], s75 offen offset:0 nt lds
    buffer_load_dwordx4 v238, s[24:27], s75 offen offset:1024 nt lds
    buffer_load_dwordx4 v239, s[24:27], s75 offen offset:2048 nt lds
    buffer_load_dwordx4 v240, s[24:27], s75 offen offset:3072 nt lds
    s_add_u32 m0, s61, 8192
    s_nop 0
    buffer_load_dwordx4 v244, s[16:19], s75 offen offset:0 nt lds
    buffer_load_dwordx4 v253, s[16:19], s75 offen offset:1024 nt lds
    buffer_load_dwordx4 v244, s[16:19], s75 offen offset:2048 nt lds
    buffer_load_dwordx4 v253, s[16:19], s75 offen offset:3072 nt lds
    s_add_u32 s75, s75, 8192
    s_and_b32 s75, s75, 0x1e000
    s_or_b32 s75, s75, s60
    s_waitcnt vmcnt(0)
    s_barrier
    ds_read_b128 a[0:3], v225 offset:0
    ds_read_b128 a[4:7], v226 offset:0
    ds_read_b128 a[8:11], v227 offset:0
    ds_read_b128 a[12:15], v228 offset:0
    ds_read_b128 a[16:19], v225 offset:4096
    ds_read_b128 a[20:23], v226 offset:4096
    ds_read_b128 a[24:27], v227 offset:4096
    ds_read_b128 a[28:31], v228 offset:4096
    s_waitcnt lgkmcnt(0)
    v_mfma_f32_16x16x32_bf16 v[160:163], a[0:3], a[128:131], 0
    v_mfma_f32_16x16x32_bf16 v[160:163], a[4:7], a[132:135], v[160:163]
    v_mfma_f32_16x16x32_bf16 v[160:163], a[8:11], a[136:139], v[160:163]
    v_mfma_f32_16x16x32_bf16 v[160:163], a[12:15], a[140:143], v[160:163]
    v_mfma_f32_16x16x32_bf16 v[164:167], a[16:19], a[128:131], 0
    v_mfma_f32_16x16x32_bf16 v[164:167], a[20:23], a[132:135], v[164:167]
    v_mfma_f32_16x16x32_bf16 v[164:167], a[24:27], a[136:139], v[164:167]
    v_mfma_f32_16x16x32_bf16 v[164:167], a[28:31], a[140:143], v[164:167]
    v_mfma_f32_16x16x32_bf16 v[168:171], a[0:3], a[144:147], 0
    v_mfma_f32_16x16x32_bf16 v[168:171], a[4:7], a[148:151], v[168:171]
    v_mfma_f32_16x16x32_bf16 v[168:171], a[8:11], a[152:155], v[168:171]
    v_mfma_f32_16x16x32_bf16 v[168:171], a[12:15], a[156:159], v[168:171]
    v_mfma_f32_16x16x32_bf16 v[172:175], a[16:19], a[144:147], 0
    v_mfma_f32_16x16x32_bf16 v[172:175], a[20:23], a[148:151], v[172:175]
    v_mfma_f32_16x16x32_bf16 v[172:175], a[24:27], a[152:155], v[172:175]
    v_mfma_f32_16x16x32_bf16 v[172:175], a[28:31], a[156:159], v[172:175]
    v_mfma_f32_16x16x32_bf16 v[176:179], a[0:3], a[160:163], 0
    v_mfma_f32_16x16x32_bf16 v[176:179], a[4:7], a[164:167], v[176:179]
    v_mfma_f32_16x16x32_bf16 v[176:179], a[8:11], a[168:171], v[176:179]
    v_mfma_f32_16x16x32_bf16 v[176:179], a[12:15], a[172:175], v[176:179]
    v_mfma_f32_16x16x32_bf16 v[180:183], a[16:19], a[160:163], 0
    v_mfma_f32_16x16x32_bf16 v[180:183], a[20:23], a[164:167], v[180:183]
    v_mfma_f32_16x16x32_bf16 v[180:183], a[24:27], a[168:171], v[180:183]
    v_mfma_f32_16x16x32_bf16 v[180:183], a[28:31], a[172:175], v[180:183]
    v_mfma_f32_16x16x32_bf16 v[184:187], a[0:3], a[176:179], 0
    v_mfma_f32_16x16x32_bf16 v[184:187], a[4:7], a[180:183], v[184:187]
    v_mfma_f32_16x16x32_bf16 v[184:187], a[8:11], a[184:187], v[184:187]
    v_mfma_f32_16x16x32_bf16 v[184:187], a[12:15], a[188:191], v[184:187]
    v_mfma_f32_16x16x32_bf16 v[188:191], a[16:19], a[176:179], 0
    v_mfma_f32_16x16x32_bf16 v[188:191], a[20:23], a[180:183], v[188:191]
    v_mfma_f32_16x16x32_bf16 v[188:191], a[24:27], a[184:187], v[188:191]
    v_mfma_f32_16x16x32_bf16 v[188:191], a[28:31], a[188:191], v[188:191]
    v_mfma_f32_16x16x32_bf16 v[192:195], a[0:3], a[192:195], 0
    v_mfma_f32_16x16x32_bf16 v[192:195], a[4:7], a[196:199], v[192:195]
    v_mfma_f32_16x16x32_bf16 v[192:195], a[8:11], a[200:203], v[192:195]
    v_mfma_f32_16x16x32_bf16 v[192:195], a[12:15], a[204:207], v[192:195]
    v_mfma_f32_16x16x32_bf16 v[196:199], a[16:19], a[192:195], 0
    v_mfma_f32_16x16x32_bf16 v[196:199], a[20:23], a[196:199], v[196:199]
    v_mfma_f32_16x16x32_bf16 v[196:199], a[24:27], a[200:203], v[196:199]
    v_mfma_f32_16x16x32_bf16 v[196:199], a[28:31], a[204:207], v[196:199]
    v_max3_f32 v200, v200, v160, v161
    v_max3_f32 v200, v200, v162, v163
    v_max3_f32 v200, v200, v164, v165
    v_max3_f32 v200, v200, v166, v167
    v_max3_f32 v204, v204, v168, v169
    v_max3_f32 v204, v204, v170, v171
    v_max3_f32 v204, v204, v172, v173
    v_max3_f32 v204, v204, v174, v175
    v_max3_f32 v208, v208, v176, v177
    v_max3_f32 v208, v208, v178, v179
    v_max3_f32 v208, v208, v180, v181
    v_max3_f32 v208, v208, v182, v183
    v_max3_f32 v212, v212, v184, v185
    v_max3_f32 v212, v212, v186, v187
    v_max3_f32 v212, v212, v188, v189
    v_max3_f32 v212, v212, v190, v191
    v_max3_f32 v216, v216, v192, v193
    v_max3_f32 v216, v216, v194, v195
    v_max3_f32 v216, v216, v196, v197
    v_max3_f32 v216, v216, v198, v199
    s_add_u32 s63, s63, 1
    s_cmp_lt_u32 s63, 16
    s_cbranch_scc1 K1_FB
    v_mov_b32 v201, v200
    s_nop 1
    v_permlane16_swap_b32 v200, v201
    v_max_f32 v200, v200, v201
    v_mov_b32 v201, v200
    s_nop 1
    v_permlane32_swap_b32 v200, v201
    v_max_f32 v200, v200, v201
    v_sub_f32 v200, 0, v200
    v_mov_b32 v201, v200
    v_mov_b32 v202, v200
    v_mov_b32 v203, v200
    v_mov_b32 v205, v204
    s_nop 1
    v_permlane16_swap_b32 v204, v205
    v_max_f32 v204, v204, v205
    v_mov_b32 v205, v204
    s_nop 1
    v_permlane32_swap_b32 v204, v205
    v_max_f32 v204, v204, v205
    v_sub_f32 v204, 0, v204
    v_mov_b32 v205, v204
    v_mov_b32 v206, v204
    v_mov_b32 v207, v204
    v_mov_b32 v209, v208
    s_nop 1
    v_permlane16_swap_b32 v208, v209
    v_max_f32 v208, v208, v209
    v_mov_b32 v209, v208
    s_nop 1
    v_permlane32_swap_b32 v208, v209
    v_max_f32 v208, v208, v209
    v_sub_f32 v208, 0, v208
    v_mov_b32 v209, v208
    v_mov_b32 v210, v208
    v_mov_b32 v211, v208
    v_mov_b32 v213, v212
    s_nop 1
    v_permlane16_swap_b32 v212, v213
    v_max_f32 v212, v212, v213
    v_mov_b32 v213, v212
    s_nop 1
    v_permlane32_swap_b32 v212, v213
    v_max_f32 v212, v212, v213
    v_sub_f32 v212, 0, v212
    v_mov_b32 v213, v212
    v_mov_b32 v214, v212
    v_mov_b32 v215, v212
    v_mov_b32 v217, v216
    s_nop 1
    v_permlane16_swap_b32 v216, v217
    v_max_f32 v216, v216, v217
    v_mov_b32 v217, v216
    s_nop 1
    v_permlane32_swap_b32 v216, v217
    v_max_f32 v216, v216, v217
    v_sub_f32 v216, 0, v216
    v_mov_b32 v217, v216
    v_mov_b32 v218, v216
    v_mov_b32 v219, v216
    s_barrier
    s_mov_b32 s75, s60
    s_add_u32 m0, s61, 0
    s_nop 0
    buffer_load_dwordx4 v237, s[24:27], s75 offen offset:0 nt lds
    buffer_load_dwordx4 v238, s[24:27], s75 offen offset:1024 nt lds
    buffer_load_dwordx4 v239, s[24:27], s75 offen offset:2048 nt lds
    buffer_load_dwordx4 v240, s[24:27], s75 offen offset:3072 nt lds
    s_add_u32 m0, s61, 8192
    s_nop 0
    buffer_load_dwordx4 v244, s[16:19], s75 offen offset:0 nt lds
    buffer_load_dwordx4 v253, s[16:19], s75 offen offset:1024 nt lds
    buffer_load_dwordx4 v244, s[16:19], s75 offen offset:2048 nt lds
    buffer_load_dwordx4 v253, s[16:19], s75 offen offset:3072 nt lds
    s_add_u32 s75, s75, 8192
    s_and_b32 s75, s75, 0x1e000
    s_or_b32 s75, s75, s60
    s_add_u32 m0, s61, 16384
    s_nop 0
    buffer_load_dwordx4 v237, s[24:27], s75 offen offset:0 nt lds
    buffer_load_dwordx4 v238, s[24:27], s75 offen offset:1024 nt lds
    buffer_load_dwordx4 v239, s[24:27], s75 offen offset:2048 nt lds
    buffer_load_dwordx4 v240, s[24:27], s75 offen offset:3072 nt lds
    s_add_u32 m0, s61, 24576
    s_nop 0
    buffer_load_dwordx4 v244, s[16:19], s75 offen offset:0 nt lds
    buffer_load_dwordx4 v253, s[16:19], s75 offen offset:1024 nt lds
    buffer_load_dwordx4 v244, s[16:19], s75 offen offset:2048 nt lds
    buffer_load_dwordx4 v253, s[16:19], s75 offen offset:3072 nt lds
    s_add_u32 s75, s75, 8192
    s_and_b32 s75, s75, 0x1e000
    s_or_b32 s75, s75, s60
    s_add_u32 m0, s61, 32768
    s_nop 0
    buffer_load_dwordx4 v237, s[24:27], s75 offen offset:0 nt lds
    buffer_load_dwordx4 v238, s[24:27], s75 offen offset:1024 nt lds
    buffer_load_dwordx4 v239, s[24:27], s75 offen offset:2048 nt lds
    buffer_load_dwordx4 v240, s[24:27], s75 offen offset:3072 nt lds
    s_add_u32 m0, s61, 40960
    s_nop 0
    buffer_load_dwordx4 v244, s[16:19], s75 offen offset:0 nt lds
    buffer_load_dwordx4 v253, s[16:19], s75 offen offset:1024 nt lds
    buffer_load_dwordx4 v244, s[16:19], s75 offen offset:2048 nt lds
    buffer_load_dwordx4 v253, s[16:19], s75 offen offset:3072 nt lds
    s_add_u32 s75, s75, 8192
    s_and_b32 s75, s75, 0x1e000
    s_or_b32 s75, s75, s60
    s_add_u32 m0, s61, 49152
    s_nop 0
    buffer_load_dwordx4 v237, s[24:27], s75 offen offset:0 nt lds
    buffer_load_dwordx4 v238, s[24:27], s75 offen offset:1024 nt lds
    buffer_load_dwordx4 v239, s[24:27], s75 offen offset:2048 nt lds
    buffer_load_dwordx4 v240, s[24:27], s75 offen offset:3072 nt lds
    s_add_u32 m0, s61, 57344
    s_nop 0
    buffer_load_dwordx4 v244, s[16:19], s75 offen offset:0 nt lds
    buffer_load_dwordx4 v253, s[16:19], s75 offen offset:1024 nt lds
    buffer_load_dwordx4 v244, s[16:19], s75 offen offset:2048 nt lds
    buffer_load_dwordx4 v253, s[16:19], s75 offen offset:3072 nt lds
    s_add_u32 s75, s75, 8192
    s_and_b32 s75, s75, 0x1e000
    s_or_b32 s75, s75, s60
    s_waitcnt vmcnt(0)
    s_barrier
    ds_read_b128 a[0:3], v225 offset:0
    ds_read_b128 a[4:7], v226 offset:0
    ds_read_b128 a[8:11], v227 offset:0
    ds_read_b128 a[12:15], v228 offset:0
    ds_read_b128 a[16:19], v225 offset:4096
    ds_read_b128 a[20:23], v226 offset:4096
    ds_read_b128 a[24:27], v227 offset:4096
    ds_read_b128 a[28:31], v228 offset:4096
    ds_read_b64_tr_b16 a[32:33], v229 offset:0
    ds_read_b64_tr_b16 a[34:35], v229 offset:4096
    ds_read_b64_tr_b16 a[36:37], v230 offset:0
    ds_read_b64_tr_b16 a[38:39], v230 offset:4096
    ds_read_b64_tr_b16 a[40:41], v231 offset:0
    ds_read_b64_tr_b16 a[42:43], v231 offset:4096
    ds_read_b64_tr_b16 a[44:45], v232 offset:0
    ds_read_b64_tr_b16 a[46:47], v232 offset:4096
    ds_read_b64_tr_b16 a[48:49], v233 offset:0
    ds_read_b64_tr_b16 a[50:51], v233 offset:4096
    ds_read_b64_tr_b16 a[52:53], v234 offset:0
    ds_read_b64_tr_b16 a[54:55], v234 offset:4096
    ds_read_b64_tr_b16 a[56:57], v235 offset:0
    ds_read_b64_tr_b16 a[58:59], v235 offset:4096
    ds_read_b64_tr_b16 a[60:61], v236 offset:0
    ds_read_b64_tr_b16 a[62:63], v236 offset:4096
    s_waitcnt lgkmcnt(0)
    v_mfma_f32_16x16x32_bf16 v[160:163], a[0:3], a[128:131], v[200:203]
    v_mfma_f32_16x16x32_bf16 v[160:163], a[4:7], a[132:135], v[160:163]
    v_mfma_f32_16x16x32_bf16 v[160:163], a[8:11], a[136:139], v[160:163]
    v_mfma_f32_16x16x32_bf16 v[160:163], a[12:15], a[140:143], v[160:163]
    v_mfma_f32_16x16x32_bf16 v[164:167], a[16:19], a[128:131], v[200:203]
    v_mfma_f32_16x16x32_bf16 v[164:167], a[20:23], a[132:135], v[164:167]
    v_mfma_f32_16x16x32_bf16 v[164:167], a[24:27], a[136:139], v[164:167]
    v_mfma_f32_16x16x32_bf16 v[164:167], a[28:31], a[140:143], v[164:167]
    v_mfma_f32_16x16x32_bf16 v[168:171], a[0:3], a[144:147], v[204:207]
    v_mfma_f32_16x16x32_bf16 v[168:171], a[4:7], a[148:151], v[168:171]
    v_mfma_f32_16x16x32_bf16 v[168:171], a[8:11], a[152:155], v[168:171]
    v_mfma_f32_16x16x32_bf16 v[168:171], a[12:15], a[156:159], v[168:171]
    v_mfma_f32_16x16x32_bf16 v[172:175], a[16:19], a[144:147], v[204:207]
    v_mfma_f32_16x16x32_bf16 v[172:175], a[20:23], a[148:151], v[172:175]
    v_mfma_f32_16x16x32_bf16 v[172:175], a[24:27], a[152:155], v[172:175]
    v_mfma_f32_16x16x32_bf16 v[172:175], a[28:31], a[156:159], v[172:175]
    v_mfma_f32_16x16x32_bf16 v[176:179], a[0:3], a[160:163], v[208:211]
    v_mfma_f32_16x16x32_bf16 v[176:179], a[4:7], a[164:167], v[176:179]
    v_mfma_f32_16x16x32_bf16 v[176:179], a[8:11], a[168:171], v[176:179]
    v_mfma_f32_16x16x32_bf16 v[176:179], a[12:15], a[172:175], v[176:179]
    v_mfma_f32_16x16x32_bf16 v[180:183], a[16:19], a[160:163], v[208:211]
    v_mfma_f32_16x16x32_bf16 v[180:183], a[20:23], a[164:167], v[180:183]
    v_mfma_f32_16x16x32_bf16 v[180:183], a[24:27], a[168:171], v[180:183]
    v_mfma_f32_16x16x32_bf16 v[180:183], a[28:31], a[172:175], v[180:183]
    v_mfma_f32_16x16x32_bf16 v[184:187], a[0:3], a[176:179], v[212:215]
    v_mfma_f32_16x16x32_bf16 v[184:187], a[4:7], a[180:183], v[184:187]
    v_mfma_f32_16x16x32_bf16 v[184:187], a[8:11], a[184:187], v[184:187]
    v_mfma_f32_16x16x32_bf16 v[184:187], a[12:15], a[188:191], v[184:187]
    v_mfma_f32_16x16x32_bf16 v[188:191], a[16:19], a[176:179], v[212:215]
    v_mfma_f32_16x16x32_bf16 v[188:191], a[20:23], a[180:183], v[188:191]
    v_mfma_f32_16x16x32_bf16 v[188:191], a[24:27], a[184:187], v[188:191]
    v_mfma_f32_16x16x32_bf16 v[188:191], a[28:31], a[188:191], v[188:191]
    v_mfma_f32_16x16x32_bf16 v[192:195], a[0:3], a[192:195], v[216:219]
    v_mfma_f32_16x16x32_bf16 v[192:195], a[4:7], a[196:199], v[192:195]
    v_mfma_f32_16x16x32_bf16 v[192:195], a[8:11], a[200:203], v[192:195]
    v_mfma_f32_16x16x32_bf16 v[192:195], a[12:15], a[204:207], v[192:195]
    v_mfma_f32_16x16x32_bf16 v[196:199], a[16:19], a[192:195], v[216:219]
    v_mfma_f32_16x16x32_bf16 v[196:199], a[20:23], a[196:199], v[196:199]
    v_mfma_f32_16x16x32_bf16 v[196:199], a[24:27], a[200:203], v[196:199]
    v_mfma_f32_16x16x32_bf16 v[196:199], a[28:31], a[204:207], v[196:199]
    v_exp_f32 v160, v160
    v_exp_f32 v161, v161
    v_exp_f32 v162, v162
    v_cvt_pk_bf16_f32 v160, v160, v161
    v_exp_f32 v163, v163
    v_exp_f32 v164, v164
    v_cvt_pk_bf16_f32 v161, v162, v163
    v_exp_f32 v165, v165
    v_exp_f32 v166, v166
    v_cvt_pk_bf16_f32 v162, v164, v165
    v_exp_f32 v167, v167
    s_nop 0
    v_cvt_pk_bf16_f32 v163, v166, v167
    s_nop 7
    s_branch K1_IT0
K1_END:
    s_endpgm
.section .rodata,"a"
.p2align 6
.amdhsa_kernel standalone__mha_block_cached__near_ridge_kernel
  .amdhsa_next_free_vgpr 512
  .amdhsa_next_free_sgpr 102
  .amdhsa_accum_offset 256
  .amdhsa_group_segment_fixed_size 0
  .amdhsa_kernarg_size 64
  .amdhsa_user_sgpr_count 2
  .amdhsa_user_sgpr_kernarg_segment_ptr 1
  .amdhsa_system_sgpr_workgroup_id_x 1
.end_amdhsa_kernel
```
